```python
import torch

def _softmax(x, axis=-1):
    return torch.softmax(x, dim=axis)
def _gelu(x):
    return torch.nn.functional.gelu(x, approximate="tanh")
def _silu(x):
    return torch.nn.functional.silu(x)
def _sigmoid(x):
    return torch.sigmoid(x)
def _layernorm(x, axis=-1, eps=1e-5):
    m = x.mean(dim=axis, keepdim=True)
    v = x.var(dim=axis, keepdim=True, unbiased=False)
    return (x - m) / torch.sqrt(v + eps)
def _scatter_add(tgt, idx, src, axis=0):
    return tgt.clone().index_add_(axis, idx, src)
def _segment_sum(src, seg, n):
    out = torch.zeros((n,) + src.shape[1:], dtype=src.dtype)
    return out.index_add_(0, seg, src)
def _pad(x, pw):
    flat = tuple(v for pair in reversed(pw) for v in pair)
    return torch.nn.functional.pad(x, flat)

kernel_name = 'recurrent_scan__linear_kernel_hedgehog__glu_gated_bilinear__prompt'

def setup_inputs():

    _w = (lambda a: (lambda t: t.to(torch.bfloat16) if t.is_floating_point() else t)(torch.as_tensor(a)))
    def _A_setup():
        B, S, D, H = 1, 2048, 1024, 32
        Dh = D // H
        return {
            "x": _w((lambda *s: torch.randn(*s, dtype=torch.bfloat16) * 0.05)(B, S, D)),
            "wqkv": _w((lambda *s: torch.randn(*s, dtype=torch.bfloat16) * 0.8)(D, 3 * D)),
            "w_phi": _w((lambda *s: torch.randn(*s, dtype=torch.bfloat16) * 0.8)(H, Dh, Dh) * (Dh ** -0.5)),
            "wo": _w((lambda *s: torch.randn(*s, dtype=torch.bfloat16) * 0.8)(D, D)),
        }
    _A_in = _A_setup()

    def _B_setup():
        B, S, D, F = 1, 2048, 1024, 3584
        return {
            "x": _w((lambda *s: torch.randn(*s, dtype=torch.bfloat16) * 0.05)(B, S, D)),
            "w_gate": _w((lambda *s: torch.randn(*s, dtype=torch.bfloat16) * 0.2)(D, F) * (D ** -0.5)),
            "w_up": _w((lambda *s: torch.randn(*s, dtype=torch.bfloat16) * 0.2)(D, F) * (D ** -0.5)),
            "w_down": _w((lambda *s: torch.randn(*s, dtype=torch.bfloat16) * 0.2)(F, D) * (F ** -0.5)),
        }
    _B_in = _B_setup()

    return {
        "A_x": _A_in["x"],
        "A_wqkv": _A_in["wqkv"],
        "A_w_phi": _A_in["w_phi"],
        "A_wo": _A_in["wo"],
        "B_x": _B_in["x"],
        "B_w_gate": _B_in["w_gate"],
        "B_w_up": _B_in["w_up"],
        "B_w_down": _B_in["w_down"],
    }

def reference(A_x, A_wqkv, A_w_phi, A_wo, B_x, B_w_gate, B_w_up, B_w_down):
    def _A_ref(x, wqkv, w_phi, wo):
        B, S, D = x.shape
        H = 32; Dh = D // H
        qkv = (lambda x, *d: x.permute(*d))((x @ wqkv).reshape(B, S, 3, H, Dh), 2, 0, 3, 1, 4)
        q, k, v = qkv[0], qkv[1], qkv[2]
        pq = torch.einsum("bhsd,hdf->bhsf", q, w_phi)
        pk = torch.einsum("bhsd,hdf->bhsf", k, w_phi)
        phi_q = torch.concatenate([_softmax(pq, axis=-1), _softmax(-pq, axis=-1)], axis=-1)
        phi_k = torch.concatenate([_softmax(pk, axis=-1), _softmax(-pk, axis=-1)], axis=-1)
        kv = torch.einsum("bhsf,bhsd->bhfd", phi_k, v)
        z  = torch.einsum("bhsf->bhf", phi_k)
        num = torch.einsum("bhqf,bhfd->bhqd", phi_q, kv)
        den = torch.einsum("bhqf,bhf->bhq", phi_q, z)[..., None] + 1e-6
        o = num / den
        return (lambda x, *d: x.permute(*d))(o, 0, 2, 1, 3).reshape(B, S, D) @ wo

    def _B_ref(x, w_gate, w_up, w_down):
        g = torch.einsum("bsd,df->bsf", x, w_gate)
        u = torch.einsum("bsd,df->bsf", x, w_up)
        h = g * u
        return torch.einsum("bsf,fd->bsd", h, w_down)

    x = A_x
    xn = _layernorm(x, axis=-1)
    s = _A_ref(xn, A_wqkv, A_w_phi, A_wo)
    g = _silu(_B_ref(xn, B_w_gate, B_w_up, B_w_down))
    return x + s * g
```

```asm
; @launch grid=(256,1,1) block=(256,1,1) lds=163840
.amdgcn_target "amdgcn-amd-amdhsa--gfx950"
.text
.p2align 8
.globl recurrent_scan__linear_kernel_hedgehog__glu_gated_bilinear__prompt_kernel
.type recurrent_scan__linear_kernel_hedgehog__glu_gated_bilinear__prompt_kernel,@function
recurrent_scan__linear_kernel_hedgehog__glu_gated_bilinear__prompt_kernel:
    s_cmp_ge_u32 s2, 256
    s_cbranch_scc1 recurrent_scan__linear_kernel_hedgehog__glu_gated_bilinear__prompt_kernel_end
    s_load_dwordx2 s[8:9], s[0:1], 0
    s_load_dwordx2 s[82:83], s[0:1], 80
    s_load_dwordx2 s[36:37], s[0:1], 72
    s_load_dwordx2 s[70:71], s[0:1], 8
    s_load_dwordx4 s[72:75], s[0:1], 16
    s_load_dwordx4 s[76:79], s[0:1], 40
    s_load_dwordx2 s[80:81], s[0:1], 56
    s_getpc_b64 s[28:29]
k_pc:
    s_and_b32 s29, s29, 0xffff
    s_lshr_b32 s4, s2, 3
    s_lshl_b32 s4, s4, 11
    s_add_u32 s30, s4, 2048
    s_min_u32 s30, s30, code_end-k_pc
    s_mov_b32 s31, 0x20000
    v_lshlrev_b32 v16, 7, v0
    buffer_load_dword v17, v16, s[28:31], s4 offen
    v_lshrrev_b32 v20, 6, v0
    v_and_b32 v1, 63, v0
    v_readfirstlane_b32 s62, v20
    s_and_b32 s3, s2, 7
    s_lshl_b32 s3, s3, 2
    s_bfe_u32 s4, s2, 0x20003
    s_add_u32 s63, s3, s4
    s_lshr_b32 s64, s2, 5
    v_lshlrev_b32 v7, 4, v1
    s_mul_i32 s3, s62, 5
    s_lshl_b32 s84, s63, 6
    s_mul_i32 s85, s63, 224
    s_lshl_b32 s69, s64, 5
    s_add_u32 s69, s69, s63
    v_and_b32 v24, 7, v0
    v_lshrrev_b32 v25, 3, v0
    v_lshlrev_b32 v112, 11, v24
    v_lshl_add_u32 v112, v25, 4, v112
    v_lshrrev_b32 v113, 3, v25
    v_lshlrev_b32 v113, 18, v113
    v_bfe_u32 v26, v25, 2, 1
    v_lshl_add_u32 v113, v26, 12, v113
    v_and_b32 v26, 3, v25
    v_lshl_add_u32 v113, v26, 8, v113
    v_lshl_add_u32 v113, v24, 4, v113
    v_lshlrev_b32 v115, 5, v24
    v_add_u32 v115, 159744, v115
    v_lshl_add_u32 v114, v20, 3, v115
    s_lshl_b32 s4, s64, 2
    s_add_u32 s4, s4, s62
    s_lshl_b32 s59, s4, 13
    s_add_u32 s60, s59, 4096
    s_lshl_b32 s4, s4, 10
    v_lshl_add_u32 v118, v1, 7, s4
    s_lshl_b32 s4, s69, 7
    v_mov_b32 v26, s4
    v_cmp_gt_u32 vcc, 8, v1
    s_nop 1
    v_cndmask_b32 v118, v26, v118, vcc
    s_lshl_b32 s65, s69, 14
    s_add_u32 s4, s3, 0
    s_cmp_ge_u32 s4, 13
    s_cselect_b32 s5, 13, 6
    s_cmp_lt_u32 s4, 6
    s_cselect_b32 s5, 0, s5
    s_cselect_b32 s12, 12, 14
    s_cselect_b32 s13, s84, s85
    s_cselect_b32 s6, 1984, 0
    s_cselect_b32 s7, 2, 0
    s_movk_i32 s15, 4682
    s_cselect_b32 s15, 5462, s15
    s_lshl_b32 s54, s4, 10
    s_sub_u32 s5, s4, s5
    s_lshl_b32 s5, s5, 6
    s_lshl_b32 s14, s12, 9
    s_lshl_b32 s49, s12, 14
    v_add_u32 v20, s5, v1
    v_mul_u32_u24 v21, s15, v20
    v_lshrrev_b32 v21, 16, v21
    v_mul_u32_u24 v22, s12, v21
    v_sub_u32 v22, v20, v22
    v_lshrrev_b32 v23, 1, v21
    v_and_b32 v24, s7, v23
    v_xor_b32 v22, v22, v24
    v_and_b32 v23, 4, v23
    v_and_b32 v24, 4, v21
    v_lshl_or_b32 v23, v24, 1, v23
    v_and_or_b32 v21, v21, 19, v23
    v_mul_u32_u24 v21, s14, v21
    v_lshl_add_u32 v21, v22, 4, v21
    v_lshrrev_b32 v22, 2, v22
    v_mul_u32_u24 v22, s6, v22
    v_add3_u32 v2, v21, v22, s13
    s_lshl_b32 s14, s14, 10
    s_mov_b32 s44, 0
    s_add_u32 s4, s3, 1
    s_cmp_ge_u32 s4, 13
    s_cselect_b32 s5, 13, 6
    s_cmp_lt_u32 s4, 6
    s_cselect_b32 s5, 0, s5
    s_cselect_b32 s16, 12, 14
    s_cselect_b32 s17, s84, s85
    s_cselect_b32 s6, 1984, 0
    s_cselect_b32 s7, 2, 0
    s_movk_i32 s19, 4682
    s_cselect_b32 s19, 5462, s19
    s_lshl_b32 s55, s4, 10
    s_sub_u32 s5, s4, s5
    s_lshl_b32 s5, s5, 6
    s_lshl_b32 s18, s16, 9
    s_lshl_b32 s50, s16, 14
    v_add_u32 v20, s5, v1
    v_mul_u32_u24 v21, s19, v20
    v_lshrrev_b32 v21, 16, v21
    v_mul_u32_u24 v22, s16, v21
    v_sub_u32 v22, v20, v22
    v_lshrrev_b32 v23, 1, v21
    v_and_b32 v24, s7, v23
    v_xor_b32 v22, v22, v24
    v_and_b32 v23, 4, v23
    v_and_b32 v24, 4, v21
    v_lshl_or_b32 v23, v24, 1, v23
    v_and_or_b32 v21, v21, 19, v23
    v_mul_u32_u24 v21, s18, v21
    v_lshl_add_u32 v21, v22, 4, v21
    v_lshrrev_b32 v22, 2, v22
    v_mul_u32_u24 v22, s6, v22
    v_add3_u32 v3, v21, v22, s17
    s_lshl_b32 s18, s18, 10
    s_mov_b32 s45, 0
    s_waitcnt lgkmcnt(0)
    s_and_b32 s9, s9, 0xffff
    s_mov_b32 s10, 0x400000
    s_mov_b32 s11, 0x20000
    buffer_load_dwordx4 v[32:35], v112, s[8:11], s65 offen offset:0
    buffer_load_dwordx4 v[36:39], v112, s[8:11], s65 offen offset:512
    buffer_load_dwordx4 v[40:43], v112, s[8:11], s65 offen offset:1024
    buffer_load_dwordx4 v[44:47], v112, s[8:11], s65 offen offset:1536
    s_mov_b32 s32, s82
    s_and_b32 s33, s83, 0xffff
    s_mov_b32 s34, 52461568
    s_mov_b32 s35, 0x20000
    s_mov_b32 s61, 52428800
    buffer_load_dword v116, v118, s[32:35], s61 offen sc1
    s_cmp_eq_u32 s62, 1
    s_cselect_b32 s40, s76, s78
    s_cselect_b32 s41, s77, s79
    s_movk_i32 s68, 7168
    s_movk_i32 s67, 896
    s_cmp_eq_u32 s62, 0
    s_cselect_b32 s40, s70, s40
    s_cselect_b32 s41, s71, s41
    s_cselect_b32 s68, 6144, s68
    s_cselect_b32 s67, 256, s67
    s_cselect_b32 s43, 6, 7
    s_cselect_b32 s42, 1792, 0
    v_and_b32 v24, 7, v0
    v_lshrrev_b32 v25, 1, v24
    v_mul_u32_u24 v25, s42, v25
    v_lshl_add_u32 v16, v24, 7, v25
    v_cmp_gt_u32 vcc, s43, v24
    v_bfe_u32 v24, v0, 3, 3
    v_mul_u32_u24 v25, s68, v24
    v_add_u32 v16, v16, v25
    v_mov_b32 v25, 0x1000000
    v_cndmask_b32 v16, v25, v16, vcc
    v_cmp_gt_u32 vcc, 4, v24
    s_nop 1
    v_cndmask_b32 v16, v25, v16, vcc
    s_and_b32 s42, s2, 7
    s_mul_i32 s67, s67, s42
    s_lshr_b32 s42, s2, 3
    s_mul_i32 s42, s42, 4
    s_mul_i32 s42, s42, s68
    s_add_u32 s67, s67, s42
    s_lshl_b32 s42, s68, 10
    s_and_b32 s41, s41, 0xffff
    s_mov_b32 s43, 0x20000
    s_lshl_b32 s68, s68, 7
    s_mov_b32 s8, s82
    s_and_b32 s9, s83, 0xffff
    s_mov_b32 s10, 4194304
    s_mov_b32 s11, 0x20000
    s_and_b32 s37, s37, 0xffff
    s_mov_b32 s38, 256
    s_mov_b32 s39, 0x20000
    s_lshl_b32 s66, s2, 2
    s_add_u32 s66, s66, s62
    s_lshl_b32 s66, s66, 10
    s_mul_i32 s4, s2, 3584
    s_sub_u32 s4, s4, 5505024
    s_and_b32 s81, s81, 0xffff
    s_cmp_eq_u32 s62, 3
    s_cselect_b32 s40, s80, s40
    s_cselect_b32 s41, s81, s41
    s_cselect_b32 s67, s4, s67
    s_cselect_b64 s[4:5], -1, 0
    v_lshlrev_b32 v14, 7, v1
    v_cmp_gt_u32 vcc, 28, v1
    s_nop 1
    v_cndmask_b32 v24, v25, v14, vcc
    v_cndmask_b32 v16, v16, v24, s[4:5]
    s_add_u32 s4, s3, 2
    s_cmp_ge_u32 s4, 13
    s_cselect_b32 s5, 13, 6
    s_cmp_lt_u32 s4, 6
    s_cselect_b32 s5, 0, s5
    s_cselect_b32 s20, 12, 14
    s_cselect_b32 s21, s84, s85
    s_cselect_b32 s6, 1984, 0
    s_cselect_b32 s7, 2, 0
    s_movk_i32 s23, 4682
    s_cselect_b32 s23, 5462, s23
    s_lshl_b32 s56, s4, 10
    s_sub_u32 s5, s4, s5
    s_lshl_b32 s5, s5, 6
    s_lshl_b32 s22, s20, 9
    s_lshl_b32 s51, s20, 14
    v_add_u32 v20, s5, v1
    v_mul_u32_u24 v21, s23, v20
    v_lshrrev_b32 v21, 16, v21
    v_mul_u32_u24 v22, s20, v21
    v_sub_u32 v22, v20, v22
    v_lshrrev_b32 v23, 1, v21
    v_and_b32 v24, s7, v23
    v_xor_b32 v22, v22, v24
    v_and_b32 v23, 4, v23
    v_and_b32 v24, 4, v21
    v_lshl_or_b32 v23, v24, 1, v23
    v_and_or_b32 v21, v21, 19, v23
    v_mul_u32_u24 v21, s22, v21
    v_lshl_add_u32 v21, v22, 4, v21
    v_lshrrev_b32 v22, 2, v22
    v_mul_u32_u24 v22, s6, v22
    v_add3_u32 v4, v21, v22, s21
    s_lshl_b32 s22, s22, 10
    s_mov_b32 s46, 0
    s_add_u32 s4, s3, 3
    s_cmp_ge_u32 s4, 13
    s_cselect_b32 s5, 13, 6
    s_cmp_lt_u32 s4, 6
    s_cselect_b32 s5, 0, s5
    s_cselect_b32 s24, 12, 14
    s_cselect_b32 s25, s84, s85
    s_cselect_b32 s6, 1984, 0
    s_cselect_b32 s7, 2, 0
    s_movk_i32 s27, 4682
    s_cselect_b32 s27, 5462, s27
    s_lshl_b32 s57, s4, 10
    s_sub_u32 s5, s4, s5
    s_lshl_b32 s5, s5, 6
    s_lshl_b32 s26, s24, 9
    s_lshl_b32 s52, s24, 14
    v_add_u32 v20, s5, v1
    v_mul_u32_u24 v21, s27, v20
    v_lshrrev_b32 v21, 16, v21
    v_mul_u32_u24 v22, s24, v21
    v_sub_u32 v22, v20, v22
    v_lshrrev_b32 v23, 1, v21
    v_and_b32 v24, s7, v23
    v_xor_b32 v22, v22, v24
    v_and_b32 v23, 4, v23
    v_and_b32 v24, 4, v21
    v_lshl_or_b32 v23, v24, 1, v23
    v_and_or_b32 v21, v21, 19, v23
    v_mul_u32_u24 v21, s26, v21
    v_lshl_add_u32 v21, v22, 4, v21
    v_lshrrev_b32 v22, 2, v22
    v_mul_u32_u24 v22, s6, v22
    v_add3_u32 v5, v21, v22, s25
    s_lshl_b32 s26, s26, 10
    s_mov_b32 s47, 0
    s_add_u32 s4, s3, 4
    s_cmp_ge_u32 s4, 13
    s_cselect_b32 s5, 13, 6
    s_cmp_lt_u32 s4, 6
    s_cselect_b32 s5, 0, s5
    s_cselect_b32 s28, 12, 14
    s_cselect_b32 s29, s84, s85
    s_cselect_b32 s6, 1984, 0
    s_cselect_b32 s7, 2, 0
    s_movk_i32 s31, 4682
    s_cselect_b32 s31, 5462, s31
    s_lshl_b32 s58, s4, 10
    s_sub_u32 s5, s4, s5
    s_lshl_b32 s5, s5, 6
    s_lshl_b32 s30, s28, 9
    s_lshl_b32 s53, s28, 14
    v_add_u32 v20, s5, v1
    v_mul_u32_u24 v21, s31, v20
    v_lshrrev_b32 v21, 16, v21
    v_mul_u32_u24 v22, s28, v21
    v_sub_u32 v22, v20, v22
    v_lshrrev_b32 v23, 1, v21
    v_and_b32 v24, s7, v23
    v_xor_b32 v22, v22, v24
    v_and_b32 v23, 4, v23
    v_and_b32 v24, 4, v21
    v_lshl_or_b32 v23, v24, 1, v23
    v_and_or_b32 v21, v21, 19, v23
    v_mul_u32_u24 v21, s30, v21
    v_lshl_add_u32 v21, v22, 4, v21
    v_lshrrev_b32 v22, 2, v22
    v_mul_u32_u24 v22, s6, v22
    v_add3_u32 v6, v21, v22, s29
    s_lshl_b32 s30, s30, 10
    s_mov_b32 s48, 0
    s_cmp_ge_u32 s3, 13
    s_cselect_b32 s12, s78, s76
    s_cselect_b32 s13, s79, s77
    s_cmp_lt_u32 s3, 6
    s_cselect_b32 s12, s70, s12
    s_cselect_b32 s13, s71, s13
    s_and_b32 s13, s13, 0xffff
    s_mov_b32 s15, 0x20000
    s_cmp_ge_u32 s3, 12
    s_cselect_b32 s16, s78, s76
    s_cselect_b32 s17, s79, s77
    s_cmp_lt_u32 s3, 5
    s_cselect_b32 s16, s70, s16
    s_cselect_b32 s17, s71, s17
    s_and_b32 s17, s17, 0xffff
    s_mov_b32 s19, 0x20000
    s_cmp_ge_u32 s3, 11
    s_cselect_b32 s20, s78, s76
    s_cselect_b32 s21, s79, s77
    s_cmp_lt_u32 s3, 4
    s_cselect_b32 s20, s70, s20
    s_cselect_b32 s21, s71, s21
    s_and_b32 s21, s21, 0xffff
    s_mov_b32 s23, 0x20000
    s_cmp_ge_u32 s3, 10
    s_cselect_b32 s24, s78, s76
    s_cselect_b32 s25, s79, s77
    s_cmp_lt_u32 s3, 3
    s_cselect_b32 s24, s70, s24
    s_cselect_b32 s25, s71, s25
    s_and_b32 s25, s25, 0xffff
    s_mov_b32 s27, 0x20000
    s_cmp_ge_u32 s3, 9
    s_cselect_b32 s28, s78, s76
    s_cselect_b32 s29, s79, s77
    s_cmp_lt_u32 s3, 2
    s_cselect_b32 s28, s70, s28
    s_cselect_b32 s29, s71, s29
    s_and_b32 s29, s29, 0xffff
    s_mov_b32 s31, 0x20000
    v_lshrrev_b32 v24, 5, v1
    v_bfe_u32 v25, v1, 2, 3
    v_lshl_add_u32 v24, v24, 4, v25
    v_and_b32 v26, 3, v1
    v_lshlrev_b32 v26, 3, v26
    v_mul_u32_u24 v27, 224, v24
    v_add_u32 v8, v27, v26
    v_add_u32 v9, 61440, v8
    v_mul_u32_u24 v27, 192, v24
    v_add_u32 v27, v27, v26
    v_and_b32 v25, 16, v1
    v_lshlrev_b32 v25, 1, v25
    v_add_u32 v10, v27, v25
    v_sub_u32 v12, v27, v25
    v_add_u32 v11, 61440, v10
    v_add_u32 v13, 61440, v12
    v_mov_b32 v20, 0
    v_mov_b32 v21, 0
    v_mov_b32 v22, 0
    v_mov_b32 v23, 0
    s_lshr_b32 s3, s69, 3
    s_lshl_b32 s3, s3, 13
    s_bfe_u32 s4, s69, 0x20001
    s_lshl_b32 s4, s4, 10
    s_or_b32 s3, s3, s4
    s_and_b32 s4, s69, 1
    s_lshl_b32 s4, s4, 7
    s_or_b32 s3, s3, s4
    s_mov_b32 s7, 0xffff0000
    s_waitcnt vmcnt(4)
    v_lshlrev_b32 v48, 16, v32
    v_and_b32 v49, s7, v32
    v_lshlrev_b32 v50, 16, v33
    v_and_b32 v51, s7, v33
    v_lshlrev_b32 v52, 16, v34
    v_and_b32 v53, s7, v34
    v_lshlrev_b32 v54, 16, v35
    v_and_b32 v55, s7, v35
    v_mov_b32 v120, v48
    v_mov_b32 v121, v49
    v_mov_b32 v122, v50
    v_mov_b32 v123, v51
    v_pk_add_f32 v[120:121], v[120:121], v[52:53]
    v_pk_add_f32 v[122:123], v[122:123], v[54:55]
    s_waitcnt vmcnt(3)
    v_lshlrev_b32 v56, 16, v36
    v_and_b32 v57, s7, v36
    v_lshlrev_b32 v58, 16, v37
    v_and_b32 v59, s7, v37
    v_lshlrev_b32 v60, 16, v38
    v_and_b32 v61, s7, v38
    v_lshlrev_b32 v62, 16, v39
    v_and_b32 v63, s7, v39
    v_pk_add_f32 v[120:121], v[120:121], v[56:57]
    v_pk_add_f32 v[122:123], v[122:123], v[58:59]
    v_pk_add_f32 v[120:121], v[120:121], v[60:61]
    v_pk_add_f32 v[122:123], v[122:123], v[62:63]
    s_waitcnt vmcnt(2)
    v_lshlrev_b32 v64, 16, v40
    v_and_b32 v65, s7, v40
    v_lshlrev_b32 v66, 16, v41
    v_and_b32 v67, s7, v41
    v_lshlrev_b32 v68, 16, v42
    v_and_b32 v69, s7, v42
    v_lshlrev_b32 v70, 16, v43
    v_and_b32 v71, s7, v43
    v_pk_add_f32 v[120:121], v[120:121], v[64:65]
    v_pk_add_f32 v[122:123], v[122:123], v[66:67]
    v_pk_add_f32 v[120:121], v[120:121], v[68:69]
    v_pk_add_f32 v[122:123], v[122:123], v[70:71]
    s_waitcnt vmcnt(1)
    buffer_load_dword v17, v16, s[40:43], s67 offen
    s_add_u32 s67, s67, s68
    v_lshlrev_b32 v72, 16, v44
    v_and_b32 v73, s7, v44
    v_lshlrev_b32 v74, 16, v45
    v_and_b32 v75, s7, v45
    v_lshlrev_b32 v76, 16, v46
    v_and_b32 v77, s7, v46
    v_lshlrev_b32 v78, 16, v47
    v_and_b32 v79, s7, v47
    v_pk_add_f32 v[120:121], v[120:121], v[72:73]
    v_pk_add_f32 v[122:123], v[122:123], v[74:75]
    v_pk_add_f32 v[120:121], v[120:121], v[76:77]
    v_pk_add_f32 v[122:123], v[122:123], v[78:79]
    v_pk_add_f32 v[120:121], v[120:121], v[122:123]
    v_add_f32 v120, v120, v121
    s_nop 1
    v_add_f32_dpp v120, v120, v120 row_ror:8 row_mask:0xf bank_mask:0xf
    v_mov_b32 v122, v120
    s_nop 1
    v_permlane16_swap_b32 v120, v122
    v_add_f32 v120, v120, v122
    v_mov_b32 v122, v120
    s_nop 1
    v_permlane32_swap_b32 v120, v122
    v_add_f32 v120, v120, v122
    v_mul_f32 v124, 0x3b800000, v120
    v_sub_f32 v80, v48, v124
    v_sub_f32 v81, v49, v124
    v_sub_f32 v82, v50, v124
    v_sub_f32 v83, v51, v124
    v_sub_f32 v84, v52, v124
    v_sub_f32 v85, v53, v124
    v_sub_f32 v86, v54, v124
    v_sub_f32 v87, v55, v124
    v_sub_f32 v88, v56, v124
    v_sub_f32 v89, v57, v124
    v_sub_f32 v90, v58, v124
    v_sub_f32 v91, v59, v124
    v_sub_f32 v92, v60, v124
    v_sub_f32 v93, v61, v124
    v_sub_f32 v94, v62, v124
    v_sub_f32 v95, v63, v124
    v_sub_f32 v96, v64, v124
    v_sub_f32 v97, v65, v124
    v_sub_f32 v98, v66, v124
    v_sub_f32 v99, v67, v124
    v_sub_f32 v100, v68, v124
    v_sub_f32 v101, v69, v124
    v_sub_f32 v102, v70, v124
    v_sub_f32 v103, v71, v124
    v_sub_f32 v104, v72, v124
    v_sub_f32 v105, v73, v124
    v_sub_f32 v106, v74, v124
    v_sub_f32 v107, v75, v124
    v_sub_f32 v108, v76, v124
    v_sub_f32 v109, v77, v124
    v_sub_f32 v110, v78, v124
    v_sub_f32 v111, v79, v124
    v_mul_f32 v32, v80, v80
    v_mul_f32 v33, v81, v81
    v_mul_f32 v34, v82, v82
    v_mul_f32 v35, v83, v83
    v_fmac_f32 v32, v84, v84
    v_fmac_f32 v33, v85, v85
    v_fmac_f32 v34, v86, v86
    v_fmac_f32 v35, v87, v87
    v_fmac_f32 v32, v88, v88
    v_fmac_f32 v33, v89, v89
    v_fmac_f32 v34, v90, v90
    v_fmac_f32 v35, v91, v91
    v_fmac_f32 v32, v92, v92
    v_fmac_f32 v33, v93, v93
    v_fmac_f32 v34, v94, v94
    v_fmac_f32 v35, v95, v95
    v_fmac_f32 v32, v96, v96
    v_fmac_f32 v33, v97, v97
    v_fmac_f32 v34, v98, v98
    v_fmac_f32 v35, v99, v99
    v_fmac_f32 v32, v100, v100
    v_fmac_f32 v33, v101, v101
    v_fmac_f32 v34, v102, v102
    v_fmac_f32 v35, v103, v103
    v_fmac_f32 v32, v104, v104
    v_fmac_f32 v33, v105, v105
    v_fmac_f32 v34, v106, v106
    v_fmac_f32 v35, v107, v107
    v_fmac_f32 v32, v108, v108
    v_fmac_f32 v33, v109, v109
    v_fmac_f32 v34, v110, v110
    v_fmac_f32 v35, v111, v111
    v_add_f32 v32, v32, v33
    v_add_f32 v34, v34, v35
    v_add_f32 v125, v32, v34
    s_nop 1
    v_add_f32_dpp v125, v125, v125 row_ror:8 row_mask:0xf bank_mask:0xf
    v_mov_b32 v122, v125
    s_nop 1
    v_permlane16_swap_b32 v125, v122
    v_add_f32 v125, v125, v122
    v_mov_b32 v122, v125
    s_nop 1
    v_permlane32_swap_b32 v125, v122
    v_add_f32 v125, v125, v122
    s_mov_b64 exec, 0xff
    ds_write_b64 v114, v[124:125]
    s_mov_b64 exec, -1
    s_waitcnt lgkmcnt(0)
    s_barrier
    ds_read_b128 v[32:35], v115
    ds_read_b128 v[36:39], v115 offset:16
    s_waitcnt lgkmcnt(0)
    v_add_f32 v120, v32, v34
    v_add_f32 v122, v36, v38
    v_add_f32 v124, v33, v35
    v_add_f32 v126, v37, v39
    v_add_f32 v120, v120, v122
    v_add_f32 v124, v124, v126
    v_mul_f32 v120, 0x3e800000, v120
    v_mul_f32 v124, 0x3a800000, v124
    v_sub_f32 v32, v32, v120
    v_sub_f32 v34, v34, v120
    v_sub_f32 v36, v36, v120
    v_sub_f32 v38, v38, v120
    v_mul_f32 v122, v32, v32
    v_fmac_f32 v122, v34, v34
    v_fmac_f32 v122, v36, v36
    v_fmac_f32 v122, v38, v38
    v_fmac_f32 v124, 0x3e800000, v122
    v_cvt_pk_bf16_f32 v120, 0, v120
    v_cvt_pk_bf16_f32 v124, 0, v124
    v_add_f32 v124, 0x3727c5ac, v124
    v_cvt_pk_bf16_f32 v124, 0, v124
    v_sqrt_f32 v124, v124
    s_nop 0
    v_cvt_pk_bf16_f32 v124, 0, v124
    v_rcp_f32 v124, v124
    v_sub_f32 v48, v48, v120
    v_sub_f32 v49, v49, v120
    v_sub_f32 v50, v50, v120
    v_sub_f32 v51, v51, v120
    v_sub_f32 v52, v52, v120
    v_sub_f32 v53, v53, v120
    v_sub_f32 v54, v54, v120
    v_sub_f32 v55, v55, v120
    v_cvt_pk_bf16_f32 v48, 0, v48
    v_cvt_pk_bf16_f32 v49, 0, v49
    v_cvt_pk_bf16_f32 v50, 0, v50
    v_cvt_pk_bf16_f32 v51, 0, v51
    v_cvt_pk_bf16_f32 v52, 0, v52
    v_cvt_pk_bf16_f32 v53, 0, v53
    v_cvt_pk_bf16_f32 v54, 0, v54
    v_cvt_pk_bf16_f32 v55, 0, v55
    v_mul_f32 v48, v48, v124
    v_mul_f32 v49, v49, v124
    v_mul_f32 v50, v50, v124
    v_mul_f32 v51, v51, v124
    v_mul_f32 v52, v52, v124
    v_mul_f32 v53, v53, v124
    v_mul_f32 v54, v54, v124
    v_mul_f32 v55, v55, v124
    v_cvt_pk_bf16_f32 v80, v48, v49
    v_cvt_pk_bf16_f32 v81, v50, v51
    v_cvt_pk_bf16_f32 v82, v52, v53
    v_cvt_pk_bf16_f32 v83, v54, v55
    buffer_store_dwordx4 v[80:83], v113, s[8:11], s3 offen sc1
    s_add_u32 s3, s3, 0x100000
    v_sub_f32 v56, v56, v120
    v_sub_f32 v57, v57, v120
    v_sub_f32 v58, v58, v120
    v_sub_f32 v59, v59, v120
    v_sub_f32 v60, v60, v120
    v_sub_f32 v61, v61, v120
    v_sub_f32 v62, v62, v120
    v_sub_f32 v63, v63, v120
    v_cvt_pk_bf16_f32 v56, 0, v56
    v_cvt_pk_bf16_f32 v57, 0, v57
    v_cvt_pk_bf16_f32 v58, 0, v58
    v_cvt_pk_bf16_f32 v59, 0, v59
    v_cvt_pk_bf16_f32 v60, 0, v60
    v_cvt_pk_bf16_f32 v61, 0, v61
    v_cvt_pk_bf16_f32 v62, 0, v62
    v_cvt_pk_bf16_f32 v63, 0, v63
    v_mul_f32 v56, v56, v124
    v_mul_f32 v57, v57, v124
    v_mul_f32 v58, v58, v124
    v_mul_f32 v59, v59, v124
    v_mul_f32 v60, v60, v124
    v_mul_f32 v61, v61, v124
    v_mul_f32 v62, v62, v124
    v_mul_f32 v63, v63, v124
    v_cvt_pk_bf16_f32 v84, v56, v57
    v_cvt_pk_bf16_f32 v85, v58, v59
    v_cvt_pk_bf16_f32 v86, v60, v61
    v_cvt_pk_bf16_f32 v87, v62, v63
    buffer_store_dwordx4 v[84:87], v113, s[8:11], s3 offen sc1
    s_add_u32 s3, s3, 0x100000
    v_sub_f32 v64, v64, v120
    v_sub_f32 v65, v65, v120
    v_sub_f32 v66, v66, v120
    v_sub_f32 v67, v67, v120
    v_sub_f32 v68, v68, v120
    v_sub_f32 v69, v69, v120
    v_sub_f32 v70, v70, v120
    v_sub_f32 v71, v71, v120
    v_cvt_pk_bf16_f32 v64, 0, v64
    v_cvt_pk_bf16_f32 v65, 0, v65
    v_cvt_pk_bf16_f32 v66, 0, v66
    v_cvt_pk_bf16_f32 v67, 0, v67
    v_cvt_pk_bf16_f32 v68, 0, v68
    v_cvt_pk_bf16_f32 v69, 0, v69
    v_cvt_pk_bf16_f32 v70, 0, v70
    v_cvt_pk_bf16_f32 v71, 0, v71
    v_mul_f32 v64, v64, v124
    v_mul_f32 v65, v65, v124
    v_mul_f32 v66, v66, v124
    v_mul_f32 v67, v67, v124
    v_mul_f32 v68, v68, v124
    v_mul_f32 v69, v69, v124
    v_mul_f32 v70, v70, v124
    v_mul_f32 v71, v71, v124
    v_cvt_pk_bf16_f32 v88, v64, v65
    v_cvt_pk_bf16_f32 v89, v66, v67
    v_cvt_pk_bf16_f32 v90, v68, v69
    v_cvt_pk_bf16_f32 v91, v70, v71
    buffer_store_dwordx4 v[88:91], v113, s[8:11], s3 offen sc1
    s_add_u32 s3, s3, 0x100000
    v_sub_f32 v72, v72, v120
    v_sub_f32 v73, v73, v120
    v_sub_f32 v74, v74, v120
    v_sub_f32 v75, v75, v120
    v_sub_f32 v76, v76, v120
    v_sub_f32 v77, v77, v120
    v_sub_f32 v78, v78, v120
    v_sub_f32 v79, v79, v120
    v_cvt_pk_bf16_f32 v72, 0, v72
    v_cvt_pk_bf16_f32 v73, 0, v73
    v_cvt_pk_bf16_f32 v74, 0, v74
    v_cvt_pk_bf16_f32 v75, 0, v75
    v_cvt_pk_bf16_f32 v76, 0, v76
    v_cvt_pk_bf16_f32 v77, 0, v77
    v_cvt_pk_bf16_f32 v78, 0, v78
    v_cvt_pk_bf16_f32 v79, 0, v79
    v_mul_f32 v72, v72, v124
    v_mul_f32 v73, v73, v124
    v_mul_f32 v74, v74, v124
    v_mul_f32 v75, v75, v124
    v_mul_f32 v76, v76, v124
    v_mul_f32 v77, v77, v124
    v_mul_f32 v78, v78, v124
    v_mul_f32 v79, v79, v124
    v_cvt_pk_bf16_f32 v92, v72, v73
    v_cvt_pk_bf16_f32 v93, v74, v75
    v_cvt_pk_bf16_f32 v94, v76, v77
    v_cvt_pk_bf16_f32 v95, v78, v79
    buffer_store_dwordx4 v[92:95], v113, s[8:11], s3 offen sc1
    s_add_u32 s3, s3, 0x100000
    s_mov_b32 s88, s72
    s_and_b32 s89, s73, 0xffff
    s_mov_b32 s90, 65536
    s_mov_b32 s91, 0x20000
    s_and_b32 s4, s62, 1
    v_mfma_f32_32x32x16_bf16 a[0:15], v[20:23], v[20:23], 0
    s_lshl_b32 s4, s4, 10
    s_add_u32 s95, s4, 122880
    s_lshl_b32 s94, s63, 11
    s_add_u32 s94, s94, s4
    v_and_b32 v24, 31, v1
    v_mfma_f32_32x32x16_bf16 a[16:31], v[20:23], v[20:23], 0
    v_lshrrev_b32 v25, 5, v1
    v_lshlrev_b32 v25, 2, v25
    v_sub_u32 v24, v24, v25
    v_mov_b32 v26, 0x3f80
    v_mov_b32 v27, 0x3f800000
    v_mfma_f32_32x32x16_bf16 a[32:47], v[20:23], v[20:23], 0
    v_cmp_eq_u32 vcc, 0, v24
    v_cmp_eq_u32 s[4:5], 1, v24
    s_nop 0
    v_cndmask_b32 v28, 0, v26, vcc
    v_cndmask_b32 v28, v28, v27, s[4:5]
    v_accvgpr_write_b32 a224, v28
    v_mfma_f32_32x32x16_bf16 a[48:63], v[20:23], v[20:23], 0
    v_cmp_eq_u32 vcc, 2, v24
    v_cmp_eq_u32 s[4:5], 3, v24
    s_nop 0
    v_cndmask_b32 v28, 0, v26, vcc
    v_cndmask_b32 v28, v28, v27, s[4:5]
    v_accvgpr_write_b32 a225, v28
    v_mfma_f32_32x32x16_bf16 a[64:79], v[20:23], v[20:23], 0
    v_cmp_eq_u32 vcc, 8, v24
    v_cmp_eq_u32 s[4:5], 9, v24
    s_nop 0
    v_cndmask_b32 v28, 0, v26, vcc
    v_cndmask_b32 v28, v28, v27, s[4:5]
    v_accvgpr_write_b32 a226, v28
    v_mfma_f32_32x32x16_bf16 a[80:95], v[20:23], v[20:23], 0
    v_cmp_eq_u32 vcc, 10, v24
    v_cmp_eq_u32 s[4:5], 11, v24
    s_nop 0
    v_cndmask_b32 v28, 0, v26, vcc
    v_cndmask_b32 v28, v28, v27, s[4:5]
    v_accvgpr_write_b32 a227, v28
    v_mfma_f32_32x32x16_bf16 v[128:143], v[20:23], v[20:23], 0
    v_cmp_eq_u32 vcc, 16, v24
    v_cmp_eq_u32 s[4:5], 17, v24
    s_nop 0
    v_cndmask_b32 v28, 0, v26, vcc
    v_cndmask_b32 v28, v28, v27, s[4:5]
    v_accvgpr_write_b32 a228, v28
    v_mfma_f32_32x32x16_bf16 v[144:159], v[20:23], v[20:23], 0
    v_cmp_eq_u32 vcc, 18, v24
    v_cmp_eq_u32 s[4:5], 19, v24
    s_nop 0
    v_cndmask_b32 v28, 0, v26, vcc
    v_cndmask_b32 v28, v28, v27, s[4:5]
    v_accvgpr_write_b32 a229, v28
    v_mfma_f32_32x32x16_bf16 v[160:175], v[20:23], v[20:23], 0
    v_cmp_eq_u32 vcc, 24, v24
    v_cmp_eq_u32 s[4:5], 25, v24
    s_nop 0
    v_cndmask_b32 v28, 0, v26, vcc
    v_cndmask_b32 v28, v28, v27, s[4:5]
    v_accvgpr_write_b32 a230, v28
    v_mfma_f32_32x32x16_bf16 v[176:191], v[20:23], v[20:23], 0
    v_cmp_eq_u32 vcc, 26, v24
    v_cmp_eq_u32 s[4:5], 27, v24
    s_nop 0
    v_cndmask_b32 v28, 0, v26, vcc
    v_cndmask_b32 v28, v28, v27, s[4:5]
    v_accvgpr_write_b32 a231, v28
    v_mfma_f32_32x32x16_bf16 v[192:207], v[20:23], v[20:23], 0
    v_mov_b32 v28, 0x3f803f80
    v_accvgpr_write_b32 a232, v28
    v_accvgpr_write_b32 a233, v28
    v_accvgpr_write_b32 a234, v28
    v_accvgpr_write_b32 a235, v28
    v_mfma_f32_32x32x16_bf16 v[208:223], v[20:23], v[20:23], 0
    s_lshl_b32 s3, s64, 3
    s_lshl_b32 s4, s62, 1
    s_add_u32 s3, s3, s4
    s_lshl_b32 s4, s3, 12
    s_add_u32 s4, s4, 4194304
    v_mfma_f32_32x32x16_bf16 v[224:239], v[20:23], v[20:23], 0
    s_mul_i32 s5, s63, 7
    s_add_u32 s6, s5, 0
    s_lshr_b32 s7, s6, 2
    s_lshl_b32 s7, s7, 18
    s_add_u32 s70, s7, s4
    v_mfma_f32_32x32x16_bf16 v[240:255], v[20:23], v[20:23], 0
    s_and_b32 s7, s6, 2
    s_lshl_b32 s7, s7, 10
    s_and_b32 s6, s6, 1
    s_lshl_b32 s6, s6, 9
    s_add_u32 s6, s6, s7
    v_mfma_f32_32x32x16_bf16 v[32:47], v[20:23], v[20:23], 0
    s_add_u32 s70, s70, s6
    s_add_u32 s6, s5, 1
    s_lshr_b32 s7, s6, 2
    s_lshl_b32 s7, s7, 18
    s_add_u32 s71, s7, s4
    v_mfma_f32_32x32x16_bf16 v[48:63], v[20:23], v[20:23], 0
    s_and_b32 s7, s6, 2
    s_lshl_b32 s7, s7, 10
    s_and_b32 s6, s6, 1
    s_lshl_b32 s6, s6, 9
    s_add_u32 s6, s6, s7
    v_mfma_f32_32x32x16_bf16 v[64:79], v[20:23], v[20:23], 0
    s_add_u32 s71, s71, s6
    s_add_u32 s6, s5, 2
    s_lshr_b32 s7, s6, 2
    s_lshl_b32 s7, s7, 18
    s_add_u32 s72, s7, s4
    s_and_b32 s7, s6, 2
    s_lshl_b32 s7, s7, 10
    s_and_b32 s6, s6, 1
    s_lshl_b32 s6, s6, 9
    s_add_u32 s6, s6, s7
    s_add_u32 s72, s72, s6
    s_add_u32 s6, s5, 3
    s_lshr_b32 s7, s6, 2
    s_lshl_b32 s7, s7, 18
    s_add_u32 s73, s7, s4
    s_and_b32 s7, s6, 2
    s_lshl_b32 s7, s7, 10
    s_and_b32 s6, s6, 1
    s_lshl_b32 s6, s6, 9
    s_add_u32 s6, s6, s7
    s_add_u32 s73, s73, s6
    s_add_u32 s6, s5, 4
    s_lshr_b32 s7, s6, 2
    s_lshl_b32 s7, s7, 18
    s_add_u32 s76, s7, s4
    s_and_b32 s7, s6, 2
    s_lshl_b32 s7, s7, 10
    s_and_b32 s6, s6, 1
    s_lshl_b32 s6, s6, 9
    s_add_u32 s6, s6, s7
    s_add_u32 s76, s76, s6
    s_add_u32 s6, s5, 5
    s_lshr_b32 s7, s6, 2
    s_lshl_b32 s7, s7, 18
    s_add_u32 s77, s7, s4
    s_and_b32 s7, s6, 2
    s_lshl_b32 s7, s7, 10
    s_and_b32 s6, s6, 1
    s_lshl_b32 s6, s6, 9
    s_add_u32 s6, s6, s7
    s_add_u32 s77, s77, s6
    s_add_u32 s6, s5, 6
    s_lshr_b32 s7, s6, 2
    s_lshl_b32 s7, s7, 18
    s_add_u32 s78, s7, s4
    s_and_b32 s7, s6, 2
    s_lshl_b32 s7, s7, 10
    s_and_b32 s6, s6, 1
    s_lshl_b32 s6, s6, 9
    s_add_u32 s6, s6, s7
    s_add_u32 s78, s78, s6
    s_lshr_b32 s6, s63, 1
    s_lshl_b32 s6, s6, 18
    s_and_b32 s7, s63, 1
    s_lshl_b32 s7, s7, 11
    s_add_u32 s6, s6, s7
    s_add_u32 s6, s6, s4
    s_add_u32 s85, s6, 14680064
    s_lshl_b32 s79, s63, 15
    s_lshl_b32 s6, s62, 10
    s_add_u32 s79, s79, s6
    s_add_u32 s79, s79, 27262976
    s_lshl_b32 s84, s63, 12
    s_add_u32 s84, s84, 29360128
    s_lshl_b32 s92, s64, 12
    s_add_u32 s92, s92, s79
    s_lshl_b32 s93, s64, 9
    s_add_u32 s93, s93, s84
    v_lshrrev_b32 v24, 5, v1
    v_bfe_u32 v25, v1, 2, 2
    v_lshl_add_u32 v24, v24, 3, v25
    v_lshlrev_b32 v24, 6, v24
    v_bfe_u32 v25, v1, 4, 1
    v_lshl_add_u32 v24, v25, 5, v24
    v_and_b32 v25, 3, v1
    v_lshl_add_u32 v24, v25, 3, v24
    v_add_u32 v24, 122880, v24
    s_lshl_b32 s3, s62, 13
    s_add_u32 s3, s3, 124928
    v_add_u32 v25, s3, v7
    s_lshl_b32 s3, s62, 9
    s_add_u32 s3, s3, 157696
    v_lshlrev_b32 v26, 2, v1
    v_add_u32 v27, s3, v26
    s_lshl_b32 s3, s62, 11
    s_add_u32 s3, s3, 124928
    v_add_u32 v28, s3, v7
    v_lshrrev_b32 v29, 5, v1
    v_lshlrev_b32 v30, 3, v29
    v_add_u32 v30, 122880, v30
    v_lshlrev_b32 v29, 8, v29
    v_and_b32 v31, 31, v1
    v_lshl_add_u32 v29, v31, 2, v29
    v_add_u32 v29, 157696, v29
    v_and_b32 v18, 15, v1
    v_lshlrev_b32 v18, 4, v18
    v_bfe_u32 v31, v1, 4, 1
    v_lshl_add_u32 v18, v31, 10, v18
    v_lshrrev_b32 v31, 5, v1
    v_lshl_add_u32 v18, v31, 8, v18
    v_add_u32 v31, 4096, v18
    s_lshl_b32 s83, s69, 7
    s_add_u32 s83, s83, 52428800
    s_waitcnt vmcnt(0)
    v_readlane_b32 s82, v116, 8
    s_barrier
    s_cmp_lg_u32 s62, 0
    s_cbranch_scc1 recurrent_scan__linear_kernel_hedgehog__glu_gated_bilinear__prompt_kernel_nx
    s_add_u32 s82, s82, 1
    v_mov_b32 v120, s82
    s_mov_b64 exec, 1
    buffer_store_dword v120, v7, s[32:35], s83 offen sc1
    s_mov_b64 exec, -1
recurrent_scan__linear_kernel_hedgehog__glu_gated_bilinear__prompt_kernel_nx:
    s_add_u32 m0, s54, 81920
    s_nop 0
    buffer_load_dwordx4 v2, s[12:15], s44 offen lds
    s_add_u32 s44, s44, s49
    s_add_u32 m0, s55, 81920
    s_nop 0
    buffer_load_dwordx4 v3, s[16:19], s45 offen lds
    s_add_u32 s45, s45, s50
    s_add_u32 m0, s56, 81920
    s_nop 0
    buffer_load_dwordx4 v4, s[20:23], s46 offen lds
    s_add_u32 s46, s46, s51
    s_add_u32 m0, s57, 81920
    s_nop 0
    buffer_load_dwordx4 v5, s[24:27], s47 offen lds
    s_add_u32 s47, s47, s52
    s_add_u32 m0, s58, 81920
    s_nop 0
    buffer_load_dwordx4 v6, s[28:31], s48 offen lds
    s_add_u32 s48, s48, s53
    s_add_u32 m0, s54, 102400
    s_nop 0
    buffer_load_dwordx4 v2, s[12:15], s44 offen lds
    s_add_u32 s44, s44, s49
    s_add_u32 m0, s55, 102400
    s_nop 0
    buffer_load_dwordx4 v3, s[16:19], s45 offen lds
    s_add_u32 s45, s45, s50
    s_add_u32 m0, s56, 102400
    s_nop 0
    buffer_load_dwordx4 v4, s[20:23], s46 offen lds
    s_add_u32 s46, s46, s51
    s_add_u32 m0, s57, 102400
    s_nop 0
    buffer_load_dwordx4 v5, s[24:27], s47 offen lds
    s_add_u32 s47, s47, s52
    s_add_u32 m0, s58, 102400
    s_nop 0
    buffer_load_dwordx4 v6, s[28:31], s48 offen lds
    s_add_u32 s48, s48, s53
    s_add_u32 m0, s54, 0
    s_nop 0
    buffer_load_dwordx4 v2, s[12:15], s44 offen lds
    s_add_u32 s44, s44, s49
    s_add_u32 m0, s55, 0
    s_nop 0
    buffer_load_dwordx4 v3, s[16:19], s45 offen lds
    s_add_u32 s45, s45, s50
    v_mfma_f32_32x32x16_bf16 v[80:95], v[20:23], v[20:23], 0
    v_mfma_f32_32x32x16_bf16 v[96:111], v[20:23], v[20:23], 0
    s_mov_b32 s4, 0
recurrent_scan__linear_kernel_hedgehog__glu_gated_bilinear__prompt_kernel_px:
    buffer_load_dword v117, v118, s[32:35], s61 offen sc1
    s_waitcnt vmcnt(0)
    v_cmp_eq_u32 vcc, v117, v116
    s_add_u32 s4, s4, 1
    s_nop 2
    s_and_b32 s5, vcc_lo, 0xff
    s_cbranch_scc0 recurrent_scan__linear_kernel_hedgehog__glu_gated_bilinear__prompt_kernel_px_ok
    s_and_b32 s5, s4, 3
    s_cbranch_scc1 recurrent_scan__linear_kernel_hedgehog__glu_gated_bilinear__prompt_kernel_px
    s_add_u32 s82, s82, 1
    v_mov_b32 v120, s82
    s_mov_b64 exec, 1
    buffer_store_dword v120, v7, s[32:35], s83 offen sc1
    s_mov_b64 exec, -1
    s_cmp_lt_u32 s4, 200000
    s_cbranch_scc1 recurrent_scan__linear_kernel_hedgehog__glu_gated_bilinear__prompt_kernel_px
recurrent_scan__linear_kernel_hedgehog__glu_gated_bilinear__prompt_kernel_px_ok:
    buffer_load_dwordx4 a[160:163], v7, s[8:11], s59 offen offset:0 sc1
    buffer_load_dwordx4 a[164:167], v7, s[8:11], s59 offen offset:1024 sc1
    buffer_load_dwordx4 a[168:171], v7, s[8:11], s59 offen offset:2048 sc1
    buffer_load_dwordx4 a[172:175], v7, s[8:11], s59 offen offset:3072 sc1
    s_add_u32 s59, s59, 0x40000
    buffer_load_dwordx4 a[176:179], v7, s[8:11], s60 offen offset:0 sc1
    buffer_load_dwordx4 a[180:183], v7, s[8:11], s60 offen offset:1024 sc1
    buffer_load_dwordx4 a[184:187], v7, s[8:11], s60 offen offset:2048 sc1
    buffer_load_dwordx4 a[188:191], v7, s[8:11], s60 offen offset:3072 sc1
    s_add_u32 s60, s60, 0x40000
    v_mfma_f32_32x32x16_bf16 v[112:127], v[20:23], v[20:23], 0
    v_mov_b32 v20, -1
    v_mov_b32 v21, -1
    v_mov_b32 v22, -1
    v_mov_b32 v23, -1
    s_add_u32 s69, s66, 37748736
    s_mov_b32 s61, -1
    s_mov_b32 s65, 0
    s_barrier
    ds_read_b64_tr_b16 a[192:193], v11 offset:20480
    ds_read_b64_tr_b16 a[194:195], v11 offset:22016
    ds_read_b64_tr_b16 a[196:197], v11 offset:40960
    ds_read_b64_tr_b16 a[198:199], v11 offset:42496
    ds_read_b64_tr_b16 a[200:201], v13 offset:20512
    ds_read_b64_tr_b16 a[202:203], v13 offset:22048
    ds_read_b64_tr_b16 a[204:205], v13 offset:40992
    ds_read_b64_tr_b16 a[206:207], v13 offset:42528
    ds_read_b64_tr_b16 a[208:209], v11 offset:20544
    ds_read_b64_tr_b16 a[210:211], v11 offset:22080
    ds_read_b64_tr_b16 a[212:213], v11 offset:41024
    ds_read_b64_tr_b16 a[214:215], v11 offset:42560
    s_add_u32 m0, s56, 0
    s_nop 0
    buffer_load_dwordx4 v4, s[20:23], s46 offen lds
    s_add_u32 s46, s46, s51
    s_add_u32 m0, s57, 0
    s_nop 0
    buffer_load_dwordx4 v5, s[24:27], s47 offen lds
    s_add_u32 s47, s47, s52
    s_add_u32 m0, s58, 0
    s_nop 0
    buffer_load_dwordx4 v6, s[28:31], s48 offen lds
    s_add_u32 s48, s48, s53
    s_add_u32 m0, s54, 20480
    s_nop 0
    buffer_load_dwordx4 v2, s[12:15], s44 offen lds
    s_add_u32 s44, s44, s49
    s_add_u32 m0, s55, 20480
    s_nop 0
    buffer_load_dwordx4 v3, s[16:19], s45 offen lds
    s_add_u32 s45, s45, s50
    s_add_u32 m0, s56, 20480
    s_nop 0
    buffer_load_dwordx4 v4, s[20:23], s46 offen lds
    s_add_u32 s46, s46, s51
    s_add_u32 m0, s57, 20480
    s_nop 0
    buffer_load_dwordx4 v5, s[24:27], s47 offen lds
    s_add_u32 s47, s47, s52
    s_add_u32 m0, s58, 20480
    s_nop 0
    buffer_load_dwordx4 v6, s[28:31], s48 offen lds
    s_add_u32 s48, s48, s53
    buffer_load_dword v17, v16, s[40:43], s67 offen
    s_add_u32 s67, s67, s68
    s_waitcnt vmcnt(9)
    s_branch recurrent_scan__linear_kernel_hedgehog__glu_gated_bilinear__prompt_kernel_part2
.p2align 6
recurrent_scan__linear_kernel_hedgehog__glu_gated_bilinear__prompt_kernel_loop:
    s_waitcnt vmcnt(12) lgkmcnt(8)
    v_mfma_f32_16x16x32_bf16 a[0:3], a[192:195], a[96:99], a[0:3]
    ds_read_b64_tr_b16 a[216:217], v12 offset:96
    v_mfma_f32_16x16x32_bf16 a[0:3], a[196:199], a[112:115], a[0:3]
    ds_read_b64_tr_b16 a[218:219], v12 offset:1632
    v_mfma_f32_16x16x32_bf16 a[4:7], a[192:195], a[100:103], a[4:7]
    ds_read_b64_tr_b16 a[220:221], v12 offset:20576
    v_mfma_f32_16x16x32_bf16 a[4:7], a[196:199], a[116:119], a[4:7]
    ds_read_b64_tr_b16 a[222:223], v12 offset:22112
    v_mfma_f32_16x16x32_bf16 a[8:11], a[192:195], a[104:107], a[8:11]
    v_mfma_f32_16x16x32_bf16 a[8:11], a[196:199], a[120:123], a[8:11]
    buffer_load_dwordx4 a[128:131], v7, s[8:11], s59 offen offset:0 sc1
    v_mfma_f32_16x16x32_bf16 a[12:15], a[192:195], a[108:111], a[12:15]
    v_mfma_f32_16x16x32_bf16 a[12:15], a[196:199], a[124:127], a[12:15]
    s_waitcnt lgkmcnt(8)
    v_mfma_f32_16x16x32_bf16 a[16:19], a[200:203], a[96:99], a[16:19]
    ds_read_b64_tr_b16 a[192:193], v10 offset:128
    v_mfma_f32_16x16x32_bf16 a[16:19], a[204:207], a[112:115], a[16:19]
    ds_read_b64_tr_b16 a[194:195], v10 offset:1664
    v_mfma_f32_16x16x32_bf16 a[20:23], a[200:203], a[100:103], a[20:23]
    ds_read_b64_tr_b16 a[196:197], v10 offset:20608
    v_mfma_f32_16x16x32_bf16 a[20:23], a[204:207], a[116:119], a[20:23]
    ds_read_b64_tr_b16 a[198:199], v10 offset:22144
    v_mfma_f32_16x16x32_bf16 a[24:27], a[200:203], a[104:107], a[24:27]
    v_mfma_f32_16x16x32_bf16 a[24:27], a[204:207], a[120:123], a[24:27]
    buffer_load_dwordx4 a[132:135], v7, s[8:11], s59 offen offset:1024 sc1
    v_mfma_f32_16x16x32_bf16 a[28:31], a[200:203], a[108:111], a[28:31]
    s_add_u32 s82, s82, 1
    v_mov_b32 v15, s82
    v_mfma_f32_16x16x32_bf16 a[28:31], a[204:207], a[124:127], a[28:31]
    buffer_store_dword v15, off, s[32:35], s83 sc1
    s_waitcnt lgkmcnt(8)
    v_mfma_f32_16x16x32_bf16 a[32:35], a[208:211], a[96:99], a[32:35]
    ds_read_b64_tr_b16 a[200:201], v12 offset:160
    v_mfma_f32_16x16x32_bf16 a[32:35], a[212:215], a[112:115], a[32:35]
    ds_read_b64_tr_b16 a[202:203], v12 offset:1696
    v_mfma_f32_16x16x32_bf16 a[36:39], a[208:211], a[100:103], a[36:39]
    ds_read_b64_tr_b16 a[204:205], v12 offset:20640
    v_mfma_f32_16x16x32_bf16 a[36:39], a[212:215], a[116:119], a[36:39]
    ds_read_b64_tr_b16 a[206:207], v12 offset:22176
    v_mfma_f32_16x16x32_bf16 a[40:43], a[208:211], a[104:107], a[40:43]
    v_mfma_f32_16x16x32_bf16 a[40:43], a[212:215], a[120:123], a[40:43]
    buffer_load_dwordx4 a[136:139], v7, s[8:11], s59 offen offset:2048 sc1
    v_mfma_f32_16x16x32_bf16 a[44:47], a[208:211], a[108:111], a[44:47]
    v_mfma_f32_16x16x32_bf16 a[44:47], a[212:215], a[124:127], a[44:47]
    s_waitcnt lgkmcnt(8)
    v_mfma_f32_16x16x32_bf16 a[48:51], a[216:219], a[96:99], a[48:51]
    ds_read_b64_tr_b16 a[208:209], v8 offset:6144
    v_mfma_f32_16x16x32_bf16 a[48:51], a[220:223], a[112:115], a[48:51]
    ds_read_b64_tr_b16 a[210:211], v8 offset:7936
    v_mfma_f32_16x16x32_bf16 a[52:55], a[216:219], a[100:103], a[52:55]
    ds_read_b64_tr_b16 a[212:213], v8 offset:26624
    v_mfma_f32_16x16x32_bf16 a[52:55], a[220:223], a[116:119], a[52:55]
    ds_read_b64_tr_b16 a[214:215], v8 offset:28416
    v_mfma_f32_16x16x32_bf16 a[56:59], a[216:219], a[104:107], a[56:59]
    v_mfma_f32_16x16x32_bf16 a[56:59], a[220:223], a[120:123], a[56:59]
    buffer_load_dwordx4 a[140:143], v7, s[8:11], s59 offen offset:3072 sc1
    s_add_u32 s59, s59, 0x40000
    v_mfma_f32_16x16x32_bf16 a[60:63], a[216:219], a[108:111], a[60:63]
    v_mfma_f32_16x16x32_bf16 a[60:63], a[220:223], a[124:127], a[60:63]
    s_waitcnt lgkmcnt(8)
    v_mfma_f32_16x16x32_bf16 a[64:67], a[96:99], a[192:195], a[64:67]
    ds_read_b64_tr_b16 a[216:217], v8 offset:6176
    v_mfma_f32_16x16x32_bf16 a[64:67], a[112:115], a[196:199], a[64:67]
    ds_read_b64_tr_b16 a[218:219], v8 offset:7968
    v_mfma_f32_16x16x32_bf16 a[68:71], a[100:103], a[192:195], a[68:71]
    ds_read_b64_tr_b16 a[220:221], v8 offset:26656
    v_mfma_f32_16x16x32_bf16 a[68:71], a[116:119], a[196:199], a[68:71]
    ds_read_b64_tr_b16 a[222:223], v8 offset:28448
    v_mfma_f32_16x16x32_bf16 a[72:75], a[104:107], a[192:195], a[72:75]
    v_mfma_f32_16x16x32_bf16 a[72:75], a[120:123], a[196:199], a[72:75]
    buffer_load_dwordx4 a[144:147], v7, s[8:11], s60 offen offset:0 sc1
    v_mfma_f32_16x16x32_bf16 a[76:79], a[108:111], a[192:195], a[76:79]
    s_mov_b32 m0, s95
    v_mfma_f32_16x16x32_bf16 a[76:79], a[124:127], a[196:199], a[76:79]
    buffer_load_dwordx4 v7, s[88:91], s94 offen lds
    s_waitcnt lgkmcnt(8)
    v_mfma_f32_16x16x32_bf16 a[80:83], a[96:99], a[200:203], a[80:83]
    ds_read_b64_tr_b16 a[192:193], v8 offset:6208
    v_mfma_f32_16x16x32_bf16 a[80:83], a[112:115], a[204:207], a[80:83]
    ds_read_b64_tr_b16 a[194:195], v8 offset:8000
    v_mfma_f32_16x16x32_bf16 a[84:87], a[100:103], a[200:203], a[84:87]
    ds_read_b64_tr_b16 a[196:197], v8 offset:26688
    v_mfma_f32_16x16x32_bf16 a[84:87], a[116:119], a[204:207], a[84:87]
    ds_read_b64_tr_b16 a[198:199], v8 offset:28480
    v_mfma_f32_16x16x32_bf16 a[88:91], a[104:107], a[200:203], a[88:91]
    v_mfma_f32_16x16x32_bf16 a[88:91], a[120:123], a[204:207], a[88:91]
    buffer_load_dwordx4 a[148:151], v7, s[8:11], s60 offen offset:1024 sc1
    v_mfma_f32_16x16x32_bf16 a[92:95], a[108:111], a[200:203], a[92:95]
    v_mfma_f32_16x16x32_bf16 a[92:95], a[124:127], a[204:207], a[92:95]
    s_waitcnt lgkmcnt(8)
    v_mfma_f32_16x16x32_bf16 v[32:35], a[208:211], a[96:99], v[32:35]
    ds_read_b64_tr_b16 a[200:201], v8 offset:6240
    v_mfma_f32_16x16x32_bf16 v[32:35], a[212:215], a[112:115], v[32:35]
    ds_read_b64_tr_b16 a[202:203], v8 offset:8032
    v_mfma_f32_16x16x32_bf16 v[36:39], a[208:211], a[100:103], v[36:39]
    ds_read_b64_tr_b16 a[204:205], v8 offset:26720
    v_mfma_f32_16x16x32_bf16 v[36:39], a[212:215], a[116:119], v[36:39]
    ds_read_b64_tr_b16 a[206:207], v8 offset:28512
    v_mfma_f32_16x16x32_bf16 v[48:51], a[208:211], a[104:107], v[48:51]
    v_mfma_f32_16x16x32_bf16 v[48:51], a[212:215], a[120:123], v[48:51]
    buffer_load_dwordx4 a[152:155], v7, s[8:11], s60 offen offset:2048 sc1
    v_mfma_f32_16x16x32_bf16 v[52:55], a[208:211], a[108:111], v[52:55]
    v_mfma_f32_16x16x32_bf16 v[52:55], a[212:215], a[124:127], v[52:55]
    s_waitcnt lgkmcnt(8)
    v_mfma_f32_16x16x32_bf16 v[64:67], a[216:219], a[96:99], v[64:67]
    ds_read_b64_tr_b16 a[208:209], v8 offset:6272
    v_mfma_f32_16x16x32_bf16 v[64:67], a[220:223], a[112:115], v[64:67]
    ds_read_b64_tr_b16 a[210:211], v8 offset:8064
    v_mfma_f32_16x16x32_bf16 v[68:71], a[216:219], a[100:103], v[68:71]
    ds_read_b64_tr_b16 a[212:213], v8 offset:26752
    v_mfma_f32_16x16x32_bf16 v[68:71], a[220:223], a[116:119], v[68:71]
    ds_read_b64_tr_b16 a[214:215], v8 offset:28544
    v_mfma_f32_16x16x32_bf16 v[80:83], a[216:219], a[104:107], v[80:83]
    v_mfma_f32_16x16x32_bf16 v[80:83], a[220:223], a[120:123], v[80:83]
    buffer_load_dwordx4 a[156:159], v7, s[8:11], s60 offen offset:3072 sc1
    s_add_u32 s60, s60, 0x40000
    v_mfma_f32_16x16x32_bf16 v[84:87], a[216:219], a[108:111], v[84:87]
    v_mfma_f32_16x16x32_bf16 v[84:87], a[220:223], a[124:127], v[84:87]
    s_waitcnt lgkmcnt(8)
    v_mfma_f32_16x16x32_bf16 v[96:99], a[192:195], a[96:99], v[96:99]
    ds_read_b64_tr_b16 a[216:217], v8 offset:6304
    v_mfma_f32_16x16x32_bf16 v[96:99], a[196:199], a[112:115], v[96:99]
    ds_read_b64_tr_b16 a[218:219], v8 offset:8096
    v_mfma_f32_16x16x32_bf16 v[100:103], a[192:195], a[100:103], v[100:103]
    ds_read_b64_tr_b16 a[220:221], v8 offset:26784
    v_mfma_f32_16x16x32_bf16 v[100:103], a[196:199], a[116:119], v[100:103]
    ds_read_b64_tr_b16 a[222:223], v8 offset:28576
    v_mfma_f32_16x16x32_bf16 v[112:115], a[192:195], a[104:107], v[112:115]
    s_add_u32 m0, s54, 81920
    v_mfma_f32_16x16x32_bf16 v[112:115], a[196:199], a[120:123], v[112:115]
    buffer_load_dwordx4 v2, s[12:15], s44 offen lds
    v_mfma_f32_16x16x32_bf16 v[116:119], a[192:195], a[108:111], v[116:119]
    s_add_u32 s44, s44, s49
    v_mfma_f32_16x16x32_bf16 v[116:119], a[196:199], a[124:127], v[116:119]
    s_waitcnt lgkmcnt(8)
    v_mfma_f32_16x16x32_bf16 v[128:131], a[200:203], a[96:99], v[128:131]
    ds_read_b64_tr_b16 a[192:193], v8 offset:6336
    v_mfma_f32_16x16x32_bf16 v[128:131], a[204:207], a[112:115], v[128:131]
    ds_read_b64_tr_b16 a[194:195], v8 offset:8128
    v_mfma_f32_16x16x32_bf16 v[132:135], a[200:203], a[100:103], v[132:135]
    ds_read_b64_tr_b16 a[196:197], v8 offset:26816
    v_mfma_f32_16x16x32_bf16 v[132:135], a[204:207], a[116:119], v[132:135]
    ds_read_b64_tr_b16 a[198:199], v8 offset:28608
    v_mfma_f32_16x16x32_bf16 v[144:147], a[200:203], a[104:107], v[144:147]
    s_add_u32 m0, s55, 81920
    v_mfma_f32_16x16x32_bf16 v[144:147], a[204:207], a[120:123], v[144:147]
    buffer_load_dwordx4 v3, s[16:19], s45 offen lds
    v_mfma_f32_16x16x32_bf16 v[148:151], a[200:203], a[108:111], v[148:151]
    s_add_u32 s45, s45, s50
    v_mfma_f32_16x16x32_bf16 v[148:151], a[204:207], a[124:127], v[148:151]
    s_waitcnt lgkmcnt(8)
    v_mfma_f32_16x16x32_bf16 v[160:163], a[208:211], a[96:99], v[160:163]
    ds_read_b64_tr_b16 a[200:201], v8 offset:13312
    v_mfma_f32_16x16x32_bf16 v[160:163], a[212:215], a[112:115], v[160:163]
    ds_read_b64_tr_b16 a[202:203], v8 offset:15104
    v_mfma_f32_16x16x32_bf16 v[164:167], a[208:211], a[100:103], v[164:167]
    ds_read_b64_tr_b16 a[204:205], v8 offset:33792
    v_mfma_f32_16x16x32_bf16 v[164:167], a[212:215], a[116:119], v[164:167]
    ds_read_b64_tr_b16 a[206:207], v8 offset:35584
    v_mfma_f32_16x16x32_bf16 v[176:179], a[208:211], a[104:107], v[176:179]
    s_add_u32 m0, s56, 81920
    v_mfma_f32_16x16x32_bf16 v[176:179], a[212:215], a[120:123], v[176:179]
    buffer_load_dwordx4 v4, s[20:23], s46 offen lds
    v_mfma_f32_16x16x32_bf16 v[180:183], a[208:211], a[108:111], v[180:183]
    s_add_u32 s46, s46, s51
    v_mfma_f32_16x16x32_bf16 v[180:183], a[212:215], a[124:127], v[180:183]
    s_waitcnt lgkmcnt(8)
    v_mfma_f32_16x16x32_bf16 v[192:195], a[216:219], a[96:99], v[192:195]
    ds_read_b64_tr_b16 a[208:209], v8 offset:13344
    v_mfma_f32_16x16x32_bf16 v[192:195], a[220:223], a[112:115], v[192:195]
    ds_read_b64_tr_b16 a[210:211], v8 offset:15136
    v_mfma_f32_16x16x32_bf16 v[196:199], a[216:219], a[100:103], v[196:199]
    ds_read_b64_tr_b16 a[212:213], v8 offset:33824
    v_mfma_f32_16x16x32_bf16 v[196:199], a[220:223], a[116:119], v[196:199]
    ds_read_b64_tr_b16 a[214:215], v8 offset:35616
    v_mfma_f32_16x16x32_bf16 v[208:211], a[216:219], a[104:107], v[208:211]
    s_add_u32 m0, s57, 81920
    v_mfma_f32_16x16x32_bf16 v[208:211], a[220:223], a[120:123], v[208:211]
    buffer_load_dwordx4 v5, s[24:27], s47 offen lds
    v_mfma_f32_16x16x32_bf16 v[212:215], a[216:219], a[108:111], v[212:215]
    s_add_u32 s47, s47, s52
    v_mfma_f32_16x16x32_bf16 v[212:215], a[220:223], a[124:127], v[212:215]
    s_waitcnt lgkmcnt(8)
    v_mfma_f32_16x16x32_bf16 v[224:227], a[192:195], a[96:99], v[224:227]
    ds_read_b64_tr_b16 a[216:217], v8 offset:13376
    v_mfma_f32_16x16x32_bf16 v[224:227], a[196:199], a[112:115], v[224:227]
    ds_read_b64_tr_b16 a[218:219], v8 offset:15168
    v_mfma_f32_16x16x32_bf16 v[228:231], a[192:195], a[100:103], v[228:231]
    ds_read_b64_tr_b16 a[220:221], v8 offset:33856
    v_mfma_f32_16x16x32_bf16 v[228:231], a[196:199], a[116:119], v[228:231]
    ds_read_b64_tr_b16 a[222:223], v8 offset:35648
    v_mfma_f32_16x16x32_bf16 v[240:243], a[192:195], a[104:107], v[240:243]
    s_add_u32 m0, s58, 81920
    v_mfma_f32_16x16x32_bf16 v[240:243], a[196:199], a[120:123], v[240:243]
    buffer_load_dwordx4 v6, s[28:31], s48 offen lds
    v_mfma_f32_16x16x32_bf16 v[244:247], a[192:195], a[108:111], v[244:247]
    s_add_u32 s48, s48, s53
    v_mfma_f32_16x16x32_bf16 v[244:247], a[196:199], a[124:127], v[244:247]
    s_waitcnt lgkmcnt(8)
    v_mfma_f32_16x16x32_bf16 v[40:43], a[200:203], a[96:99], v[40:43]
    ds_read_b64_tr_b16 a[192:193], v8 offset:13408
    v_mfma_f32_16x16x32_bf16 v[40:43], a[204:207], a[112:115], v[40:43]
    ds_read_b64_tr_b16 a[194:195], v8 offset:15200
    v_mfma_f32_16x16x32_bf16 v[44:47], a[200:203], a[100:103], v[44:47]
    ds_read_b64_tr_b16 a[196:197], v8 offset:33888
    v_mfma_f32_16x16x32_bf16 v[44:47], a[204:207], a[116:119], v[44:47]
    ds_read_b64_tr_b16 a[198:199], v8 offset:35680
    v_mfma_f32_16x16x32_bf16 v[56:59], a[200:203], a[104:107], v[56:59]
    s_add_u32 m0, s54, 102400
    v_mfma_f32_16x16x32_bf16 v[56:59], a[204:207], a[120:123], v[56:59]
    buffer_load_dwordx4 v2, s[12:15], s44 offen lds
    v_mfma_f32_16x16x32_bf16 v[60:63], a[200:203], a[108:111], v[60:63]
    s_add_u32 s44, s44, s49
    v_mfma_f32_16x16x32_bf16 v[60:63], a[204:207], a[124:127], v[60:63]
    s_waitcnt lgkmcnt(8)
    v_mfma_f32_16x16x32_bf16 v[72:75], a[208:211], a[96:99], v[72:75]
    ds_read_b64_tr_b16 a[200:201], v8 offset:13440
    v_mfma_f32_16x16x32_bf16 v[72:75], a[212:215], a[112:115], v[72:75]
    ds_read_b64_tr_b16 a[202:203], v8 offset:15232
    v_mfma_f32_16x16x32_bf16 v[76:79], a[208:211], a[100:103], v[76:79]
    ds_read_b64_tr_b16 a[204:205], v8 offset:33920
    v_mfma_f32_16x16x32_bf16 v[76:79], a[212:215], a[116:119], v[76:79]
    ds_read_b64_tr_b16 a[206:207], v8 offset:35712
    v_mfma_f32_16x16x32_bf16 v[88:91], a[208:211], a[104:107], v[88:91]
    s_add_u32 m0, s55, 102400
    v_mfma_f32_16x16x32_bf16 v[88:91], a[212:215], a[120:123], v[88:91]
    buffer_load_dwordx4 v3, s[16:19], s45 offen lds
    v_mfma_f32_16x16x32_bf16 v[92:95], a[208:211], a[108:111], v[92:95]
    s_add_u32 s45, s45, s50
    v_mfma_f32_16x16x32_bf16 v[92:95], a[212:215], a[124:127], v[92:95]
    s_waitcnt lgkmcnt(8)
    v_mfma_f32_16x16x32_bf16 v[104:107], a[216:219], a[96:99], v[104:107]
    ds_read_b64_tr_b16 a[208:209], v8 offset:13472
    v_mfma_f32_16x16x32_bf16 v[104:107], a[220:223], a[112:115], v[104:107]
    ds_read_b64_tr_b16 a[210:211], v8 offset:15264
    v_mfma_f32_16x16x32_bf16 v[108:111], a[216:219], a[100:103], v[108:111]
    ds_read_b64_tr_b16 a[212:213], v8 offset:33952
    v_mfma_f32_16x16x32_bf16 v[108:111], a[220:223], a[116:119], v[108:111]
    ds_read_b64_tr_b16 a[214:215], v8 offset:35744
    v_mfma_f32_16x16x32_bf16 v[120:123], a[216:219], a[104:107], v[120:123]
    s_add_u32 m0, s56, 102400
    v_mfma_f32_16x16x32_bf16 v[120:123], a[220:223], a[120:123], v[120:123]
    buffer_load_dwordx4 v4, s[20:23], s46 offen lds
    v_mfma_f32_16x16x32_bf16 v[124:127], a[216:219], a[108:111], v[124:127]
    s_add_u32 s46, s46, s51
    v_mfma_f32_16x16x32_bf16 v[124:127], a[220:223], a[124:127], v[124:127]
    s_waitcnt lgkmcnt(8)
    v_mfma_f32_16x16x32_bf16 v[136:139], a[192:195], a[96:99], v[136:139]
    ds_read_b64_tr_b16 a[216:217], v8 offset:13504
    v_mfma_f32_16x16x32_bf16 v[136:139], a[196:199], a[112:115], v[136:139]
    ds_read_b64_tr_b16 a[218:219], v8 offset:15296
    v_mfma_f32_16x16x32_bf16 v[140:143], a[192:195], a[100:103], v[140:143]
    ds_read_b64_tr_b16 a[220:221], v8 offset:33984
    v_mfma_f32_16x16x32_bf16 v[140:143], a[196:199], a[116:119], v[140:143]
    ds_read_b64_tr_b16 a[222:223], v8 offset:35776
    v_mfma_f32_16x16x32_bf16 v[152:155], a[192:195], a[104:107], v[152:155]
    s_add_u32 m0, s57, 102400
    v_mfma_f32_16x16x32_bf16 v[152:155], a[196:199], a[120:123], v[152:155]
    buffer_load_dwordx4 v5, s[24:27], s47 offen lds
    v_mfma_f32_16x16x32_bf16 v[156:159], a[192:195], a[108:111], v[156:159]
    s_add_u32 s47, s47, s52
    v_mfma_f32_16x16x32_bf16 v[156:159], a[196:199], a[124:127], v[156:159]
    s_waitcnt lgkmcnt(8)
    v_mfma_f32_16x16x32_bf16 v[168:171], a[200:203], a[96:99], v[168:171]
    s_add_u32 m0, s58, 102400
    v_mfma_f32_16x16x32_bf16 v[168:171], a[204:207], a[112:115], v[168:171]
    buffer_load_dwordx4 v6, s[28:31], s48 offen lds
    v_mfma_f32_16x16x32_bf16 v[172:175], a[200:203], a[100:103], v[172:175]
    s_add_u32 s48, s48, s53
    v_mfma_f32_16x16x32_bf16 v[172:175], a[204:207], a[116:119], v[172:175]
    s_waitcnt vmcnt(22) lgkmcnt(0)
    s_barrier
    v_mfma_f32_16x16x32_bf16 v[184:187], a[200:203], a[104:107], v[184:187]
    ds_read_b64_tr_b16 a[192:193], v10 offset:40960
    v_mfma_f32_16x16x32_bf16 v[184:187], a[204:207], a[120:123], v[184:187]
    ds_read_b64_tr_b16 a[194:195], v10 offset:42496
    v_mfma_f32_16x16x32_bf16 v[188:191], a[200:203], a[108:111], v[188:191]
    ds_read_b64_tr_b16 a[196:197], v11 offset:0
    v_mfma_f32_16x16x32_bf16 v[188:191], a[204:207], a[124:127], v[188:191]
    ds_read_b64_tr_b16 a[198:199], v11 offset:1536
    v_mfma_f32_16x16x32_bf16 v[200:203], a[208:211], a[96:99], v[200:203]
    ds_read_b64_tr_b16 a[200:201], v12 offset:40992
    v_mfma_f32_16x16x32_bf16 v[200:203], a[212:215], a[112:115], v[200:203]
    ds_read_b64_tr_b16 a[202:203], v12 offset:42528
    v_mfma_f32_16x16x32_bf16 v[204:207], a[208:211], a[100:103], v[204:207]
    ds_read_b64_tr_b16 a[204:205], v13 offset:32
    v_mfma_f32_16x16x32_bf16 v[204:207], a[212:215], a[116:119], v[204:207]
    ds_read_b64_tr_b16 a[206:207], v13 offset:1568
    v_mfma_f32_16x16x32_bf16 v[216:219], a[208:211], a[104:107], v[216:219]
    v_mfma_f32_16x16x32_bf16 v[216:219], a[212:215], a[120:123], v[216:219]
    buffer_load_dword v17, v16, s[40:43], s67 offen
    s_add_u32 s67, s67, s68
    v_mfma_f32_16x16x32_bf16 v[220:223], a[208:211], a[108:111], v[220:223]
    v_mfma_f32_16x16x32_bf16 v[220:223], a[212:215], a[124:127], v[220:223]
    s_waitcnt lgkmcnt(8)
    v_mfma_f32_16x16x32_bf16 v[232:235], a[216:219], a[96:99], v[232:235]
    ds_read_b64_tr_b16 a[208:209], v10 offset:41024
    v_mfma_f32_16x16x32_bf16 v[232:235], a[220:223], a[112:115], v[232:235]
    ds_read_b64_tr_b16 a[210:211], v10 offset:42560
    v_mfma_f32_16x16x32_bf16 v[236:239], a[216:219], a[100:103], v[236:239]
    ds_read_b64_tr_b16 a[212:213], v11 offset:64
    v_mfma_f32_16x16x32_bf16 v[236:239], a[220:223], a[116:119], v[236:239]
    ds_read_b64_tr_b16 a[214:215], v11 offset:1600
    v_mfma_f32_16x16x32_bf16 v[248:251], a[216:219], a[104:107], v[248:251]
    s_sub_u32 s4, s65, 2
    s_cmp_lt_u32 s4, 12
    s_cselect_b32 s4, s69, 52461568
    v_mfma_f32_16x16x32_bf16 v[248:251], a[220:223], a[120:123], v[248:251]
    buffer_store_dwordx4 v[20:23], v7, s[32:35], s4 offen sc1
    s_add_u32 s69, s69, 0x100000
    v_mfma_f32_16x16x32_bf16 v[252:255], a[216:219], a[108:111], v[252:255]
    s_add_u32 s65, s65, 1
    v_mfma_f32_16x16x32_bf16 v[252:255], a[220:223], a[124:127], v[252:255]
    s_cmp_lg_u32 s61, 4
    s_cbranch_scc1 recurrent_scan__linear_kernel_hedgehog__glu_gated_bilinear__prompt_kernel_nlf
    s_bfe_u32 s4, s2, 0x20001
    s_mul_i32 s4, s4, 1835008
    s_add_u32 s5, s4, 524288
    s_lshr_b32 s6, s2, 5
    s_lshl_b32 s6, s6, 8
    s_add_u32 s4, s4, s6
    v_lshrrev_b32 v20, 4, v1
    v_lshlrev_b32 v21, 1, v20
    v_and_b32 v22, 15, v1
    v_xor_b32 v21, v21, v22
    v_lshlrev_b32 v20, 11, v20
    v_lshl_add_u32 v20, v21, 4, v20
    s_mov_b32 s12, s80
    s_mov_b32 s13, s81
    s_mov_b32 s14, s5
    s_lshl_b32 s6, s54, 3
    s_add_u32 s44, s6, s4
    s_mov_b32 s49, 163840
    s_bfe_u32 s6, s54, 0x1000b
    s_lshl_b32 s6, s6, 7
    v_xor_b32 v2, s6, v20
    s_mov_b32 s16, s80
    s_mov_b32 s17, s81
    s_mov_b32 s18, s5
    s_lshl_b32 s6, s55, 3
    s_add_u32 s45, s6, s4
    s_mov_b32 s50, 163840
    s_bfe_u32 s6, s55, 0x1000b
    s_lshl_b32 s6, s6, 7
    v_xor_b32 v3, s6, v20
    s_mov_b32 s20, s80
    s_mov_b32 s21, s81
    s_mov_b32 s22, s5
    s_lshl_b32 s6, s56, 3
    s_add_u32 s46, s6, s4
    s_mov_b32 s51, 163840
    s_bfe_u32 s6, s56, 0x1000b
    s_lshl_b32 s6, s6, 7
    v_xor_b32 v4, s6, v20
    s_mov_b32 s24, s80
    s_mov_b32 s25, s81
    s_mov_b32 s26, s5
    s_lshl_b32 s6, s57, 3
    s_add_u32 s47, s6, s4
    s_mov_b32 s52, 163840
    s_bfe_u32 s6, s57, 0x1000b
    s_lshl_b32 s6, s6, 7
    v_xor_b32 v5, s6, v20
    s_mov_b32 s28, s80
    s_mov_b32 s29, s81
    s_mov_b32 s30, s5
    s_lshl_b32 s6, s58, 3
    s_add_u32 s48, s6, s4
    s_mov_b32 s53, 163840
    s_bfe_u32 s6, s58, 0x1000b
    s_lshl_b32 s6, s6, 7
    v_xor_b32 v6, s6, v20
recurrent_scan__linear_kernel_hedgehog__glu_gated_bilinear__prompt_kernel_nlf:
    s_waitcnt vmcnt(12) lgkmcnt(8)
    v_mfma_f32_16x16x32_bf16 a[0:3], a[192:195], a[128:131], a[0:3]
    ds_read_b64_tr_b16 a[216:217], v12 offset:41056
    v_mfma_f32_16x16x32_bf16 a[0:3], a[196:199], a[144:147], a[0:3]
    ds_read_b64_tr_b16 a[218:219], v12 offset:42592
    v_mfma_f32_16x16x32_bf16 a[4:7], a[192:195], a[132:135], a[4:7]
    ds_read_b64_tr_b16 a[220:221], v13 offset:96
    v_mfma_f32_16x16x32_bf16 a[4:7], a[196:199], a[148:151], a[4:7]
    ds_read_b64_tr_b16 a[222:223], v13 offset:1632
    v_mfma_f32_16x16x32_bf16 a[8:11], a[192:195], a[136:139], a[8:11]
    v_mfma_f32_16x16x32_bf16 a[8:11], a[196:199], a[152:155], a[8:11]
    buffer_load_dwordx4 a[160:163], v7, s[8:11], s59 offen offset:0 sc1
    v_mfma_f32_16x16x32_bf16 a[12:15], a[192:195], a[140:143], a[12:15]
    v_mfma_f32_16x16x32_bf16 a[12:15], a[196:199], a[156:159], a[12:15]
    s_waitcnt lgkmcnt(8)
    v_mfma_f32_16x16x32_bf16 a[16:19], a[200:203], a[128:131], a[16:19]
    ds_read_b64_tr_b16 a[192:193], v10 offset:41088
    v_mfma_f32_16x16x32_bf16 a[16:19], a[204:207], a[144:147], a[16:19]
    ds_read_b64_tr_b16 a[194:195], v10 offset:42624
    v_mfma_f32_16x16x32_bf16 a[20:23], a[200:203], a[132:135], a[20:23]
    ds_read_b64_tr_b16 a[196:197], v11 offset:128
    v_mfma_f32_16x16x32_bf16 a[20:23], a[204:207], a[148:151], a[20:23]
    ds_read_b64_tr_b16 a[198:199], v11 offset:1664
    v_mfma_f32_16x16x32_bf16 a[24:27], a[200:203], a[136:139], a[24:27]
    v_mfma_f32_16x16x32_bf16 a[24:27], a[204:207], a[152:155], a[24:27]
    buffer_load_dwordx4 a[164:167], v7, s[8:11], s59 offen offset:1024 sc1
    v_mfma_f32_16x16x32_bf16 a[28:31], a[200:203], a[140:143], a[28:31]
    v_mfma_f32_16x16x32_bf16 a[28:31], a[204:207], a[156:159], a[28:31]
    buffer_store_dwordx4 v[20:23], v7, s[32:35], s92 offen sc1
    s_mov_b32 s92, 52461568
    s_waitcnt lgkmcnt(8)
    v_mfma_f32_16x16x32_bf16 a[32:35], a[208:211], a[128:131], a[32:35]
    ds_read_b64_tr_b16 a[200:201], v12 offset:41120
    v_mfma_f32_16x16x32_bf16 a[32:35], a[212:215], a[144:147], a[32:35]
    ds_read_b64_tr_b16 a[202:203], v12 offset:42656
    v_mfma_f32_16x16x32_bf16 a[36:39], a[208:211], a[132:135], a[36:39]
    ds_read_b64_tr_b16 a[204:205], v13 offset:160
    v_mfma_f32_16x16x32_bf16 a[36:39], a[212:215], a[148:151], a[36:39]
    ds_read_b64_tr_b16 a[206:207], v13 offset:1696
    v_mfma_f32_16x16x32_bf16 a[40:43], a[208:211], a[136:139], a[40:43]
    v_mfma_f32_16x16x32_bf16 a[40:43], a[212:215], a[152:155], a[40:43]
    buffer_load_dwordx4 a[168:171], v7, s[8:11], s59 offen offset:2048 sc1
    v_mfma_f32_16x16x32_bf16 a[44:47], a[208:211], a[140:143], a[44:47]
    v_mfma_f32_16x16x32_bf16 a[44:47], a[212:215], a[156:159], a[44:47]
    s_waitcnt lgkmcnt(8)
    v_mfma_f32_16x16x32_bf16 a[48:51], a[216:219], a[128:131], a[48:51]
    ds_read_b64_tr_b16 a[208:209], v8 offset:47104
    v_mfma_f32_16x16x32_bf16 a[48:51], a[220:223], a[144:147], a[48:51]
    ds_read_b64_tr_b16 a[210:211], v8 offset:48896
    v_mfma_f32_16x16x32_bf16 a[52:55], a[216:219], a[132:135], a[52:55]
    ds_read_b64_tr_b16 a[212:213], v9 offset:6144
    v_mfma_f32_16x16x32_bf16 a[52:55], a[220:223], a[148:151], a[52:55]
    ds_read_b64_tr_b16 a[214:215], v9 offset:7936
    v_mfma_f32_16x16x32_bf16 a[56:59], a[216:219], a[136:139], a[56:59]
    v_mfma_f32_16x16x32_bf16 a[56:59], a[220:223], a[152:155], a[56:59]
    buffer_load_dwordx4 a[172:175], v7, s[8:11], s59 offen offset:3072 sc1
    s_add_u32 s59, s59, 0x40000
    v_mfma_f32_16x16x32_bf16 a[60:63], a[216:219], a[140:143], a[60:63]
    v_mfma_f32_16x16x32_bf16 a[60:63], a[220:223], a[156:159], a[60:63]
    buffer_store_dword v20, v26, s[32:35], s93 offen sc1
    s_waitcnt lgkmcnt(8)
    v_mfma_f32_16x16x32_bf16 a[64:67], a[128:131], a[192:195], a[64:67]
    ds_read_b64_tr_b16 a[216:217], v8 offset:47136
    v_mfma_f32_16x16x32_bf16 a[64:67], a[144:147], a[196:199], a[64:67]
    ds_read_b64_tr_b16 a[218:219], v8 offset:48928
    v_mfma_f32_16x16x32_bf16 a[68:71], a[132:135], a[192:195], a[68:71]
    ds_read_b64_tr_b16 a[220:221], v9 offset:6176
    v_mfma_f32_16x16x32_bf16 a[68:71], a[148:151], a[196:199], a[68:71]
    ds_read_b64_tr_b16 a[222:223], v9 offset:7968
    v_mfma_f32_16x16x32_bf16 a[72:75], a[136:139], a[192:195], a[72:75]
    v_mfma_f32_16x16x32_bf16 a[72:75], a[152:155], a[196:199], a[72:75]
    buffer_load_dwordx4 a[176:179], v7, s[8:11], s60 offen offset:0 sc1
    v_mfma_f32_16x16x32_bf16 a[76:79], a[140:143], a[192:195], a[76:79]
    v_mfma_f32_16x16x32_bf16 a[76:79], a[156:159], a[196:199], a[76:79]
    s_waitcnt lgkmcnt(8)
    v_mfma_f32_16x16x32_bf16 a[80:83], a[128:131], a[200:203], a[80:83]
    ds_read_b64_tr_b16 a[192:193], v8 offset:47168
    v_mfma_f32_16x16x32_bf16 a[80:83], a[144:147], a[204:207], a[80:83]
    ds_read_b64_tr_b16 a[194:195], v8 offset:48960
    v_mfma_f32_16x16x32_bf16 a[84:87], a[132:135], a[200:203], a[84:87]
    ds_read_b64_tr_b16 a[196:197], v9 offset:6208
    v_mfma_f32_16x16x32_bf16 a[84:87], a[148:151], a[204:207], a[84:87]
    ds_read_b64_tr_b16 a[198:199], v9 offset:8000
    v_mfma_f32_16x16x32_bf16 a[88:91], a[136:139], a[200:203], a[88:91]
    v_mfma_f32_16x16x32_bf16 a[88:91], a[152:155], a[204:207], a[88:91]
    buffer_load_dwordx4 a[180:183], v7, s[8:11], s60 offen offset:1024 sc1
    v_mfma_f32_16x16x32_bf16 a[92:95], a[140:143], a[200:203], a[92:95]
    v_mfma_f32_16x16x32_bf16 a[92:95], a[156:159], a[204:207], a[92:95]
    buffer_store_dword v20, v26, s[32:35], s93 offen offset:256 sc1
    s_mov_b32 s93, 52461568
    s_waitcnt lgkmcnt(8)
    v_mfma_f32_16x16x32_bf16 v[32:35], a[208:211], a[128:131], v[32:35]
    ds_read_b64_tr_b16 a[200:201], v8 offset:47200
    v_mfma_f32_16x16x32_bf16 v[32:35], a[212:215], a[144:147], v[32:35]
    ds_read_b64_tr_b16 a[202:203], v8 offset:48992
    v_mfma_f32_16x16x32_bf16 v[36:39], a[208:211], a[132:135], v[36:39]
    ds_read_b64_tr_b16 a[204:205], v9 offset:6240
    v_mfma_f32_16x16x32_bf16 v[36:39], a[212:215], a[148:151], v[36:39]
    ds_read_b64_tr_b16 a[206:207], v9 offset:8032
    v_mfma_f32_16x16x32_bf16 v[48:51], a[208:211], a[136:139], v[48:51]
    v_mfma_f32_16x16x32_bf16 v[48:51], a[212:215], a[152:155], v[48:51]
    buffer_load_dwordx4 a[184:187], v7, s[8:11], s60 offen offset:2048 sc1
    v_mfma_f32_16x16x32_bf16 v[52:55], a[208:211], a[140:143], v[52:55]
    v_mfma_f32_16x16x32_bf16 v[52:55], a[212:215], a[156:159], v[52:55]
    s_waitcnt lgkmcnt(8)
    v_mfma_f32_16x16x32_bf16 v[64:67], a[216:219], a[128:131], v[64:67]
    ds_read_b64_tr_b16 a[208:209], v8 offset:47232
    v_mfma_f32_16x16x32_bf16 v[64:67], a[220:223], a[144:147], v[64:67]
    ds_read_b64_tr_b16 a[210:211], v8 offset:49024
    v_mfma_f32_16x16x32_bf16 v[68:71], a[216:219], a[132:135], v[68:71]
    ds_read_b64_tr_b16 a[212:213], v9 offset:6272
    v_mfma_f32_16x16x32_bf16 v[68:71], a[220:223], a[148:151], v[68:71]
    ds_read_b64_tr_b16 a[214:215], v9 offset:8064
    v_mfma_f32_16x16x32_bf16 v[80:83], a[216:219], a[136:139], v[80:83]
    v_mfma_f32_16x16x32_bf16 v[80:83], a[220:223], a[152:155], v[80:83]
    buffer_load_dwordx4 a[188:191], v7, s[8:11], s60 offen offset:3072 sc1
    s_add_u32 s60, s60, 0x40000
    v_mfma_f32_16x16x32_bf16 v[84:87], a[216:219], a[140:143], v[84:87]
    v_mfma_f32_16x16x32_bf16 v[84:87], a[220:223], a[156:159], v[84:87]
    s_waitcnt lgkmcnt(8)
    v_mfma_f32_16x16x32_bf16 v[96:99], a[192:195], a[128:131], v[96:99]
    ds_read_b64_tr_b16 a[216:217], v8 offset:47264
    v_mfma_f32_16x16x32_bf16 v[96:99], a[196:199], a[144:147], v[96:99]
    ds_read_b64_tr_b16 a[218:219], v8 offset:49056
    v_mfma_f32_16x16x32_bf16 v[100:103], a[192:195], a[132:135], v[100:103]
    ds_read_b64_tr_b16 a[220:221], v9 offset:6304
    v_mfma_f32_16x16x32_bf16 v[100:103], a[196:199], a[148:151], v[100:103]
    ds_read_b64_tr_b16 a[222:223], v9 offset:8096
    v_mfma_f32_16x16x32_bf16 v[112:115], a[192:195], a[136:139], v[112:115]
    s_add_u32 m0, s54, 0
    v_mfma_f32_16x16x32_bf16 v[112:115], a[196:199], a[152:155], v[112:115]
    buffer_load_dwordx4 v2, s[12:15], s44 offen lds
    v_mfma_f32_16x16x32_bf16 v[116:119], a[192:195], a[140:143], v[116:119]
    s_add_u32 s44, s44, s49
    v_mfma_f32_16x16x32_bf16 v[116:119], a[196:199], a[156:159], v[116:119]
    s_waitcnt lgkmcnt(8)
    v_mfma_f32_16x16x32_bf16 v[128:131], a[200:203], a[128:131], v[128:131]
    ds_read_b64_tr_b16 a[192:193], v8 offset:47296
    v_mfma_f32_16x16x32_bf16 v[128:131], a[204:207], a[144:147], v[128:131]
    ds_read_b64_tr_b16 a[194:195], v8 offset:49088
    v_mfma_f32_16x16x32_bf16 v[132:135], a[200:203], a[132:135], v[132:135]
    ds_read_b64_tr_b16 a[196:197], v9 offset:6336
    v_mfma_f32_16x16x32_bf16 v[132:135], a[204:207], a[148:151], v[132:135]
    ds_read_b64_tr_b16 a[198:199], v9 offset:8128
    v_mfma_f32_16x16x32_bf16 v[144:147], a[200:203], a[136:139], v[144:147]
    s_add_u32 m0, s55, 0
    v_mfma_f32_16x16x32_bf16 v[144:147], a[204:207], a[152:155], v[144:147]
    buffer_load_dwordx4 v3, s[16:19], s45 offen lds
    v_mfma_f32_16x16x32_bf16 v[148:151], a[200:203], a[140:143], v[148:151]
    s_add_u32 s45, s45, s50
    v_mfma_f32_16x16x32_bf16 v[148:151], a[204:207], a[156:159], v[148:151]
    s_waitcnt lgkmcnt(8)
    v_mfma_f32_16x16x32_bf16 v[160:163], a[208:211], a[128:131], v[160:163]
    ds_read_b64_tr_b16 a[200:201], v8 offset:54272
    v_mfma_f32_16x16x32_bf16 v[160:163], a[212:215], a[144:147], v[160:163]
    ds_read_b64_tr_b16 a[202:203], v8 offset:56064
    v_mfma_f32_16x16x32_bf16 v[164:167], a[208:211], a[132:135], v[164:167]
    ds_read_b64_tr_b16 a[204:205], v9 offset:13312
    v_mfma_f32_16x16x32_bf16 v[164:167], a[212:215], a[148:151], v[164:167]
    ds_read_b64_tr_b16 a[206:207], v9 offset:15104
    v_mfma_f32_16x16x32_bf16 v[176:179], a[208:211], a[136:139], v[176:179]
    s_add_u32 m0, s56, 0
    v_mfma_f32_16x16x32_bf16 v[176:179], a[212:215], a[152:155], v[176:179]
    buffer_load_dwordx4 v4, s[20:23], s46 offen lds
    v_mfma_f32_16x16x32_bf16 v[180:183], a[208:211], a[140:143], v[180:183]
    s_add_u32 s46, s46, s51
    v_mfma_f32_16x16x32_bf16 v[180:183], a[212:215], a[156:159], v[180:183]
    s_waitcnt lgkmcnt(8)
    v_mfma_f32_16x16x32_bf16 v[192:195], a[216:219], a[128:131], v[192:195]
    ds_read_b64_tr_b16 a[208:209], v8 offset:54304
    v_mfma_f32_16x16x32_bf16 v[192:195], a[220:223], a[144:147], v[192:195]
    ds_read_b64_tr_b16 a[210:211], v8 offset:56096
    v_mfma_f32_16x16x32_bf16 v[196:199], a[216:219], a[132:135], v[196:199]
    ds_read_b64_tr_b16 a[212:213], v9 offset:13344
    v_mfma_f32_16x16x32_bf16 v[196:199], a[220:223], a[148:151], v[196:199]
    ds_read_b64_tr_b16 a[214:215], v9 offset:15136
    v_mfma_f32_16x16x32_bf16 v[208:211], a[216:219], a[136:139], v[208:211]
    s_add_u32 m0, s57, 0
    v_mfma_f32_16x16x32_bf16 v[208:211], a[220:223], a[152:155], v[208:211]
    buffer_load_dwordx4 v5, s[24:27], s47 offen lds
    v_mfma_f32_16x16x32_bf16 v[212:215], a[216:219], a[140:143], v[212:215]
    s_add_u32 s47, s47, s52
    v_mfma_f32_16x16x32_bf16 v[212:215], a[220:223], a[156:159], v[212:215]
    s_waitcnt lgkmcnt(8)
    v_mfma_f32_16x16x32_bf16 v[224:227], a[192:195], a[128:131], v[224:227]
    ds_read_b64_tr_b16 a[216:217], v8 offset:54336
    v_mfma_f32_16x16x32_bf16 v[224:227], a[196:199], a[144:147], v[224:227]
    ds_read_b64_tr_b16 a[218:219], v8 offset:56128
    v_mfma_f32_16x16x32_bf16 v[228:231], a[192:195], a[132:135], v[228:231]
    ds_read_b64_tr_b16 a[220:221], v9 offset:13376
    v_mfma_f32_16x16x32_bf16 v[228:231], a[196:199], a[148:151], v[228:231]
    ds_read_b64_tr_b16 a[222:223], v9 offset:15168
    v_mfma_f32_16x16x32_bf16 v[240:243], a[192:195], a[136:139], v[240:243]
    s_add_u32 m0, s58, 0
    v_mfma_f32_16x16x32_bf16 v[240:243], a[196:199], a[152:155], v[240:243]
    buffer_load_dwordx4 v6, s[28:31], s48 offen lds
    v_mfma_f32_16x16x32_bf16 v[244:247], a[192:195], a[140:143], v[244:247]
    s_add_u32 s48, s48, s53
    v_mfma_f32_16x16x32_bf16 v[244:247], a[196:199], a[156:159], v[244:247]
    s_waitcnt lgkmcnt(8)
    v_mfma_f32_16x16x32_bf16 v[40:43], a[200:203], a[128:131], v[40:43]
    ds_read_b64_tr_b16 a[192:193], v8 offset:54368
    v_mfma_f32_16x16x32_bf16 v[40:43], a[204:207], a[144:147], v[40:43]
    ds_read_b64_tr_b16 a[194:195], v8 offset:56160
    v_mfma_f32_16x16x32_bf16 v[44:47], a[200:203], a[132:135], v[44:47]
    ds_read_b64_tr_b16 a[196:197], v9 offset:13408
    v_mfma_f32_16x16x32_bf16 v[44:47], a[204:207], a[148:151], v[44:47]
    ds_read_b64_tr_b16 a[198:199], v9 offset:15200
    v_mfma_f32_16x16x32_bf16 v[56:59], a[200:203], a[136:139], v[56:59]
    s_add_u32 m0, s54, 20480
    v_mfma_f32_16x16x32_bf16 v[56:59], a[204:207], a[152:155], v[56:59]
    buffer_load_dwordx4 v2, s[12:15], s44 offen lds
    v_mfma_f32_16x16x32_bf16 v[60:63], a[200:203], a[140:143], v[60:63]
    s_add_u32 s44, s44, s49
    v_mfma_f32_16x16x32_bf16 v[60:63], a[204:207], a[156:159], v[60:63]
    s_waitcnt lgkmcnt(8)
    v_mfma_f32_16x16x32_bf16 v[72:75], a[208:211], a[128:131], v[72:75]
    ds_read_b64_tr_b16 a[200:201], v8 offset:54400
    v_mfma_f32_16x16x32_bf16 v[72:75], a[212:215], a[144:147], v[72:75]
    ds_read_b64_tr_b16 a[202:203], v8 offset:56192
    v_mfma_f32_16x16x32_bf16 v[76:79], a[208:211], a[132:135], v[76:79]
    ds_read_b64_tr_b16 a[204:205], v9 offset:13440
    v_mfma_f32_16x16x32_bf16 v[76:79], a[212:215], a[148:151], v[76:79]
    ds_read_b64_tr_b16 a[206:207], v9 offset:15232
    v_mfma_f32_16x16x32_bf16 v[88:91], a[208:211], a[136:139], v[88:91]
    s_add_u32 m0, s55, 20480
    v_mfma_f32_16x16x32_bf16 v[88:91], a[212:215], a[152:155], v[88:91]
    buffer_load_dwordx4 v3, s[16:19], s45 offen lds
    v_mfma_f32_16x16x32_bf16 v[92:95], a[208:211], a[140:143], v[92:95]
    s_add_u32 s45, s45, s50
    v_mfma_f32_16x16x32_bf16 v[92:95], a[212:215], a[156:159], v[92:95]
    s_waitcnt lgkmcnt(8)
    v_mfma_f32_16x16x32_bf16 v[104:107], a[216:219], a[128:131], v[104:107]
    ds_read_b64_tr_b16 a[208:209], v8 offset:54432
    v_mfma_f32_16x16x32_bf16 v[104:107], a[220:223], a[144:147], v[104:107]
    ds_read_b64_tr_b16 a[210:211], v8 offset:56224
    v_mfma_f32_16x16x32_bf16 v[108:111], a[216:219], a[132:135], v[108:111]
    ds_read_b64_tr_b16 a[212:213], v9 offset:13472
    v_mfma_f32_16x16x32_bf16 v[108:111], a[220:223], a[148:151], v[108:111]
    ds_read_b64_tr_b16 a[214:215], v9 offset:15264
    v_mfma_f32_16x16x32_bf16 v[120:123], a[216:219], a[136:139], v[120:123]
    s_add_u32 m0, s56, 20480
    v_mfma_f32_16x16x32_bf16 v[120:123], a[220:223], a[152:155], v[120:123]
    buffer_load_dwordx4 v4, s[20:23], s46 offen lds
    v_mfma_f32_16x16x32_bf16 v[124:127], a[216:219], a[140:143], v[124:127]
    s_add_u32 s46, s46, s51
    v_mfma_f32_16x16x32_bf16 v[124:127], a[220:223], a[156:159], v[124:127]
    s_waitcnt lgkmcnt(8)
    v_mfma_f32_16x16x32_bf16 v[136:139], a[192:195], a[128:131], v[136:139]
    ds_read_b64_tr_b16 a[216:217], v8 offset:54464
    v_mfma_f32_16x16x32_bf16 v[136:139], a[196:199], a[144:147], v[136:139]
    ds_read_b64_tr_b16 a[218:219], v8 offset:56256
    v_mfma_f32_16x16x32_bf16 v[140:143], a[192:195], a[132:135], v[140:143]
    ds_read_b64_tr_b16 a[220:221], v9 offset:13504
    v_mfma_f32_16x16x32_bf16 v[140:143], a[196:199], a[148:151], v[140:143]
    ds_read_b64_tr_b16 a[222:223], v9 offset:15296
    v_mfma_f32_16x16x32_bf16 v[152:155], a[192:195], a[136:139], v[152:155]
    s_add_u32 m0, s57, 20480
    v_mfma_f32_16x16x32_bf16 v[152:155], a[196:199], a[152:155], v[152:155]
    buffer_load_dwordx4 v5, s[24:27], s47 offen lds
    v_mfma_f32_16x16x32_bf16 v[156:159], a[192:195], a[140:143], v[156:159]
    s_add_u32 s47, s47, s52
    v_mfma_f32_16x16x32_bf16 v[156:159], a[196:199], a[156:159], v[156:159]
    s_waitcnt lgkmcnt(8)
    v_mfma_f32_16x16x32_bf16 v[168:171], a[200:203], a[128:131], v[168:171]
    s_add_u32 m0, s58, 20480
    v_mfma_f32_16x16x32_bf16 v[168:171], a[204:207], a[144:147], v[168:171]
    buffer_load_dwordx4 v6, s[28:31], s48 offen lds
    v_mfma_f32_16x16x32_bf16 v[172:175], a[200:203], a[132:135], v[172:175]
    s_add_u32 s48, s48, s53
    v_mfma_f32_16x16x32_bf16 v[172:175], a[204:207], a[148:151], v[172:175]
    s_waitcnt vmcnt(23) lgkmcnt(0)
    s_barrier
    v_mfma_f32_16x16x32_bf16 v[184:187], a[200:203], a[136:139], v[184:187]
    ds_read_b64_tr_b16 a[192:193], v11 offset:20480
    v_mfma_f32_16x16x32_bf16 v[184:187], a[204:207], a[152:155], v[184:187]
    ds_read_b64_tr_b16 a[194:195], v11 offset:22016
    v_mfma_f32_16x16x32_bf16 v[188:191], a[200:203], a[140:143], v[188:191]
    ds_read_b64_tr_b16 a[196:197], v11 offset:40960
    v_mfma_f32_16x16x32_bf16 v[188:191], a[204:207], a[156:159], v[188:191]
    ds_read_b64_tr_b16 a[198:199], v11 offset:42496
    v_mfma_f32_16x16x32_bf16 v[200:203], a[208:211], a[128:131], v[200:203]
    ds_read_b64_tr_b16 a[200:201], v13 offset:20512
    v_mfma_f32_16x16x32_bf16 v[200:203], a[212:215], a[144:147], v[200:203]
    ds_read_b64_tr_b16 a[202:203], v13 offset:22048
    v_mfma_f32_16x16x32_bf16 v[204:207], a[208:211], a[132:135], v[204:207]
    ds_read_b64_tr_b16 a[204:205], v13 offset:40992
    v_mfma_f32_16x16x32_bf16 v[204:207], a[212:215], a[148:151], v[204:207]
    ds_read_b64_tr_b16 a[206:207], v13 offset:42528
    v_mfma_f32_16x16x32_bf16 v[216:219], a[208:211], a[136:139], v[216:219]
    v_mfma_f32_16x16x32_bf16 v[216:219], a[212:215], a[152:155], v[216:219]
    buffer_load_dword v17, v16, s[40:43], s67 offen
    s_add_u32 s67, s67, s68
    v_mfma_f32_16x16x32_bf16 v[220:223], a[208:211], a[140:143], v[220:223]
    v_mfma_f32_16x16x32_bf16 v[220:223], a[212:215], a[156:159], v[220:223]
    s_waitcnt lgkmcnt(8)
    v_mfma_f32_16x16x32_bf16 v[232:235], a[216:219], a[128:131], v[232:235]
    ds_read_b64_tr_b16 a[208:209], v11 offset:20544
    v_mfma_f32_16x16x32_bf16 v[232:235], a[220:223], a[144:147], v[232:235]
    ds_read_b64_tr_b16 a[210:211], v11 offset:22080
    v_mfma_f32_16x16x32_bf16 v[236:239], a[216:219], a[132:135], v[236:239]
    ds_read_b64_tr_b16 a[212:213], v11 offset:41024
    v_mfma_f32_16x16x32_bf16 v[236:239], a[220:223], a[148:151], v[236:239]
    ds_read_b64_tr_b16 a[214:215], v11 offset:42560
    v_mfma_f32_16x16x32_bf16 v[248:251], a[216:219], a[136:139], v[248:251]
    s_sub_u32 s4, s65, 2
    s_cmp_lt_u32 s4, 12
    s_cselect_b32 s4, s69, 52461568
    v_mfma_f32_16x16x32_bf16 v[248:251], a[220:223], a[152:155], v[248:251]
    buffer_store_dwordx4 v[20:23], v7, s[32:35], s4 offen sc1
    s_add_u32 s69, s69, 0x100000
    v_mfma_f32_16x16x32_bf16 v[252:255], a[216:219], a[140:143], v[252:255]
    s_add_u32 s65, s65, 1
    v_mfma_f32_16x16x32_bf16 v[252:255], a[220:223], a[156:159], v[252:255]
recurrent_scan__linear_kernel_hedgehog__glu_gated_bilinear__prompt_kernel_part2:
    s_waitcnt vmcnt(11) lgkmcnt(8)
    v_mfma_f32_16x16x32_bf16 a[0:3], a[192:195], a[160:163], a[0:3]
    ds_read_b64_tr_b16 a[216:217], v13 offset:20576
    v_mfma_f32_16x16x32_bf16 a[0:3], a[196:199], a[176:179], a[0:3]
    ds_read_b64_tr_b16 a[218:219], v13 offset:22112
    v_mfma_f32_16x16x32_bf16 a[4:7], a[192:195], a[164:167], a[4:7]
    ds_read_b64_tr_b16 a[220:221], v13 offset:41056
    v_mfma_f32_16x16x32_bf16 a[4:7], a[196:199], a[180:183], a[4:7]
    ds_read_b64_tr_b16 a[222:223], v13 offset:42592
    v_mfma_f32_16x16x32_bf16 a[8:11], a[192:195], a[168:171], a[8:11]
    v_mfma_f32_16x16x32_bf16 a[8:11], a[196:199], a[184:187], a[8:11]
    buffer_load_dwordx4 a[96:99], v7, s[8:11], s59 offen offset:0 sc1
    v_mfma_f32_16x16x32_bf16 a[12:15], a[192:195], a[172:175], a[12:15]
    v_mfma_f32_16x16x32_bf16 a[12:15], a[196:199], a[188:191], a[12:15]
    s_waitcnt lgkmcnt(8)
    v_mfma_f32_16x16x32_bf16 a[16:19], a[200:203], a[160:163], a[16:19]
    ds_read_b64_tr_b16 a[192:193], v11 offset:20608
    v_mfma_f32_16x16x32_bf16 a[16:19], a[204:207], a[176:179], a[16:19]
    ds_read_b64_tr_b16 a[194:195], v11 offset:22144
    v_mfma_f32_16x16x32_bf16 a[20:23], a[200:203], a[164:167], a[20:23]
    ds_read_b64_tr_b16 a[196:197], v11 offset:41088
    v_mfma_f32_16x16x32_bf16 a[20:23], a[204:207], a[180:183], a[20:23]
    ds_read_b64_tr_b16 a[198:199], v11 offset:42624
    v_mfma_f32_16x16x32_bf16 a[24:27], a[200:203], a[168:171], a[24:27]
    v_mfma_f32_16x16x32_bf16 a[24:27], a[204:207], a[184:187], a[24:27]
    buffer_load_dwordx4 a[100:103], v7, s[8:11], s59 offen offset:1024 sc1
    v_mfma_f32_16x16x32_bf16 a[28:31], a[200:203], a[172:175], a[28:31]
    v_mfma_f32_16x16x32_bf16 a[28:31], a[204:207], a[188:191], a[28:31]
    s_waitcnt lgkmcnt(8)
    v_mfma_f32_16x16x32_bf16 a[32:35], a[208:211], a[160:163], a[32:35]
    ds_read_b64_tr_b16 a[200:201], v13 offset:20640
    v_mfma_f32_16x16x32_bf16 a[32:35], a[212:215], a[176:179], a[32:35]
    ds_read_b64_tr_b16 a[202:203], v13 offset:22176
    v_mfma_f32_16x16x32_bf16 a[36:39], a[208:211], a[164:167], a[36:39]
    ds_read_b64_tr_b16 a[204:205], v13 offset:41120
    v_mfma_f32_16x16x32_bf16 a[36:39], a[212:215], a[180:183], a[36:39]
    ds_read_b64_tr_b16 a[206:207], v13 offset:42656
    v_mfma_f32_16x16x32_bf16 a[40:43], a[208:211], a[168:171], a[40:43]
    v_mfma_f32_16x16x32_bf16 a[40:43], a[212:215], a[184:187], a[40:43]
    buffer_load_dwordx4 a[104:107], v7, s[8:11], s59 offen offset:2048 sc1
    v_mfma_f32_16x16x32_bf16 a[44:47], a[208:211], a[172:175], a[44:47]
    v_mfma_f32_16x16x32_bf16 a[44:47], a[212:215], a[188:191], a[44:47]
    s_waitcnt lgkmcnt(8)
    v_mfma_f32_16x16x32_bf16 a[48:51], a[216:219], a[160:163], a[48:51]
    ds_read_b64_tr_b16 a[208:209], v9 offset:26624
    v_mfma_f32_16x16x32_bf16 a[48:51], a[220:223], a[176:179], a[48:51]
    ds_read_b64_tr_b16 a[210:211], v9 offset:28416
    v_mfma_f32_16x16x32_bf16 a[52:55], a[216:219], a[164:167], a[52:55]
    ds_read_b64_tr_b16 a[212:213], v9 offset:47104
    v_mfma_f32_16x16x32_bf16 a[52:55], a[220:223], a[180:183], a[52:55]
    ds_read_b64_tr_b16 a[214:215], v9 offset:48896
    v_mfma_f32_16x16x32_bf16 a[56:59], a[216:219], a[168:171], a[56:59]
    v_mfma_f32_16x16x32_bf16 a[56:59], a[220:223], a[184:187], a[56:59]
    buffer_load_dwordx4 a[108:111], v7, s[8:11], s59 offen offset:3072 sc1
    s_add_u32 s59, s59, 0x40000
    v_mfma_f32_16x16x32_bf16 a[60:63], a[216:219], a[172:175], a[60:63]
    v_mfma_f32_16x16x32_bf16 a[60:63], a[220:223], a[188:191], a[60:63]
    s_waitcnt lgkmcnt(8)
    v_mfma_f32_16x16x32_bf16 a[64:67], a[160:163], a[192:195], a[64:67]
    ds_read_b64_tr_b16 a[216:217], v9 offset:26656
    v_mfma_f32_16x16x32_bf16 a[64:67], a[176:179], a[196:199], a[64:67]
    ds_read_b64_tr_b16 a[218:219], v9 offset:28448
    v_mfma_f32_16x16x32_bf16 a[68:71], a[164:167], a[192:195], a[68:71]
    ds_read_b64_tr_b16 a[220:221], v9 offset:47136
    v_mfma_f32_16x16x32_bf16 a[68:71], a[180:183], a[196:199], a[68:71]
    ds_read_b64_tr_b16 a[222:223], v9 offset:48928
    v_mfma_f32_16x16x32_bf16 a[72:75], a[168:171], a[192:195], a[72:75]
    v_mfma_f32_16x16x32_bf16 a[72:75], a[184:187], a[196:199], a[72:75]
    buffer_load_dwordx4 a[112:115], v7, s[8:11], s60 offen offset:0 sc1
    v_mfma_f32_16x16x32_bf16 a[76:79], a[172:175], a[192:195], a[76:79]
    v_mfma_f32_16x16x32_bf16 a[76:79], a[188:191], a[196:199], a[76:79]
    s_waitcnt lgkmcnt(8)
    v_mfma_f32_16x16x32_bf16 a[80:83], a[160:163], a[200:203], a[80:83]
    ds_read_b64_tr_b16 a[192:193], v9 offset:26688
    v_mfma_f32_16x16x32_bf16 a[80:83], a[176:179], a[204:207], a[80:83]
    ds_read_b64_tr_b16 a[194:195], v9 offset:28480
    v_mfma_f32_16x16x32_bf16 a[84:87], a[164:167], a[200:203], a[84:87]
    ds_read_b64_tr_b16 a[196:197], v9 offset:47168
    v_mfma_f32_16x16x32_bf16 a[84:87], a[180:183], a[204:207], a[84:87]
    ds_read_b64_tr_b16 a[198:199], v9 offset:48960
    v_mfma_f32_16x16x32_bf16 a[88:91], a[168:171], a[200:203], a[88:91]
    v_mfma_f32_16x16x32_bf16 a[88:91], a[184:187], a[204:207], a[88:91]
    buffer_load_dwordx4 a[116:119], v7, s[8:11], s60 offen offset:1024 sc1
    v_mfma_f32_16x16x32_bf16 a[92:95], a[172:175], a[200:203], a[92:95]
    v_mfma_f32_16x16x32_bf16 a[92:95], a[188:191], a[204:207], a[92:95]
    s_waitcnt lgkmcnt(8)
    v_mfma_f32_16x16x32_bf16 v[32:35], a[208:211], a[160:163], v[32:35]
    ds_read_b64_tr_b16 a[200:201], v9 offset:26720
    v_mfma_f32_16x16x32_bf16 v[32:35], a[212:215], a[176:179], v[32:35]
    ds_read_b64_tr_b16 a[202:203], v9 offset:28512
    v_mfma_f32_16x16x32_bf16 v[36:39], a[208:211], a[164:167], v[36:39]
    ds_read_b64_tr_b16 a[204:205], v9 offset:47200
    v_mfma_f32_16x16x32_bf16 v[36:39], a[212:215], a[180:183], v[36:39]
    ds_read_b64_tr_b16 a[206:207], v9 offset:48992
    v_mfma_f32_16x16x32_bf16 v[48:51], a[208:211], a[168:171], v[48:51]
    v_mfma_f32_16x16x32_bf16 v[48:51], a[212:215], a[184:187], v[48:51]
    buffer_load_dwordx4 a[120:123], v7, s[8:11], s60 offen offset:2048 sc1
    v_mfma_f32_16x16x32_bf16 v[52:55], a[208:211], a[172:175], v[52:55]
    v_mfma_f32_16x16x32_bf16 v[52:55], a[212:215], a[188:191], v[52:55]
    s_waitcnt lgkmcnt(8)
    v_mfma_f32_16x16x32_bf16 v[64:67], a[216:219], a[160:163], v[64:67]
    ds_read_b64_tr_b16 a[208:209], v9 offset:26752
    v_mfma_f32_16x16x32_bf16 v[64:67], a[220:223], a[176:179], v[64:67]
    ds_read_b64_tr_b16 a[210:211], v9 offset:28544
    v_mfma_f32_16x16x32_bf16 v[68:71], a[216:219], a[164:167], v[68:71]
    ds_read_b64_tr_b16 a[212:213], v9 offset:47232
    v_mfma_f32_16x16x32_bf16 v[68:71], a[220:223], a[180:183], v[68:71]
    ds_read_b64_tr_b16 a[214:215], v9 offset:49024
    v_mfma_f32_16x16x32_bf16 v[80:83], a[216:219], a[168:171], v[80:83]
    v_mfma_f32_16x16x32_bf16 v[80:83], a[220:223], a[184:187], v[80:83]
    buffer_load_dwordx4 a[124:127], v7, s[8:11], s60 offen offset:3072 sc1
    s_add_u32 s60, s60, 0x40000
    v_mfma_f32_16x16x32_bf16 v[84:87], a[216:219], a[172:175], v[84:87]
    v_mfma_f32_16x16x32_bf16 v[84:87], a[220:223], a[188:191], v[84:87]
    s_waitcnt lgkmcnt(8)
    v_mfma_f32_16x16x32_bf16 v[96:99], a[192:195], a[160:163], v[96:99]
    ds_read_b64_tr_b16 a[216:217], v9 offset:26784
    v_mfma_f32_16x16x32_bf16 v[96:99], a[196:199], a[176:179], v[96:99]
    ds_read_b64_tr_b16 a[218:219], v9 offset:28576
    v_mfma_f32_16x16x32_bf16 v[100:103], a[192:195], a[164:167], v[100:103]
    ds_read_b64_tr_b16 a[220:221], v9 offset:47264
    v_mfma_f32_16x16x32_bf16 v[100:103], a[196:199], a[180:183], v[100:103]
    ds_read_b64_tr_b16 a[222:223], v9 offset:49056
    v_mfma_f32_16x16x32_bf16 v[112:115], a[192:195], a[168:171], v[112:115]
    s_add_u32 m0, s54, 40960
    v_mfma_f32_16x16x32_bf16 v[112:115], a[196:199], a[184:187], v[112:115]
    buffer_load_dwordx4 v2, s[12:15], s44 offen lds
    v_mfma_f32_16x16x32_bf16 v[116:119], a[192:195], a[172:175], v[116:119]
    s_add_u32 s44, s44, s49
    v_mfma_f32_16x16x32_bf16 v[116:119], a[196:199], a[188:191], v[116:119]
    s_waitcnt lgkmcnt(8)
    v_mfma_f32_16x16x32_bf16 v[128:131], a[200:203], a[160:163], v[128:131]
    ds_read_b64_tr_b16 a[192:193], v9 offset:26816
    v_mfma_f32_16x16x32_bf16 v[128:131], a[204:207], a[176:179], v[128:131]
    ds_read_b64_tr_b16 a[194:195], v9 offset:28608
    v_mfma_f32_16x16x32_bf16 v[132:135], a[200:203], a[164:167], v[132:135]
    ds_read_b64_tr_b16 a[196:197], v9 offset:47296
    v_mfma_f32_16x16x32_bf16 v[132:135], a[204:207], a[180:183], v[132:135]
    ds_read_b64_tr_b16 a[198:199], v9 offset:49088
    v_mfma_f32_16x16x32_bf16 v[144:147], a[200:203], a[168:171], v[144:147]
    s_add_u32 m0, s55, 40960
    v_mfma_f32_16x16x32_bf16 v[144:147], a[204:207], a[184:187], v[144:147]
    buffer_load_dwordx4 v3, s[16:19], s45 offen lds
    v_mfma_f32_16x16x32_bf16 v[148:151], a[200:203], a[172:175], v[148:151]
    s_add_u32 s45, s45, s50
    v_mfma_f32_16x16x32_bf16 v[148:151], a[204:207], a[188:191], v[148:151]
    s_waitcnt lgkmcnt(8)
    v_mfma_f32_16x16x32_bf16 v[160:163], a[208:211], a[160:163], v[160:163]
    ds_read_b64_tr_b16 a[200:201], v9 offset:33792
    v_mfma_f32_16x16x32_bf16 v[160:163], a[212:215], a[176:179], v[160:163]
    ds_read_b64_tr_b16 a[202:203], v9 offset:35584
    v_mfma_f32_16x16x32_bf16 v[164:167], a[208:211], a[164:167], v[164:167]
    ds_read_b64_tr_b16 a[204:205], v9 offset:54272
    v_mfma_f32_16x16x32_bf16 v[164:167], a[212:215], a[180:183], v[164:167]
    ds_read_b64_tr_b16 a[206:207], v9 offset:56064
    v_mfma_f32_16x16x32_bf16 v[176:179], a[208:211], a[168:171], v[176:179]
    s_add_u32 m0, s56, 40960
    v_mfma_f32_16x16x32_bf16 v[176:179], a[212:215], a[184:187], v[176:179]
    buffer_load_dwordx4 v4, s[20:23], s46 offen lds
    v_mfma_f32_16x16x32_bf16 v[180:183], a[208:211], a[172:175], v[180:183]
    s_add_u32 s46, s46, s51
    v_mfma_f32_16x16x32_bf16 v[180:183], a[212:215], a[188:191], v[180:183]
    s_waitcnt lgkmcnt(8)
    v_mfma_f32_16x16x32_bf16 v[192:195], a[216:219], a[160:163], v[192:195]
    ds_read_b64_tr_b16 a[208:209], v9 offset:33824
    v_mfma_f32_16x16x32_bf16 v[192:195], a[220:223], a[176:179], v[192:195]
    ds_read_b64_tr_b16 a[210:211], v9 offset:35616
    v_mfma_f32_16x16x32_bf16 v[196:199], a[216:219], a[164:167], v[196:199]
    ds_read_b64_tr_b16 a[212:213], v9 offset:54304
    v_mfma_f32_16x16x32_bf16 v[196:199], a[220:223], a[180:183], v[196:199]
    ds_read_b64_tr_b16 a[214:215], v9 offset:56096
    v_mfma_f32_16x16x32_bf16 v[208:211], a[216:219], a[168:171], v[208:211]
    s_add_u32 m0, s57, 40960
    v_mfma_f32_16x16x32_bf16 v[208:211], a[220:223], a[184:187], v[208:211]
    buffer_load_dwordx4 v5, s[24:27], s47 offen lds
    v_mfma_f32_16x16x32_bf16 v[212:215], a[216:219], a[172:175], v[212:215]
    s_add_u32 s47, s47, s52
    v_mfma_f32_16x16x32_bf16 v[212:215], a[220:223], a[188:191], v[212:215]
    s_waitcnt lgkmcnt(8)
    v_mfma_f32_16x16x32_bf16 v[224:227], a[192:195], a[160:163], v[224:227]
    ds_read_b64_tr_b16 a[216:217], v9 offset:33856
    v_mfma_f32_16x16x32_bf16 v[224:227], a[196:199], a[176:179], v[224:227]
    ds_read_b64_tr_b16 a[218:219], v9 offset:35648
    v_mfma_f32_16x16x32_bf16 v[228:231], a[192:195], a[164:167], v[228:231]
    ds_read_b64_tr_b16 a[220:221], v9 offset:54336
    v_mfma_f32_16x16x32_bf16 v[228:231], a[196:199], a[180:183], v[228:231]
    ds_read_b64_tr_b16 a[222:223], v9 offset:56128
    v_mfma_f32_16x16x32_bf16 v[240:243], a[192:195], a[168:171], v[240:243]
    s_add_u32 m0, s58, 40960
    v_mfma_f32_16x16x32_bf16 v[240:243], a[196:199], a[184:187], v[240:243]
    buffer_load_dwordx4 v6, s[28:31], s48 offen lds
    v_mfma_f32_16x16x32_bf16 v[244:247], a[192:195], a[172:175], v[244:247]
    s_add_u32 s48, s48, s53
    v_mfma_f32_16x16x32_bf16 v[244:247], a[196:199], a[188:191], v[244:247]
    s_waitcnt lgkmcnt(8)
    v_mfma_f32_16x16x32_bf16 v[40:43], a[200:203], a[160:163], v[40:43]
    ds_read_b64_tr_b16 a[192:193], v9 offset:33888
    v_mfma_f32_16x16x32_bf16 v[40:43], a[204:207], a[176:179], v[40:43]
    ds_read_b64_tr_b16 a[194:195], v9 offset:35680
    v_mfma_f32_16x16x32_bf16 v[44:47], a[200:203], a[164:167], v[44:47]
    ds_read_b64_tr_b16 a[196:197], v9 offset:54368
    v_mfma_f32_16x16x32_bf16 v[44:47], a[204:207], a[180:183], v[44:47]
    ds_read_b64_tr_b16 a[198:199], v9 offset:56160
    v_mfma_f32_16x16x32_bf16 v[56:59], a[200:203], a[168:171], v[56:59]
    s_add_u32 m0, s54, 61440
    v_mfma_f32_16x16x32_bf16 v[56:59], a[204:207], a[184:187], v[56:59]
    buffer_load_dwordx4 v2, s[12:15], s44 offen lds
    v_mfma_f32_16x16x32_bf16 v[60:63], a[200:203], a[172:175], v[60:63]
    s_add_u32 s44, s44, s49
    v_mfma_f32_16x16x32_bf16 v[60:63], a[204:207], a[188:191], v[60:63]
    s_waitcnt lgkmcnt(8)
    v_mfma_f32_16x16x32_bf16 v[72:75], a[208:211], a[160:163], v[72:75]
    ds_read_b64_tr_b16 a[200:201], v9 offset:33920
    v_mfma_f32_16x16x32_bf16 v[72:75], a[212:215], a[176:179], v[72:75]
    ds_read_b64_tr_b16 a[202:203], v9 offset:35712
    v_mfma_f32_16x16x32_bf16 v[76:79], a[208:211], a[164:167], v[76:79]
    ds_read_b64_tr_b16 a[204:205], v9 offset:54400
    v_mfma_f32_16x16x32_bf16 v[76:79], a[212:215], a[180:183], v[76:79]
    ds_read_b64_tr_b16 a[206:207], v9 offset:56192
    v_mfma_f32_16x16x32_bf16 v[88:91], a[208:211], a[168:171], v[88:91]
    s_add_u32 m0, s55, 61440
    v_mfma_f32_16x16x32_bf16 v[88:91], a[212:215], a[184:187], v[88:91]
    buffer_load_dwordx4 v3, s[16:19], s45 offen lds
    v_mfma_f32_16x16x32_bf16 v[92:95], a[208:211], a[172:175], v[92:95]
    s_add_u32 s45, s45, s50
    v_mfma_f32_16x16x32_bf16 v[92:95], a[212:215], a[188:191], v[92:95]
    s_waitcnt lgkmcnt(8)
    v_mfma_f32_16x16x32_bf16 v[104:107], a[216:219], a[160:163], v[104:107]
    ds_read_b64_tr_b16 a[208:209], v9 offset:33952
    v_mfma_f32_16x16x32_bf16 v[104:107], a[220:223], a[176:179], v[104:107]
    ds_read_b64_tr_b16 a[210:211], v9 offset:35744
    v_mfma_f32_16x16x32_bf16 v[108:111], a[216:219], a[164:167], v[108:111]
    ds_read_b64_tr_b16 a[212:213], v9 offset:54432
    v_mfma_f32_16x16x32_bf16 v[108:111], a[220:223], a[180:183], v[108:111]
    ds_read_b64_tr_b16 a[214:215], v9 offset:56224
    v_mfma_f32_16x16x32_bf16 v[120:123], a[216:219], a[168:171], v[120:123]
    s_add_u32 m0, s56, 61440
    v_mfma_f32_16x16x32_bf16 v[120:123], a[220:223], a[184:187], v[120:123]
    buffer_load_dwordx4 v4, s[20:23], s46 offen lds
    v_mfma_f32_16x16x32_bf16 v[124:127], a[216:219], a[172:175], v[124:127]
    s_add_u32 s46, s46, s51
    v_mfma_f32_16x16x32_bf16 v[124:127], a[220:223], a[188:191], v[124:127]
    s_waitcnt lgkmcnt(8)
    v_mfma_f32_16x16x32_bf16 v[136:139], a[192:195], a[160:163], v[136:139]
    ds_read_b64_tr_b16 a[216:217], v9 offset:33984
    v_mfma_f32_16x16x32_bf16 v[136:139], a[196:199], a[176:179], v[136:139]
    ds_read_b64_tr_b16 a[218:219], v9 offset:35776
    v_mfma_f32_16x16x32_bf16 v[140:143], a[192:195], a[164:167], v[140:143]
    ds_read_b64_tr_b16 a[220:221], v9 offset:54464
    v_mfma_f32_16x16x32_bf16 v[140:143], a[196:199], a[180:183], v[140:143]
    ds_read_b64_tr_b16 a[222:223], v9 offset:56256
    v_mfma_f32_16x16x32_bf16 v[152:155], a[192:195], a[168:171], v[152:155]
    s_add_u32 m0, s57, 61440
    v_mfma_f32_16x16x32_bf16 v[152:155], a[196:199], a[184:187], v[152:155]
    buffer_load_dwordx4 v5, s[24:27], s47 offen lds
    v_mfma_f32_16x16x32_bf16 v[156:159], a[192:195], a[172:175], v[156:159]
    s_add_u32 s47, s47, s52
    v_mfma_f32_16x16x32_bf16 v[156:159], a[196:199], a[188:191], v[156:159]
    s_waitcnt lgkmcnt(8)
    v_mfma_f32_16x16x32_bf16 v[168:171], a[200:203], a[160:163], v[168:171]
    s_add_u32 m0, s58, 61440
    v_mfma_f32_16x16x32_bf16 v[168:171], a[204:207], a[176:179], v[168:171]
    buffer_load_dwordx4 v6, s[28:31], s48 offen lds
    v_mfma_f32_16x16x32_bf16 v[172:175], a[200:203], a[164:167], v[172:175]
    s_add_u32 s48, s48, s53
    v_mfma_f32_16x16x32_bf16 v[172:175], a[204:207], a[180:183], v[172:175]
    s_waitcnt vmcnt(19) lgkmcnt(0)
    s_barrier
    v_mfma_f32_16x16x32_bf16 v[184:187], a[200:203], a[168:171], v[184:187]
    ds_read_b64_tr_b16 a[192:193], v10 offset:0
    v_mfma_f32_16x16x32_bf16 v[184:187], a[204:207], a[184:187], v[184:187]
    ds_read_b64_tr_b16 a[194:195], v10 offset:1536
    v_mfma_f32_16x16x32_bf16 v[188:191], a[200:203], a[172:175], v[188:191]
    ds_read_b64_tr_b16 a[196:197], v10 offset:20480
    v_mfma_f32_16x16x32_bf16 v[188:191], a[204:207], a[188:191], v[188:191]
    ds_read_b64_tr_b16 a[198:199], v10 offset:22016
    v_mfma_f32_16x16x32_bf16 v[200:203], a[208:211], a[160:163], v[200:203]
    ds_read_b64_tr_b16 a[200:201], v12 offset:32
    v_mfma_f32_16x16x32_bf16 v[200:203], a[212:215], a[176:179], v[200:203]
    ds_read_b64_tr_b16 a[202:203], v12 offset:1568
    v_mfma_f32_16x16x32_bf16 v[204:207], a[208:211], a[164:167], v[204:207]
    ds_read_b64_tr_b16 a[204:205], v12 offset:20512
    v_mfma_f32_16x16x32_bf16 v[204:207], a[212:215], a[180:183], v[204:207]
    ds_read_b64_tr_b16 a[206:207], v12 offset:22048
    v_mfma_f32_16x16x32_bf16 v[216:219], a[208:211], a[168:171], v[216:219]
    v_mfma_f32_16x16x32_bf16 v[216:219], a[212:215], a[184:187], v[216:219]
    buffer_load_dword v17, v16, s[40:43], s67 offen
    s_add_u32 s67, s67, s68
    v_mfma_f32_16x16x32_bf16 v[220:223], a[208:211], a[172:175], v[220:223]
    v_mfma_f32_16x16x32_bf16 v[220:223], a[212:215], a[188:191], v[220:223]
    s_waitcnt lgkmcnt(8)
    v_mfma_f32_16x16x32_bf16 v[232:235], a[216:219], a[160:163], v[232:235]
    ds_read_b64_tr_b16 a[208:209], v10 offset:64
    v_mfma_f32_16x16x32_bf16 v[232:235], a[220:223], a[176:179], v[232:235]
    ds_read_b64_tr_b16 a[210:211], v10 offset:1600
    v_mfma_f32_16x16x32_bf16 v[236:239], a[216:219], a[164:167], v[236:239]
    ds_read_b64_tr_b16 a[212:213], v10 offset:20544
    v_mfma_f32_16x16x32_bf16 v[236:239], a[220:223], a[180:183], v[236:239]
    ds_read_b64_tr_b16 a[214:215], v10 offset:22080
    v_mfma_f32_16x16x32_bf16 v[248:251], a[216:219], a[168:171], v[248:251]
    s_sub_u32 s4, s65, 2
    s_cmp_lt_u32 s4, 12
    s_cselect_b32 s4, s69, 52461568
    v_mfma_f32_16x16x32_bf16 v[248:251], a[220:223], a[184:187], v[248:251]
    buffer_store_dwordx4 v[20:23], v7, s[32:35], s4 offen sc1
    s_add_u32 s69, s69, 0x100000
    v_mfma_f32_16x16x32_bf16 v[252:255], a[216:219], a[172:175], v[252:255]
    s_add_u32 s65, s65, 1
    v_mfma_f32_16x16x32_bf16 v[252:255], a[220:223], a[188:191], v[252:255]
    s_add_u32 s61, s61, 1
    s_cmp_lg_u32 s61, 2
    s_cbranch_scc1 recurrent_scan__linear_kernel_hedgehog__glu_gated_bilinear__prompt_kernel_n1
    s_cmp_lg_u32 s62, 3
    s_cbranch_scc1 recurrent_scan__linear_kernel_hedgehog__glu_gated_bilinear__prompt_kernel_n6
    v_mov_b32 v15, 1
    s_lshl_b32 s4, s64, 5
    s_mov_b64 exec, 1
    buffer_atomic_add v15, v7, s[36:39], s4 offen offset:4 sc1
    s_mov_b64 exec, -1
recurrent_scan__linear_kernel_hedgehog__glu_gated_bilinear__prompt_kernel_n6:
    s_cmp_eq_u32 s62, 3
    s_cbranch_scc1 recurrent_scan__linear_kernel_hedgehog__glu_gated_bilinear__prompt_kernel_n1
    s_mov_b32 s40, s74
    s_and_b32 s41, s75, 0xffff
    s_mov_b32 s42, 2097152
    s_mov_b32 s43, 0x20000
    s_mul_i32 s67, s2, 3
    s_add_u32 s67, s67, s62
    s_lshl_b32 s67, s67, 10
    s_mov_b32 s68, 786432
    v_mov_b32 v16, 0x1000000
    v_cmp_gt_u32 vcc, 8, v1
    s_nop 1
    v_cndmask_b32 v16, v16, v14, vcc
recurrent_scan__linear_kernel_hedgehog__glu_gated_bilinear__prompt_kernel_n1:
    s_cmp_lt_u32 s61, 5
    s_cbranch_scc1 recurrent_scan__linear_kernel_hedgehog__glu_gated_bilinear__prompt_kernel_loop
k_epi:
    ds_read_b64_tr_b16 a[236:237], v24 offset:0
    ds_read_b64_tr_b16 a[238:239], v24 offset:256
    ds_read_b64_tr_b16 a[240:241], v24 offset:1024
    ds_read_b64_tr_b16 a[242:243], v24 offset:1280
    s_load_dwordx2 s[12:13], s[0:1], 72
    s_load_dwordx2 s[36:37], s[0:1], 0
    s_load_dwordx2 s[38:39], s[0:1], 24
    s_load_dwordx4 s[40:43], s[0:1], 56
    s_mov_b32 s44, 1069066811
    s_mov_b32 s45, 1069066811
    s_mov_b32 s46, 0xfffffffe
    s_lshl_b32 s47, s64, 12
    s_add_u32 s47, s47, s79
    s_lshl_b32 s48, s64, 9
    s_add_u32 s48, s48, s84
    v_pk_mul_f32 v[32:33], v[32:33], v[40:41]
    v_pk_mul_f32 v[34:35], v[34:35], v[42:43]
    v_pk_mul_f32 v[36:37], v[36:37], v[44:45]
    v_pk_mul_f32 v[38:39], v[38:39], v[46:47]
    v_cvt_pk_bf16_f32 v32, v32, v33
    v_cvt_pk_bf16_f32 v33, v34, v35
    v_cvt_pk_bf16_f32 v34, v36, v37
    v_cvt_pk_bf16_f32 v35, v38, v39
    v_pk_mul_f32 v[48:49], v[48:49], v[56:57]
    v_pk_mul_f32 v[50:51], v[50:51], v[58:59]
    v_pk_mul_f32 v[52:53], v[52:53], v[60:61]
    v_pk_mul_f32 v[54:55], v[54:55], v[62:63]
    v_cvt_pk_bf16_f32 v36, v48, v49
    v_cvt_pk_bf16_f32 v37, v50, v51
    v_cvt_pk_bf16_f32 v38, v52, v53
    v_cvt_pk_bf16_f32 v39, v54, v55
    v_permlane16_swap_b32 v32, v34
    v_permlane16_swap_b32 v33, v35
    v_pk_mul_f32 v[64:65], v[64:65], v[72:73]
    v_pk_mul_f32 v[66:67], v[66:67], v[74:75]
    v_pk_mul_f32 v[68:69], v[68:69], v[76:77]
    v_pk_mul_f32 v[70:71], v[70:71], v[78:79]
    v_cvt_pk_bf16_f32 v40, v64, v65
    v_cvt_pk_bf16_f32 v41, v66, v67
    v_cvt_pk_bf16_f32 v42, v68, v69
    v_cvt_pk_bf16_f32 v43, v70, v71
    v_permlane16_swap_b32 v36, v38
    v_permlane16_swap_b32 v37, v39
    v_pk_mul_f32 v[80:81], v[80:81], v[88:89]
    v_pk_mul_f32 v[82:83], v[82:83], v[90:91]
    v_pk_mul_f32 v[84:85], v[84:85], v[92:93]
    v_pk_mul_f32 v[86:87], v[86:87], v[94:95]
    v_cvt_pk_bf16_f32 v44, v80, v81
    v_cvt_pk_bf16_f32 v45, v82, v83
    v_cvt_pk_bf16_f32 v46, v84, v85
    v_cvt_pk_bf16_f32 v47, v86, v87
    v_permlane16_swap_b32 v40, v42
    v_permlane16_swap_b32 v41, v43
    buffer_store_dwordx4 v[32:35], v18, s[32:35], s70 offen sc1
    v_pk_mul_f32 v[96:97], v[96:97], v[104:105]
    v_pk_mul_f32 v[98:99], v[98:99], v[106:107]
    v_pk_mul_f32 v[100:101], v[100:101], v[108:109]
    v_pk_mul_f32 v[102:103], v[102:103], v[110:111]
    v_cvt_pk_bf16_f32 v48, v96, v97
    v_cvt_pk_bf16_f32 v49, v98, v99
    v_cvt_pk_bf16_f32 v50, v100, v101
    v_cvt_pk_bf16_f32 v51, v102, v103
    v_permlane16_swap_b32 v44, v46
    v_permlane16_swap_b32 v45, v47
    v_pk_mul_f32 v[112:113], v[112:113], v[120:121]
    v_pk_mul_f32 v[114:115], v[114:115], v[122:123]
    v_pk_mul_f32 v[116:117], v[116:117], v[124:125]
    v_pk_mul_f32 v[118:119], v[118:119], v[126:127]
    v_cvt_pk_bf16_f32 v52, v112, v113
    v_cvt_pk_bf16_f32 v53, v114, v115
    v_cvt_pk_bf16_f32 v54, v116, v117
    v_cvt_pk_bf16_f32 v55, v118, v119
    v_permlane16_swap_b32 v48, v50
    v_permlane16_swap_b32 v49, v51
    v_pk_mul_f32 v[128:129], v[128:129], v[136:137]
    v_pk_mul_f32 v[130:131], v[130:131], v[138:139]
    v_pk_mul_f32 v[132:133], v[132:133], v[140:141]
    v_pk_mul_f32 v[134:135], v[134:135], v[142:143]
    v_cvt_pk_bf16_f32 v56, v128, v129
    v_cvt_pk_bf16_f32 v57, v130, v131
    v_cvt_pk_bf16_f32 v58, v132, v133
    v_cvt_pk_bf16_f32 v59, v134, v135
    v_permlane16_swap_b32 v52, v54
    v_permlane16_swap_b32 v53, v55
    buffer_store_dwordx4 v[36:39], v31, s[32:35], s70 offen sc1
    v_pk_mul_f32 v[144:145], v[144:145], v[152:153]
    v_pk_mul_f32 v[146:147], v[146:147], v[154:155]
    v_pk_mul_f32 v[148:149], v[148:149], v[156:157]
    v_pk_mul_f32 v[150:151], v[150:151], v[158:159]
    v_cvt_pk_bf16_f32 v60, v144, v145
    v_cvt_pk_bf16_f32 v61, v146, v147
    v_cvt_pk_bf16_f32 v62, v148, v149
    v_cvt_pk_bf16_f32 v63, v150, v151
    v_permlane16_swap_b32 v56, v58
    v_permlane16_swap_b32 v57, v59
    v_pk_mul_f32 v[160:161], v[160:161], v[168:169]
    v_pk_mul_f32 v[162:163], v[162:163], v[170:171]
    v_pk_mul_f32 v[164:165], v[164:165], v[172:173]
    v_pk_mul_f32 v[166:167], v[166:167], v[174:175]
    v_cvt_pk_bf16_f32 v64, v160, v161
    v_cvt_pk_bf16_f32 v65, v162, v163
    v_cvt_pk_bf16_f32 v66, v164, v165
    v_cvt_pk_bf16_f32 v67, v166, v167
    v_permlane16_swap_b32 v60, v62
    v_permlane16_swap_b32 v61, v63
    v_pk_mul_f32 v[176:177], v[176:177], v[184:185]
    v_pk_mul_f32 v[178:179], v[178:179], v[186:187]
    v_pk_mul_f32 v[180:181], v[180:181], v[188:189]
    v_pk_mul_f32 v[182:183], v[182:183], v[190:191]
    v_cvt_pk_bf16_f32 v68, v176, v177
    v_cvt_pk_bf16_f32 v69, v178, v179
    v_cvt_pk_bf16_f32 v70, v180, v181
    v_cvt_pk_bf16_f32 v71, v182, v183
    v_permlane16_swap_b32 v64, v66
    v_permlane16_swap_b32 v65, v67
    buffer_store_dwordx4 v[40:43], v18, s[32:35], s71 offen sc1
    v_pk_mul_f32 v[192:193], v[192:193], v[200:201]
    v_pk_mul_f32 v[194:195], v[194:195], v[202:203]
    v_pk_mul_f32 v[196:197], v[196:197], v[204:205]
    v_pk_mul_f32 v[198:199], v[198:199], v[206:207]
    v_cvt_pk_bf16_f32 v72, v192, v193
    v_cvt_pk_bf16_f32 v73, v194, v195
    v_cvt_pk_bf16_f32 v74, v196, v197
    v_cvt_pk_bf16_f32 v75, v198, v199
    v_permlane16_swap_b32 v68, v70
    v_permlane16_swap_b32 v69, v71
    v_pk_mul_f32 v[208:209], v[208:209], v[216:217]
    v_pk_mul_f32 v[210:211], v[210:211], v[218:219]
    v_pk_mul_f32 v[212:213], v[212:213], v[220:221]
    v_pk_mul_f32 v[214:215], v[214:215], v[222:223]
    v_cvt_pk_bf16_f32 v76, v208, v209
    v_cvt_pk_bf16_f32 v77, v210, v211
    v_cvt_pk_bf16_f32 v78, v212, v213
    v_cvt_pk_bf16_f32 v79, v214, v215
    v_permlane16_swap_b32 v72, v74
    v_permlane16_swap_b32 v73, v75
    v_pk_mul_f32 v[224:225], v[224:225], v[232:233]
    v_pk_mul_f32 v[226:227], v[226:227], v[234:235]
    v_pk_mul_f32 v[228:229], v[228:229], v[236:237]
    v_pk_mul_f32 v[230:231], v[230:231], v[238:239]
    v_cvt_pk_bf16_f32 v80, v224, v225
    v_cvt_pk_bf16_f32 v81, v226, v227
    v_cvt_pk_bf16_f32 v82, v228, v229
    v_cvt_pk_bf16_f32 v83, v230, v231
    v_permlane16_swap_b32 v76, v78
    v_permlane16_swap_b32 v77, v79
    buffer_store_dwordx4 v[44:47], v31, s[32:35], s71 offen sc1
    v_pk_mul_f32 v[240:241], v[240:241], v[248:249]
    v_pk_mul_f32 v[242:243], v[242:243], v[250:251]
    v_pk_mul_f32 v[244:245], v[244:245], v[252:253]
    v_pk_mul_f32 v[246:247], v[246:247], v[254:255]
    v_cvt_pk_bf16_f32 v84, v240, v241
    v_cvt_pk_bf16_f32 v85, v242, v243
    v_cvt_pk_bf16_f32 v86, v244, v245
    v_cvt_pk_bf16_f32 v87, v246, v247
    v_permlane16_swap_b32 v80, v82
    v_permlane16_swap_b32 v81, v83
    v_permlane16_swap_b32 v84, v86
    v_permlane16_swap_b32 v85, v87
    v_accvgpr_read_b32 v112, a32
    v_accvgpr_read_b32 v113, a33
    v_accvgpr_read_b32 v114, a34
    v_accvgpr_read_b32 v115, a35
    v_accvgpr_read_b32 v116, a36
    v_accvgpr_read_b32 v117, a37
    v_accvgpr_read_b32 v118, a38
    v_accvgpr_read_b32 v119, a39
    v_accvgpr_read_b32 v120, a48
    v_accvgpr_read_b32 v121, a49
    v_accvgpr_read_b32 v122, a50
    v_accvgpr_read_b32 v123, a51
    v_accvgpr_read_b32 v124, a52
    v_accvgpr_read_b32 v125, a53
    v_accvgpr_read_b32 v126, a54
    v_accvgpr_read_b32 v127, a55
    v_cvt_pk_bf16_f32 v128, v112, v113
    v_cvt_pk_bf16_f32 v129, v114, v115
    v_cvt_pk_bf16_f32 v130, v116, v117
    v_cvt_pk_bf16_f32 v131, v118, v119
    v_cvt_pk_bf16_f32 v132, v120, v121
    v_cvt_pk_bf16_f32 v133, v122, v123
    v_cvt_pk_bf16_f32 v134, v124, v125
    v_cvt_pk_bf16_f32 v135, v126, v127
    v_accvgpr_read_b32 v192, a40
    v_accvgpr_read_b32 v193, a41
    v_accvgpr_read_b32 v194, a42
    v_accvgpr_read_b32 v195, a43
    buffer_store_dwordx4 v[48:51], v18, s[32:35], s72 offen sc1
    v_accvgpr_read_b32 v196, a44
    v_accvgpr_read_b32 v197, a45
    v_accvgpr_read_b32 v198, a46
    v_accvgpr_read_b32 v199, a47
    v_accvgpr_read_b32 v200, a56
    v_accvgpr_read_b32 v201, a57
    v_accvgpr_read_b32 v202, a58
    v_accvgpr_read_b32 v203, a59
    v_accvgpr_read_b32 v204, a60
    v_accvgpr_read_b32 v205, a61
    v_accvgpr_read_b32 v206, a62
    v_accvgpr_read_b32 v207, a63
    v_cvt_pk_bf16_f32 v208, v192, v193
    v_cvt_pk_bf16_f32 v209, v194, v195
    v_cvt_pk_bf16_f32 v210, v196, v197
    v_cvt_pk_bf16_f32 v211, v198, v199
    v_cvt_pk_bf16_f32 v212, v200, v201
    v_cvt_pk_bf16_f32 v213, v202, v203
    v_cvt_pk_bf16_f32 v214, v204, v205
    v_cvt_pk_bf16_f32 v215, v206, v207
    v_permlane16_swap_b32 v128, v130
    v_permlane16_swap_b32 v129, v131
    v_permlane16_swap_b32 v132, v134
    v_permlane16_swap_b32 v133, v135
    v_permlane16_swap_b32 v208, v210
    v_permlane16_swap_b32 v209, v211
    v_permlane16_swap_b32 v212, v214
    v_permlane16_swap_b32 v213, v215
    buffer_store_dwordx4 v[52:55], v31, s[32:35], s72 offen sc1
    s_waitcnt lgkmcnt(0)
    s_and_b32 s13, s13, 0xffff
    s_mov_b32 s14, 256
    s_mov_b32 s15, 0x20000
    v_and_b32 v22, 7, v1
    v_lshlrev_b32 v22, 5, v22
    buffer_load_dword v23, v22, s[12:15], 0 offen offset:4 sc1
    v_mfma_f32_32x32x16_bf16 v[96:111], a[236:239], v[128:131], 0
    v_mfma_f32_32x32x16_bf16 v[176:191], a[236:239], v[208:211], 0
    v_mfma_f32_32x32x16_bf16 v[96:111], a[240:243], v[132:135], v[96:111]
    v_mfma_f32_32x32x16_bf16 v[176:191], a[240:243], v[212:215], v[176:191]
    v_accvgpr_read_b32 v112, a64
    v_accvgpr_read_b32 v113, a65
    v_accvgpr_read_b32 v114, a66
    v_accvgpr_read_b32 v115, a67
    v_accvgpr_read_b32 v116, a80
    v_accvgpr_read_b32 v117, a81
    v_accvgpr_read_b32 v118, a82
    v_accvgpr_read_b32 v119, a83
    v_accvgpr_read_b32 v120, a68
    v_accvgpr_read_b32 v121, a69
    v_accvgpr_read_b32 v122, a70
    v_accvgpr_read_b32 v123, a71
    v_accvgpr_read_b32 v124, a84
    v_accvgpr_read_b32 v125, a85
    v_accvgpr_read_b32 v126, a86
    v_accvgpr_read_b32 v127, a87
    v_cvt_pk_bf16_f32 v152, v112, v113
    buffer_store_dwordx4 v[56:59], v18, s[32:35], s73 offen sc1
    v_cvt_pk_bf16_f32 v153, v114, v115
    v_cvt_pk_bf16_f32 v154, v116, v117
    v_cvt_pk_bf16_f32 v155, v118, v119
    v_cvt_pk_bf16_f32 v156, v120, v121
    v_cvt_pk_bf16_f32 v157, v122, v123
    v_cvt_pk_bf16_f32 v158, v124, v125
    v_cvt_pk_bf16_f32 v159, v126, v127
    v_accvgpr_read_b32 v192, a72
    v_accvgpr_read_b32 v193, a73
    v_accvgpr_read_b32 v194, a74
    v_accvgpr_read_b32 v195, a75
    v_accvgpr_read_b32 v196, a88
    v_accvgpr_read_b32 v197, a89
    v_accvgpr_read_b32 v198, a90
    v_accvgpr_read_b32 v199, a91
    v_accvgpr_read_b32 v200, a76
    v_accvgpr_read_b32 v201, a77
    v_accvgpr_read_b32 v202, a78
    v_accvgpr_read_b32 v203, a79
    v_accvgpr_read_b32 v204, a92
    v_accvgpr_read_b32 v205, a93
    v_accvgpr_read_b32 v206, a94
    v_accvgpr_read_b32 v207, a95
    v_cvt_pk_bf16_f32 v232, v192, v193
    v_cvt_pk_bf16_f32 v233, v194, v195
    v_cvt_pk_bf16_f32 v234, v196, v197
    v_cvt_pk_bf16_f32 v235, v198, v199
    v_cvt_pk_bf16_f32 v236, v200, v201
    buffer_store_dwordx4 v[60:63], v31, s[32:35], s73 offen sc1
    v_cvt_pk_bf16_f32 v237, v202, v203
    v_cvt_pk_bf16_f32 v238, v204, v205
    v_cvt_pk_bf16_f32 v239, v206, v207
    v_permlane16_swap_b32 v152, v154
    v_permlane16_swap_b32 v153, v155
    v_permlane16_swap_b32 v156, v158
    v_permlane16_swap_b32 v157, v159
    v_permlane16_swap_b32 v232, v234
    v_permlane16_swap_b32 v233, v235
    v_permlane16_swap_b32 v236, v238
    v_permlane16_swap_b32 v237, v239
    v_permlane32_swap_b32 v152, v154
    v_permlane32_swap_b32 v153, v155
    v_permlane32_swap_b32 v156, v158
    v_permlane32_swap_b32 v157, v159
    v_permlane32_swap_b32 v232, v234
    v_permlane32_swap_b32 v233, v235
    v_permlane32_swap_b32 v236, v238
    v_permlane32_swap_b32 v237, v239
    v_cvt_pk_bf16_f32 v96, 0, v96
    v_cvt_pk_bf16_f32 v176, 0, v176
    v_cvt_pk_bf16_f32 v97, 0, v97
    v_cvt_pk_bf16_f32 v177, 0, v177
    v_cvt_pk_bf16_f32 v98, 0, v98
    v_cvt_pk_bf16_f32 v178, 0, v178
    v_cvt_pk_bf16_f32 v99, 0, v99
    v_cvt_pk_bf16_f32 v179, 0, v179
    v_cvt_pk_bf16_f32 v100, 0, v100
    buffer_store_dwordx4 v[64:67], v18, s[32:35], s76 offen sc1
    v_cvt_pk_bf16_f32 v180, 0, v180
    v_cvt_pk_bf16_f32 v101, 0, v101
    v_cvt_pk_bf16_f32 v181, 0, v181
    v_cvt_pk_bf16_f32 v102, 0, v102
    v_cvt_pk_bf16_f32 v182, 0, v182
    v_cvt_pk_bf16_f32 v103, 0, v103
    v_cvt_pk_bf16_f32 v183, 0, v183
    v_cvt_pk_bf16_f32 v104, 0, v104
    v_cvt_pk_bf16_f32 v184, 0, v184
    v_cvt_pk_bf16_f32 v105, 0, v105
    v_cvt_pk_bf16_f32 v185, 0, v185
    v_cvt_pk_bf16_f32 v106, 0, v106
    v_cvt_pk_bf16_f32 v186, 0, v186
    v_cvt_pk_bf16_f32 v107, 0, v107
    v_cvt_pk_bf16_f32 v187, 0, v187
    v_cvt_pk_bf16_f32 v108, 0, v108
    v_cvt_pk_bf16_f32 v188, 0, v188
    v_cvt_pk_bf16_f32 v109, 0, v109
    v_cvt_pk_bf16_f32 v189, 0, v189
    v_cvt_pk_bf16_f32 v110, 0, v110
    v_cvt_pk_bf16_f32 v190, 0, v190
    v_cvt_pk_bf16_f32 v111, 0, v111
    v_cvt_pk_bf16_f32 v191, 0, v191
    v_max3_f32 v128, v96, v97, v98
    v_min3_f32 v130, v96, v97, v98
    v_max3_f32 v208, v176, v177, v178
    v_min3_f32 v210, v176, v177, v178
    v_max3_f32 v128, v128, v99, v100
    buffer_store_dwordx4 v[68:71], v31, s[32:35], s76 offen sc1
    v_min3_f32 v130, v130, v99, v100
    v_max3_f32 v208, v208, v179, v180
    v_min3_f32 v210, v210, v179, v180
    v_max3_f32 v128, v128, v101, v102
    v_min3_f32 v130, v130, v101, v102
    v_max3_f32 v208, v208, v181, v182
    v_min3_f32 v210, v210, v181, v182
    v_max3_f32 v128, v128, v103, v104
    v_min3_f32 v130, v130, v103, v104
    v_max3_f32 v208, v208, v183, v184
    v_min3_f32 v210, v210, v183, v184
    v_max3_f32 v128, v128, v105, v106
    v_min3_f32 v130, v130, v105, v106
    v_max3_f32 v208, v208, v185, v186
    v_min3_f32 v210, v210, v185, v186
    v_max3_f32 v128, v128, v107, v108
    v_min3_f32 v130, v130, v107, v108
    v_max3_f32 v208, v208, v187, v188
    v_min3_f32 v210, v210, v187, v188
    v_max3_f32 v128, v128, v109, v110
    v_min3_f32 v130, v130, v109, v110
    v_max3_f32 v208, v208, v189, v190
    v_min3_f32 v210, v210, v189, v190
    v_max_f32 v128, v128, v111
    v_min_f32 v130, v130, v111
    v_max_f32 v208, v208, v191
    v_min_f32 v210, v210, v191
    v_mov_b32 v129, v128
    buffer_store_dwordx4 v[72:75], v18, s[32:35], s77 offen sc1
    v_mov_b32 v131, v130
    v_mov_b32 v209, v208
    v_mov_b32 v211, v210
    v_permlane32_swap_b32 v128, v129
    v_permlane32_swap_b32 v130, v131
    v_permlane32_swap_b32 v208, v209
    v_permlane32_swap_b32 v210, v211
    v_max_f32 v128, v128, v129
    v_min_f32 v130, v130, v131
    v_max_f32 v208, v208, v209
    v_min_f32 v210, v210, v211
    v_mul_f32 v128, s44, v128
    v_mul_f32 v130, s44, v130
    v_mul_f32 v208, s44, v208
    v_mul_f32 v210, s44, v210
    v_pk_fma_f32 v[112:113], v[96:97], s[44:45], v[130:131] op_sel_hi:[1,1,0] neg_lo:[1,0,0] neg_hi:[1,0,0]
    v_pk_fma_f32 v[96:97], v[96:97], s[44:45], v[128:129] op_sel_hi:[1,1,0] neg_lo:[0,0,1] neg_hi:[0,0,1]
    v_pk_fma_f32 v[192:193], v[176:177], s[44:45], v[210:211] op_sel_hi:[1,1,0] neg_lo:[1,0,0] neg_hi:[1,0,0]
    v_pk_fma_f32 v[176:177], v[176:177], s[44:45], v[208:209] op_sel_hi:[1,1,0] neg_lo:[0,0,1] neg_hi:[0,0,1]
    v_pk_fma_f32 v[114:115], v[98:99], s[44:45], v[130:131] op_sel_hi:[1,1,0] neg_lo:[1,0,0] neg_hi:[1,0,0]
    v_pk_fma_f32 v[98:99], v[98:99], s[44:45], v[128:129] op_sel_hi:[1,1,0] neg_lo:[0,0,1] neg_hi:[0,0,1]
    v_pk_fma_f32 v[194:195], v[178:179], s[44:45], v[210:211] op_sel_hi:[1,1,0] neg_lo:[1,0,0] neg_hi:[1,0,0]
    v_pk_fma_f32 v[178:179], v[178:179], s[44:45], v[208:209] op_sel_hi:[1,1,0] neg_lo:[0,0,1] neg_hi:[0,0,1]
    v_pk_fma_f32 v[116:117], v[100:101], s[44:45], v[130:131] op_sel_hi:[1,1,0] neg_lo:[1,0,0] neg_hi:[1,0,0]
    v_pk_fma_f32 v[100:101], v[100:101], s[44:45], v[128:129] op_sel_hi:[1,1,0] neg_lo:[0,0,1] neg_hi:[0,0,1]
    v_pk_fma_f32 v[196:197], v[180:181], s[44:45], v[210:211] op_sel_hi:[1,1,0] neg_lo:[1,0,0] neg_hi:[1,0,0]
    v_pk_fma_f32 v[180:181], v[180:181], s[44:45], v[208:209] op_sel_hi:[1,1,0] neg_lo:[0,0,1] neg_hi:[0,0,1]
    v_pk_fma_f32 v[118:119], v[102:103], s[44:45], v[130:131] op_sel_hi:[1,1,0] neg_lo:[1,0,0] neg_hi:[1,0,0]
    buffer_store_dwordx4 v[76:79], v31, s[32:35], s77 offen sc1
    v_pk_fma_f32 v[102:103], v[102:103], s[44:45], v[128:129] op_sel_hi:[1,1,0] neg_lo:[0,0,1] neg_hi:[0,0,1]
    v_pk_fma_f32 v[198:199], v[182:183], s[44:45], v[210:211] op_sel_hi:[1,1,0] neg_lo:[1,0,0] neg_hi:[1,0,0]
    v_pk_fma_f32 v[182:183], v[182:183], s[44:45], v[208:209] op_sel_hi:[1,1,0] neg_lo:[0,0,1] neg_hi:[0,0,1]
    v_pk_fma_f32 v[120:121], v[104:105], s[44:45], v[130:131] op_sel_hi:[1,1,0] neg_lo:[1,0,0] neg_hi:[1,0,0]
    v_pk_fma_f32 v[104:105], v[104:105], s[44:45], v[128:129] op_sel_hi:[1,1,0] neg_lo:[0,0,1] neg_hi:[0,0,1]
    v_pk_fma_f32 v[200:201], v[184:185], s[44:45], v[210:211] op_sel_hi:[1,1,0] neg_lo:[1,0,0] neg_hi:[1,0,0]
    v_pk_fma_f32 v[184:185], v[184:185], s[44:45], v[208:209] op_sel_hi:[1,1,0] neg_lo:[0,0,1] neg_hi:[0,0,1]
    v_pk_fma_f32 v[122:123], v[106:107], s[44:45], v[130:131] op_sel_hi:[1,1,0] neg_lo:[1,0,0] neg_hi:[1,0,0]
    v_pk_fma_f32 v[106:107], v[106:107], s[44:45], v[128:129] op_sel_hi:[1,1,0] neg_lo:[0,0,1] neg_hi:[0,0,1]
    v_pk_fma_f32 v[202:203], v[186:187], s[44:45], v[210:211] op_sel_hi:[1,1,0] neg_lo:[1,0,0] neg_hi:[1,0,0]
    v_pk_fma_f32 v[186:187], v[186:187], s[44:45], v[208:209] op_sel_hi:[1,1,0] neg_lo:[0,0,1] neg_hi:[0,0,1]
    v_pk_fma_f32 v[124:125], v[108:109], s[44:45], v[130:131] op_sel_hi:[1,1,0] neg_lo:[1,0,0] neg_hi:[1,0,0]
    v_pk_fma_f32 v[108:109], v[108:109], s[44:45], v[128:129] op_sel_hi:[1,1,0] neg_lo:[0,0,1] neg_hi:[0,0,1]
    v_pk_fma_f32 v[204:205], v[188:189], s[44:45], v[210:211] op_sel_hi:[1,1,0] neg_lo:[1,0,0] neg_hi:[1,0,0]
    v_pk_fma_f32 v[188:189], v[188:189], s[44:45], v[208:209] op_sel_hi:[1,1,0] neg_lo:[0,0,1] neg_hi:[0,0,1]
    v_pk_fma_f32 v[126:127], v[110:111], s[44:45], v[130:131] op_sel_hi:[1,1,0] neg_lo:[1,0,0] neg_hi:[1,0,0]
    v_pk_fma_f32 v[110:111], v[110:111], s[44:45], v[128:129] op_sel_hi:[1,1,0] neg_lo:[0,0,1] neg_hi:[0,0,1]
    v_pk_fma_f32 v[206:207], v[190:191], s[44:45], v[210:211] op_sel_hi:[1,1,0] neg_lo:[1,0,0] neg_hi:[1,0,0]
    v_pk_fma_f32 v[190:191], v[190:191], s[44:45], v[208:209] op_sel_hi:[1,1,0] neg_lo:[0,0,1] neg_hi:[0,0,1]
    v_exp_f32 v96, v96
    v_exp_f32 v112, v112
    v_exp_f32 v176, v176
    v_exp_f32 v192, v192
    v_exp_f32 v97, v97
    v_exp_f32 v113, v113
    v_exp_f32 v177, v177
    v_exp_f32 v193, v193
    v_exp_f32 v98, v98
    buffer_store_dwordx4 v[80:83], v18, s[32:35], s78 offen sc1
    v_exp_f32 v114, v114
    v_exp_f32 v178, v178
    v_exp_f32 v194, v194
    v_exp_f32 v99, v99
    v_exp_f32 v115, v115
    v_exp_f32 v179, v179
    v_exp_f32 v195, v195
    v_exp_f32 v100, v100
    v_exp_f32 v116, v116
    v_exp_f32 v180, v180
    v_exp_f32 v196, v196
    v_exp_f32 v101, v101
    v_exp_f32 v117, v117
    v_exp_f32 v181, v181
    v_exp_f32 v197, v197
    v_exp_f32 v102, v102
    v_exp_f32 v118, v118
    v_exp_f32 v182, v182
    v_exp_f32 v198, v198
    v_exp_f32 v103, v103
    v_exp_f32 v119, v119
    v_exp_f32 v183, v183
    v_exp_f32 v199, v199
    v_exp_f32 v104, v104
    v_exp_f32 v120, v120
    v_exp_f32 v184, v184
    v_exp_f32 v200, v200
    v_exp_f32 v105, v105
    buffer_store_dwordx4 v[84:87], v31, s[32:35], s78 offen sc1
    v_exp_f32 v121, v121
    v_exp_f32 v185, v185
    v_exp_f32 v201, v201
    v_exp_f32 v106, v106
    v_exp_f32 v122, v122
    v_exp_f32 v186, v186
    v_exp_f32 v202, v202
    v_exp_f32 v107, v107
    v_exp_f32 v123, v123
    v_exp_f32 v187, v187
    v_exp_f32 v203, v203
    v_exp_f32 v108, v108
    v_exp_f32 v124, v124
    v_exp_f32 v188, v188
    v_exp_f32 v204, v204
    v_exp_f32 v109, v109
    v_exp_f32 v125, v125
    v_exp_f32 v189, v189
    v_exp_f32 v205, v205
    v_exp_f32 v110, v110
    v_exp_f32 v126, v126
    v_exp_f32 v190, v190
    v_exp_f32 v206, v206
    v_exp_f32 v111, v111
    v_exp_f32 v127, v127
    v_exp_f32 v191, v191
    v_exp_f32 v207, v207
    v_pk_add_f32 v[128:129], v[96:97], v[98:99]
    v_pk_add_f32 v[130:131], v[112:113], v[114:115]
    v_pk_add_f32 v[208:209], v[176:177], v[178:179]
    v_pk_add_f32 v[210:211], v[192:193], v[194:195]
    v_pk_add_f32 v[128:129], v[128:129], v[100:101]
    v_pk_add_f32 v[130:131], v[130:131], v[116:117]
    v_pk_add_f32 v[208:209], v[208:209], v[180:181]
    v_pk_add_f32 v[210:211], v[210:211], v[196:197]
    v_pk_add_f32 v[128:129], v[128:129], v[102:103]
    v_pk_add_f32 v[130:131], v[130:131], v[118:119]
    v_pk_add_f32 v[208:209], v[208:209], v[182:183]
    v_pk_add_f32 v[210:211], v[210:211], v[198:199]
    v_pk_add_f32 v[128:129], v[128:129], v[104:105]
    v_pk_add_f32 v[130:131], v[130:131], v[120:121]
    v_pk_add_f32 v[208:209], v[208:209], v[184:185]
    v_pk_add_f32 v[210:211], v[210:211], v[200:201]
    v_pk_add_f32 v[128:129], v[128:129], v[106:107]
    v_pk_add_f32 v[130:131], v[130:131], v[122:123]
    v_pk_add_f32 v[208:209], v[208:209], v[186:187]
    v_pk_add_f32 v[210:211], v[210:211], v[202:203]
    v_pk_add_f32 v[128:129], v[128:129], v[108:109]
    v_pk_add_f32 v[130:131], v[130:131], v[124:125]
    v_pk_add_f32 v[208:209], v[208:209], v[188:189]
    v_pk_add_f32 v[210:211], v[210:211], v[204:205]
    v_pk_add_f32 v[128:129], v[128:129], v[110:111]
    v_pk_add_f32 v[130:131], v[130:131], v[126:127]
    v_pk_add_f32 v[208:209], v[208:209], v[190:191]
    v_pk_add_f32 v[210:211], v[210:211], v[206:207]
    v_add_f32 v128, v128, v129
    v_add_f32 v130, v130, v131
    v_add_f32 v208, v208, v209
    v_add_f32 v210, v210, v211
    v_mov_b32 v129, v128
    v_mov_b32 v131, v130
    v_mov_b32 v209, v208
    v_mov_b32 v211, v210
    v_permlane32_swap_b32 v128, v129
    v_permlane32_swap_b32 v130, v131
    v_permlane32_swap_b32 v208, v209
    v_permlane32_swap_b32 v210, v211
    v_add_f32 v128, v128, v129
    v_add_f32 v130, v130, v131
    v_add_f32 v208, v208, v209
    v_add_f32 v210, v210, v211
    v_rcp_f32 v128, v128
    v_rcp_f32 v130, v130
    v_rcp_f32 v208, v208
    v_rcp_f32 v210, v210
    v_pk_mul_f32 v[96:97], v[96:97], v[128:129] op_sel_hi:[1,0]
    v_pk_mul_f32 v[112:113], v[112:113], v[130:131] op_sel_hi:[1,0]
    v_pk_mul_f32 v[176:177], v[176:177], v[208:209] op_sel_hi:[1,0]
    v_pk_mul_f32 v[192:193], v[192:193], v[210:211] op_sel_hi:[1,0]
    v_pk_mul_f32 v[98:99], v[98:99], v[128:129] op_sel_hi:[1,0]
    v_pk_mul_f32 v[114:115], v[114:115], v[130:131] op_sel_hi:[1,0]
    v_pk_mul_f32 v[178:179], v[178:179], v[208:209] op_sel_hi:[1,0]
    v_pk_mul_f32 v[194:195], v[194:195], v[210:211] op_sel_hi:[1,0]
    v_pk_mul_f32 v[100:101], v[100:101], v[128:129] op_sel_hi:[1,0]
    v_pk_mul_f32 v[116:117], v[116:117], v[130:131] op_sel_hi:[1,0]
    v_pk_mul_f32 v[180:181], v[180:181], v[208:209] op_sel_hi:[1,0]
    v_pk_mul_f32 v[196:197], v[196:197], v[210:211] op_sel_hi:[1,0]
    v_pk_mul_f32 v[102:103], v[102:103], v[128:129] op_sel_hi:[1,0]
    v_pk_mul_f32 v[118:119], v[118:119], v[130:131] op_sel_hi:[1,0]
    v_pk_mul_f32 v[182:183], v[182:183], v[208:209] op_sel_hi:[1,0]
    v_pk_mul_f32 v[198:199], v[198:199], v[210:211] op_sel_hi:[1,0]
    v_pk_mul_f32 v[104:105], v[104:105], v[128:129] op_sel_hi:[1,0]
    v_pk_mul_f32 v[120:121], v[120:121], v[130:131] op_sel_hi:[1,0]
    v_pk_mul_f32 v[184:185], v[184:185], v[208:209] op_sel_hi:[1,0]
    v_pk_mul_f32 v[200:201], v[200:201], v[210:211] op_sel_hi:[1,0]
    v_pk_mul_f32 v[106:107], v[106:107], v[128:129] op_sel_hi:[1,0]
    v_pk_mul_f32 v[122:123], v[122:123], v[130:131] op_sel_hi:[1,0]
    v_pk_mul_f32 v[186:187], v[186:187], v[208:209] op_sel_hi:[1,0]
    v_pk_mul_f32 v[202:203], v[202:203], v[210:211] op_sel_hi:[1,0]
    v_pk_mul_f32 v[108:109], v[108:109], v[128:129] op_sel_hi:[1,0]
    v_pk_mul_f32 v[124:125], v[124:125], v[130:131] op_sel_hi:[1,0]
    v_pk_mul_f32 v[188:189], v[188:189], v[208:209] op_sel_hi:[1,0]
    v_pk_mul_f32 v[204:205], v[204:205], v[210:211] op_sel_hi:[1,0]
    v_pk_mul_f32 v[110:111], v[110:111], v[128:129] op_sel_hi:[1,0]
    v_pk_mul_f32 v[126:127], v[126:127], v[130:131] op_sel_hi:[1,0]
    v_pk_mul_f32 v[190:191], v[190:191], v[208:209] op_sel_hi:[1,0]
    v_pk_mul_f32 v[206:207], v[206:207], v[210:211] op_sel_hi:[1,0]
    v_cvt_pk_bf16_f32 v136, v96, v97
    v_cvt_pk_bf16_f32 v144, v112, v113
    v_cvt_pk_bf16_f32 v216, v176, v177
    v_cvt_pk_bf16_f32 v224, v192, v193
    v_cvt_pk_bf16_f32 v137, v98, v99
    v_cvt_pk_bf16_f32 v145, v114, v115
    v_cvt_pk_bf16_f32 v217, v178, v179
    v_cvt_pk_bf16_f32 v225, v194, v195
    v_cvt_pk_bf16_f32 v138, v100, v101
    v_cvt_pk_bf16_f32 v146, v116, v117
    v_cvt_pk_bf16_f32 v218, v180, v181
    v_cvt_pk_bf16_f32 v226, v196, v197
    v_cvt_pk_bf16_f32 v139, v102, v103
    v_cvt_pk_bf16_f32 v147, v118, v119
    v_cvt_pk_bf16_f32 v219, v182, v183
    v_cvt_pk_bf16_f32 v227, v198, v199
    v_cvt_pk_bf16_f32 v140, v104, v105
    v_cvt_pk_bf16_f32 v148, v120, v121
    v_cvt_pk_bf16_f32 v220, v184, v185
    v_cvt_pk_bf16_f32 v228, v200, v201
    v_cvt_pk_bf16_f32 v141, v106, v107
    v_cvt_pk_bf16_f32 v149, v122, v123
    v_cvt_pk_bf16_f32 v221, v186, v187
    v_cvt_pk_bf16_f32 v229, v202, v203
    v_cvt_pk_bf16_f32 v142, v108, v109
    v_cvt_pk_bf16_f32 v150, v124, v125
    v_cvt_pk_bf16_f32 v222, v188, v189
    v_cvt_pk_bf16_f32 v230, v204, v205
    v_cvt_pk_bf16_f32 v143, v110, v111
    v_cvt_pk_bf16_f32 v151, v126, v127
    v_cvt_pk_bf16_f32 v223, v190, v191
    v_cvt_pk_bf16_f32 v231, v206, v207
    v_mfma_f32_32x32x16_bf16 v[96:111], v[136:139], a[224:227], 0
    v_accvgpr_read_b32 v32, a0
    v_accvgpr_read_b32 v33, a1
    v_accvgpr_read_b32 v34, a2
    v_accvgpr_read_b32 v35, a3
    v_accvgpr_read_b32 v36, a4
    v_mfma_f32_32x32x16_bf16 v[112:127], v[144:147], a[224:227], 0
    v_accvgpr_read_b32 v37, a5
    v_accvgpr_read_b32 v38, a6
    v_accvgpr_read_b32 v39, a7
    v_accvgpr_read_b32 v40, a16
    v_accvgpr_read_b32 v41, a17
    v_mfma_f32_32x32x16_bf16 v[96:111], v[140:143], a[228:231], v[96:111]
    v_accvgpr_read_b32 v42, a18
    v_accvgpr_read_b32 v43, a19
    v_accvgpr_read_b32 v44, a20
    v_accvgpr_read_b32 v45, a21
    v_accvgpr_read_b32 v46, a22
    v_mfma_f32_32x32x16_bf16 v[112:127], v[148:151], a[228:231], v[112:127]
    v_accvgpr_read_b32 v47, a23
    v_cvt_pk_bf16_f32 v160, v32, v33
    v_cvt_pk_bf16_f32 v161, v34, v35
    v_cvt_pk_bf16_f32 v162, v36, v37
    v_cvt_pk_bf16_f32 v163, v38, v39
    v_mfma_f32_32x32x16_bf16 v[176:191], v[216:219], a[224:227], 0
    v_cvt_pk_bf16_f32 v164, v40, v41
    v_cvt_pk_bf16_f32 v165, v42, v43
    v_cvt_pk_bf16_f32 v166, v44, v45
    v_cvt_pk_bf16_f32 v167, v46, v47
    v_accvgpr_read_b32 v48, a8
    v_mfma_f32_32x32x16_bf16 v[192:207], v[224:227], a[224:227], 0
    v_accvgpr_read_b32 v49, a9
    v_accvgpr_read_b32 v50, a10
    v_accvgpr_read_b32 v51, a11
    v_accvgpr_read_b32 v52, a12
    v_accvgpr_read_b32 v53, a13
    v_mfma_f32_32x32x16_bf16 v[176:191], v[220:223], a[228:231], v[176:191]
    v_accvgpr_read_b32 v54, a14
    v_accvgpr_read_b32 v55, a15
    v_accvgpr_read_b32 v56, a24
    v_accvgpr_read_b32 v57, a25
    v_accvgpr_read_b32 v58, a26
    v_mfma_f32_32x32x16_bf16 v[192:207], v[228:231], a[228:231], v[192:207]
    v_accvgpr_read_b32 v59, a27
    v_accvgpr_read_b32 v60, a28
    v_accvgpr_read_b32 v61, a29
    v_accvgpr_read_b32 v62, a30
    v_accvgpr_read_b32 v63, a31
    v_cvt_pk_bf16_f32 v136, v96, v97
    v_cvt_pk_bf16_f32 v137, v98, v99
    v_cvt_pk_bf16_f32 v138, v100, v101
    v_cvt_pk_bf16_f32 v139, v102, v103
    v_cvt_pk_bf16_f32 v140, v104, v105
    v_cvt_pk_bf16_f32 v141, v106, v107
    v_cvt_pk_bf16_f32 v142, v108, v109
    v_cvt_pk_bf16_f32 v143, v110, v111
    v_cvt_pk_bf16_f32 v144, v112, v113
    v_cvt_pk_bf16_f32 v145, v114, v115
    v_cvt_pk_bf16_f32 v146, v116, v117
    v_cvt_pk_bf16_f32 v147, v118, v119
    v_cvt_pk_bf16_f32 v148, v120, v121
    v_cvt_pk_bf16_f32 v149, v122, v123
    v_cvt_pk_bf16_f32 v150, v124, v125
    v_cvt_pk_bf16_f32 v151, v126, v127
    v_mfma_f32_32x32x16_bf16 a[32:47], v[136:139], v[152:155], 0
    v_cvt_pk_bf16_f32 v216, v176, v177
    v_cvt_pk_bf16_f32 v217, v178, v179
    v_cvt_pk_bf16_f32 v218, v180, v181
    v_cvt_pk_bf16_f32 v219, v182, v183
    v_mfma_f32_32x32x16_bf16 a[48:63], v[144:147], v[152:155], 0
    v_cvt_pk_bf16_f32 v220, v184, v185
    v_cvt_pk_bf16_f32 v221, v186, v187
    v_cvt_pk_bf16_f32 v222, v188, v189
    v_cvt_pk_bf16_f32 v223, v190, v191
    v_mfma_f32_32x32x16_bf16 a[64:79], a[232:235], v[136:139], 0
    v_cvt_pk_bf16_f32 v224, v192, v193
    v_cvt_pk_bf16_f32 v225, v194, v195
    v_cvt_pk_bf16_f32 v226, v196, v197
    v_cvt_pk_bf16_f32 v227, v198, v199
    v_mfma_f32_32x32x16_bf16 a[80:95], a[232:235], v[144:147], 0
    v_cvt_pk_bf16_f32 v228, v200, v201
    v_cvt_pk_bf16_f32 v229, v202, v203
    v_cvt_pk_bf16_f32 v230, v204, v205
    v_cvt_pk_bf16_f32 v231, v206, v207
    v_mfma_f32_32x32x16_bf16 a[32:47], v[140:143], v[156:159], a[32:47]
    v_cvt_pk_bf16_f32 v240, v48, v49
    v_cvt_pk_bf16_f32 v241, v50, v51
    v_cvt_pk_bf16_f32 v242, v52, v53
    v_cvt_pk_bf16_f32 v243, v54, v55
    v_mfma_f32_32x32x16_bf16 a[48:63], v[148:151], v[156:159], a[48:63]
    v_cvt_pk_bf16_f32 v244, v56, v57
    v_cvt_pk_bf16_f32 v245, v58, v59
    v_cvt_pk_bf16_f32 v246, v60, v61
    v_cvt_pk_bf16_f32 v247, v62, v63
    v_mfma_f32_32x32x16_bf16 a[64:79], a[232:235], v[140:143], a[64:79]
    v_permlane16_swap_b32 v160, v162
    v_permlane16_swap_b32 v161, v163
    v_permlane16_swap_b32 v164, v166
    v_permlane16_swap_b32 v165, v167
    v_mfma_f32_32x32x16_bf16 a[80:95], a[232:235], v[148:151], a[80:95]
    v_permlane16_swap_b32 v240, v242
    v_permlane16_swap_b32 v241, v243
    v_permlane16_swap_b32 v244, v246
    v_permlane16_swap_b32 v245, v247
    v_mfma_f32_32x32x16_bf16 a[32:47], v[216:219], v[232:235], a[32:47]
    v_mfma_f32_32x32x16_bf16 a[48:63], v[224:227], v[232:235], a[48:63]
    v_mfma_f32_32x32x16_bf16 a[64:79], a[232:235], v[216:219], a[64:79]
    v_mfma_f32_32x32x16_bf16 a[80:95], a[232:235], v[224:227], a[80:95]
    v_mfma_f32_32x32x16_bf16 a[32:47], v[220:223], v[236:239], a[32:47]
    v_mfma_f32_32x32x16_bf16 a[48:63], v[228:231], v[236:239], a[48:63]
    v_mfma_f32_32x32x16_bf16 a[64:79], a[232:235], v[220:223], a[64:79]
    v_mfma_f32_32x32x16_bf16 a[80:95], a[232:235], v[228:231], a[80:95]
    v_mfma_f32_32x32x16_bf16 v[96:111], a[236:239], v[160:163], 0
    v_mfma_f32_32x32x16_bf16 v[176:191], a[236:239], v[240:243], 0
    v_mfma_f32_32x32x16_bf16 v[96:111], a[240:243], v[164:167], v[96:111]
    v_mfma_f32_32x32x16_bf16 v[176:191], a[240:243], v[244:247], v[176:191]
    s_nop 4
    ds_write_b128 v25, a[32:35] offset:0
    ds_write_b128 v25, a[36:39] offset:1024
    ds_write_b128 v25, a[40:43] offset:2048
    s_nop 2
    v_cvt_pk_bf16_f32 v96, 0, v96
    v_cvt_pk_bf16_f32 v176, 0, v176
    v_cvt_pk_bf16_f32 v97, 0, v97
    v_cvt_pk_bf16_f32 v177, 0, v177
    ds_write_b128 v25, a[44:47] offset:3072
    v_cvt_pk_bf16_f32 v98, 0, v98
    v_cvt_pk_bf16_f32 v178, 0, v178
    v_cvt_pk_bf16_f32 v99, 0, v99
    v_cvt_pk_bf16_f32 v179, 0, v179
    ds_write_b128 v25, a[48:51] offset:4096
    v_cvt_pk_bf16_f32 v100, 0, v100
    v_cvt_pk_bf16_f32 v180, 0, v180
    v_cvt_pk_bf16_f32 v101, 0, v101
    v_cvt_pk_bf16_f32 v181, 0, v181
    ds_write_b128 v25, a[52:55] offset:5120
    v_cvt_pk_bf16_f32 v102, 0, v102
    v_cvt_pk_bf16_f32 v182, 0, v182
    v_cvt_pk_bf16_f32 v103, 0, v103
    v_cvt_pk_bf16_f32 v183, 0, v183
    ds_write_b128 v25, a[56:59] offset:6144
    v_cvt_pk_bf16_f32 v104, 0, v104
    v_cvt_pk_bf16_f32 v184, 0, v184
    v_cvt_pk_bf16_f32 v105, 0, v105
    v_cvt_pk_bf16_f32 v185, 0, v185
    ds_write_b128 v25, a[60:63] offset:7168
    v_cvt_pk_bf16_f32 v106, 0, v106
    v_cvt_pk_bf16_f32 v186, 0, v186
    v_cvt_pk_bf16_f32 v107, 0, v107
    v_cvt_pk_bf16_f32 v187, 0, v187
    ds_write_b32 v27, a64
    ds_write_b32 v27, a80 offset:256
    v_cvt_pk_bf16_f32 v108, 0, v108
    v_cvt_pk_bf16_f32 v188, 0, v188
    v_cvt_pk_bf16_f32 v109, 0, v109
    v_cvt_pk_bf16_f32 v189, 0, v189
    v_cvt_pk_bf16_f32 v110, 0, v110
    v_cvt_pk_bf16_f32 v190, 0, v190
    v_cvt_pk_bf16_f32 v111, 0, v111
    v_cvt_pk_bf16_f32 v191, 0, v191
    v_max3_f32 v128, v96, v97, v98
    v_min3_f32 v130, v96, v97, v98
    v_max3_f32 v208, v176, v177, v178
    v_min3_f32 v210, v176, v177, v178
    s_waitcnt vmcnt(0) lgkmcnt(0)
    s_barrier
    s_mov_b32 s4, 0
recurrent_scan__linear_kernel_hedgehog__glu_gated_bilinear__prompt_kernel_pa:
    v_cmp_gt_u32 vcc, 32, v23
    s_nop 4
    s_cbranch_vccz recurrent_scan__linear_kernel_hedgehog__glu_gated_bilinear__prompt_kernel_pa_ok
    s_add_u32 s4, s4, 1
    s_cmp_ge_u32 s4, 200000
    s_cbranch_scc1 recurrent_scan__linear_kernel_hedgehog__glu_gated_bilinear__prompt_kernel_pa_ok
    s_add_u32 s82, s82, 1
    v_mov_b32 v23, s82
    s_mov_b64 exec, 1
    buffer_store_dword v23, v7, s[32:35], s83 offen sc1
    s_mov_b64 exec, -1
    buffer_load_dword v23, v22, s[12:15], 0 offen offset:4 sc1
    s_waitcnt vmcnt(0)
    s_branch recurrent_scan__linear_kernel_hedgehog__glu_gated_bilinear__prompt_kernel_pa
recurrent_scan__linear_kernel_hedgehog__glu_gated_bilinear__prompt_kernel_pa_ok:
    ds_read_b128 v[32:35], v28 offset:0
    ds_read_b128 v[36:39], v28 offset:1024
    ds_read_b128 v[40:43], v28 offset:8192
    ds_read_b128 v[44:47], v28 offset:9216
    ds_read_b128 v[48:51], v28 offset:16384
    ds_read_b128 v[52:55], v28 offset:17408
    ds_read_b128 v[56:59], v28 offset:24576
    ds_read_b128 v[60:63], v28 offset:25600
    ds_read_b32 v64, v29 offset:0
    ds_read_b32 v65, v29 offset:512
    ds_read_b32 v66, v29 offset:1024
    ds_read_b32 v67, v29 offset:1536
    v_max3_f32 v128, v128, v99, v100
    v_min3_f32 v130, v130, v99, v100
    v_max3_f32 v208, v208, v179, v180
    v_min3_f32 v210, v210, v179, v180
    v_max3_f32 v128, v128, v101, v102
    v_min3_f32 v130, v130, v101, v102
    v_max3_f32 v208, v208, v181, v182
    v_min3_f32 v210, v210, v181, v182
    v_max3_f32 v128, v128, v103, v104
    v_min3_f32 v130, v130, v103, v104
    v_max3_f32 v208, v208, v183, v184
    v_min3_f32 v210, v210, v183, v184
    v_max3_f32 v128, v128, v105, v106
    v_min3_f32 v130, v130, v105, v106
    v_max3_f32 v208, v208, v185, v186
    v_min3_f32 v210, v210, v185, v186
    v_max3_f32 v128, v128, v107, v108
    v_min3_f32 v130, v130, v107, v108
    v_max3_f32 v208, v208, v187, v188
    v_min3_f32 v210, v210, v187, v188
    s_waitcnt lgkmcnt(0)
    v_pk_add_f32 v[32:33], v[32:33], v[40:41]
    v_pk_add_f32 v[48:49], v[48:49], v[56:57]
    v_pk_add_f32 v[34:35], v[34:35], v[42:43]
    v_pk_add_f32 v[50:51], v[50:51], v[58:59]
    v_pk_add_f32 v[36:37], v[36:37], v[44:45]
    v_pk_add_f32 v[52:53], v[52:53], v[60:61]
    v_pk_add_f32 v[38:39], v[38:39], v[46:47]
    v_pk_add_f32 v[54:55], v[54:55], v[62:63]
    v_add_f32 v64, v64, v65
    v_add_f32 v66, v66, v67
    v_pk_add_f32 v[32:33], v[32:33], v[48:49]
    v_pk_add_f32 v[34:35], v[34:35], v[50:51]
    v_pk_add_f32 v[36:37], v[36:37], v[52:53]
    v_pk_add_f32 v[38:39], v[38:39], v[54:55]
    v_add_f32 v64, v64, v66
    v_cvt_pk_bf16_f32 v32, v32, v33
    v_cvt_pk_bf16_f32 v33, v34, v35
    v_cvt_pk_bf16_f32 v34, v36, v37
    v_cvt_pk_bf16_f32 v35, v38, v39
    v_min_u32 v32, s46, v32
    v_min_u32 v33, s46, v33
    v_min_u32 v34, s46, v34
    v_min_u32 v35, s46, v35
    v_min_u32 v64, s46, v64
    buffer_store_dwordx4 v[32:35], v7, s[32:35], s47 offen sc1
    s_cmp_lg_u32 s62, 0
    s_cbranch_scc1 recurrent_scan__linear_kernel_hedgehog__glu_gated_bilinear__prompt_kernel_nz
    buffer_store_dword v64, v26, s[32:35], s48 offen sc1
    v_mov_b32 v22, 0
    buffer_store_dword v22, v22, s[32:35], s48 offen offset:256 sc1
recurrent_scan__linear_kernel_hedgehog__glu_gated_bilinear__prompt_kernel_nz:
    v_mov_b32 v8, v64
    s_bfe_u32 s26, s2, 0x20001
    s_and_b32 s4, s2, 1
    s_lshl_b32 s4, s4, 2
    s_bfe_u32 s5, s2, 0x20003
    s_add_u32 s24, s4, s5
    s_lshr_b32 s25, s2, 5
    s_and_b32 s29, s26, 1
    s_lshl_b32 s4, s24, 9
    v_lshlrev_b32 v2, 12, v1
    v_add_u32 v2, s4, v2
    v_mov_b32 v3, 0x40000000
    v_cmp_gt_u32 vcc, 32, v1
    v_lshl_add_u32 v4, v1, 2, s4
    s_nop 0
    v_cndmask_b32 v254, v3, v4, vcc
    s_lshl_b32 s4, s26, 15
    v_add_u32 v2, s4, v2
    v_cmp_gt_u32 vcc, 8, v1
    s_nop 1
    v_cndmask_b32 v253, v3, v2, vcc
    s_sub_u32 s4, s48, 29360128
    s_xor_b32 s5, s4, 32768
    v_writelane_b32 v253, s5, 8
    s_xor_b32 s5, s4, 65536
    v_writelane_b32 v253, s5, 9
    s_xor_b32 s5, s4, 98304
    v_writelane_b32 v253, s5, 10
    s_mov_b32 s58, 29360128
    s_mov_b32 s8, s40
    s_and_b32 s9, s41, 0xffff
    s_mov_b32 s10, 7340032
    s_mov_b32 s11, 0x20000
    s_mul_i32 s28, s26, 1835008
    s_lshl_b32 s4, s62, 15
    s_add_u32 s28, s28, s4
    s_lshl_b32 s4, s25, 8
    s_add_u32 s28, s28, s4
    s_lshl_b32 s30, s62, 12
    v_lshrrev_b32 v2, 4, v1
    v_lshlrev_b32 v3, 1, v2
    v_and_b32 v4, 15, v1
    v_xor_b32 v3, v3, v4
    v_lshlrev_b32 v4, 11, v2
    v_lshl_add_u32 v168, v3, 4, v4
    v_add_u32 v169, 7168, v168
    v_xor_b32 v170, 128, v168
    v_add_u32 v171, 21504, v170
    v_add_u32 v170, 14336, v170
    s_lshl_b32 s5, s25, 1
    s_add_u32 s5, s5, s29
    s_lshl_b32 s5, s5, 7
    s_lshl_b32 s57, s62, 16
    s_add_u32 s57, s57, s5
    s_mov_b32 s20, s38
    s_and_b32 s21, s39, 0xffff
    s_mov_b32 s22, 2097152
    s_mov_b32 s23, 0x20000
    v_lshlrev_b32 v3, 1, v2
    v_and_b32 v4, 7, v1
    v_xor_b32 v3, v3, v4
    v_lshrrev_b32 v5, 3, v1
    v_lshlrev_b32 v5, 11, v5
    v_lshl_add_u32 v172, v3, 4, v5
    v_add_u32 v173, 15360, v172
    v_add_u32 v174, 30720, v172
    v_add_u32 v175, 46080, v172
    v_xor_b32 v3, v2, v4
    v_lshl_add_u32 v250, v3, 4, v5
    v_xor_b32 v251, 64, v250
    s_add_u32 s28, s28, 524288
    v_max3_f32 v128, v128, v109, v110
    v_min3_f32 v130, v130, v109, v110
    v_max3_f32 v208, v208, v189, v190
    v_min3_f32 v210, v210, v189, v190
    v_max_f32 v128, v128, v111
    v_min_f32 v130, v130, v111
    v_max_f32 v208, v208, v191
    v_min_f32 v210, v210, v191
    v_mov_b32 v129, v128
    v_mov_b32 v131, v130
    v_mov_b32 v209, v208
    v_mov_b32 v211, v210
    v_permlane32_swap_b32 v128, v129
    v_permlane32_swap_b32 v130, v131
    s_add_u32 m0, s30, 65536
    s_nop 0
    buffer_load_dwordx4 v172, s[20:23], s57 offen offset:0 lds
    v_permlane32_swap_b32 v208, v209
    v_permlane32_swap_b32 v210, v211
    v_max_f32 v128, v128, v129
    v_min_f32 v130, v130, v131
    v_max_f32 v208, v208, v209
    v_min_f32 v210, v210, v211
    v_mul_f32 v128, s44, v128
    v_mul_f32 v130, s44, v130
    v_mul_f32 v208, s44, v208
    v_mul_f32 v210, s44, v210
    v_pk_fma_f32 v[112:113], v[96:97], s[44:45], v[130:131] op_sel_hi:[1,1,0] neg_lo:[1,0,0] neg_hi:[1,0,0]
    v_pk_fma_f32 v[96:97], v[96:97], s[44:45], v[128:129] op_sel_hi:[1,1,0] neg_lo:[0,0,1] neg_hi:[0,0,1]
    v_pk_fma_f32 v[192:193], v[176:177], s[44:45], v[210:211] op_sel_hi:[1,1,0] neg_lo:[1,0,0] neg_hi:[1,0,0]
    v_pk_fma_f32 v[176:177], v[176:177], s[44:45], v[208:209] op_sel_hi:[1,1,0] neg_lo:[0,0,1] neg_hi:[0,0,1]
    buffer_load_dwordx4 v173, s[20:23], s57 offen offset:1024 lds
    v_pk_fma_f32 v[114:115], v[98:99], s[44:45], v[130:131] op_sel_hi:[1,1,0] neg_lo:[1,0,0] neg_hi:[1,0,0]
    v_pk_fma_f32 v[98:99], v[98:99], s[44:45], v[128:129] op_sel_hi:[1,1,0] neg_lo:[0,0,1] neg_hi:[0,0,1]
    v_pk_fma_f32 v[194:195], v[178:179], s[44:45], v[210:211] op_sel_hi:[1,1,0] neg_lo:[1,0,0] neg_hi:[1,0,0]
    v_pk_fma_f32 v[178:179], v[178:179], s[44:45], v[208:209] op_sel_hi:[1,1,0] neg_lo:[0,0,1] neg_hi:[0,0,1]
    v_pk_fma_f32 v[116:117], v[100:101], s[44:45], v[130:131] op_sel_hi:[1,1,0] neg_lo:[1,0,0] neg_hi:[1,0,0]
    v_pk_fma_f32 v[100:101], v[100:101], s[44:45], v[128:129] op_sel_hi:[1,1,0] neg_lo:[0,0,1] neg_hi:[0,0,1]
    v_pk_fma_f32 v[196:197], v[180:181], s[44:45], v[210:211] op_sel_hi:[1,1,0] neg_lo:[1,0,0] neg_hi:[1,0,0]
    v_pk_fma_f32 v[180:181], v[180:181], s[44:45], v[208:209] op_sel_hi:[1,1,0] neg_lo:[0,0,1] neg_hi:[0,0,1]
    v_pk_fma_f32 v[118:119], v[102:103], s[44:45], v[130:131] op_sel_hi:[1,1,0] neg_lo:[1,0,0] neg_hi:[1,0,0]
    v_pk_fma_f32 v[102:103], v[102:103], s[44:45], v[128:129] op_sel_hi:[1,1,0] neg_lo:[0,0,1] neg_hi:[0,0,1]
    v_pk_fma_f32 v[198:199], v[182:183], s[44:45], v[210:211] op_sel_hi:[1,1,0] neg_lo:[1,0,0] neg_hi:[1,0,0]
    v_pk_fma_f32 v[182:183], v[182:183], s[44:45], v[208:209] op_sel_hi:[1,1,0] neg_lo:[0,0,1] neg_hi:[0,0,1]
    v_pk_fma_f32 v[120:121], v[104:105], s[44:45], v[130:131] op_sel_hi:[1,1,0] neg_lo:[1,0,0] neg_hi:[1,0,0]
    v_pk_fma_f32 v[104:105], v[104:105], s[44:45], v[128:129] op_sel_hi:[1,1,0] neg_lo:[0,0,1] neg_hi:[0,0,1]
    buffer_load_dwordx4 v174, s[20:23], s57 offen offset:2048 lds
    v_pk_fma_f32 v[200:201], v[184:185], s[44:45], v[210:211] op_sel_hi:[1,1,0] neg_lo:[1,0,0] neg_hi:[1,0,0]
    v_pk_fma_f32 v[184:185], v[184:185], s[44:45], v[208:209] op_sel_hi:[1,1,0] neg_lo:[0,0,1] neg_hi:[0,0,1]
    v_pk_fma_f32 v[122:123], v[106:107], s[44:45], v[130:131] op_sel_hi:[1,1,0] neg_lo:[1,0,0] neg_hi:[1,0,0]
    v_pk_fma_f32 v[106:107], v[106:107], s[44:45], v[128:129] op_sel_hi:[1,1,0] neg_lo:[0,0,1] neg_hi:[0,0,1]
    v_pk_fma_f32 v[202:203], v[186:187], s[44:45], v[210:211] op_sel_hi:[1,1,0] neg_lo:[1,0,0] neg_hi:[1,0,0]
    v_pk_fma_f32 v[186:187], v[186:187], s[44:45], v[208:209] op_sel_hi:[1,1,0] neg_lo:[0,0,1] neg_hi:[0,0,1]
    v_pk_fma_f32 v[124:125], v[108:109], s[44:45], v[130:131] op_sel_hi:[1,1,0] neg_lo:[1,0,0] neg_hi:[1,0,0]
    v_pk_fma_f32 v[108:109], v[108:109], s[44:45], v[128:129] op_sel_hi:[1,1,0] neg_lo:[0,0,1] neg_hi:[0,0,1]
    v_pk_fma_f32 v[204:205], v[188:189], s[44:45], v[210:211] op_sel_hi:[1,1,0] neg_lo:[1,0,0] neg_hi:[1,0,0]
    v_pk_fma_f32 v[188:189], v[188:189], s[44:45], v[208:209] op_sel_hi:[1,1,0] neg_lo:[0,0,1] neg_hi:[0,0,1]
    v_pk_fma_f32 v[126:127], v[110:111], s[44:45], v[130:131] op_sel_hi:[1,1,0] neg_lo:[1,0,0] neg_hi:[1,0,0]
    v_pk_fma_f32 v[110:111], v[110:111], s[44:45], v[128:129] op_sel_hi:[1,1,0] neg_lo:[0,0,1] neg_hi:[0,0,1]
    v_pk_fma_f32 v[206:207], v[190:191], s[44:45], v[210:211] op_sel_hi:[1,1,0] neg_lo:[1,0,0] neg_hi:[1,0,0]
    v_pk_fma_f32 v[190:191], v[190:191], s[44:45], v[208:209] op_sel_hi:[1,1,0] neg_lo:[0,0,1] neg_hi:[0,0,1]
    buffer_load_dwordx4 v175, s[20:23], s57 offen offset:3072 lds
    s_add_u32 s57, s57, 0x40000
    v_exp_f32 v96, v96
    v_exp_f32 v112, v112
    v_exp_f32 v176, v176
    v_exp_f32 v192, v192
    v_exp_f32 v97, v97
    v_exp_f32 v113, v113
    v_exp_f32 v177, v177
    v_exp_f32 v193, v193
    v_exp_f32 v98, v98
    v_exp_f32 v114, v114
    v_exp_f32 v178, v178
    v_exp_f32 v194, v194
    v_exp_f32 v99, v99
    v_exp_f32 v115, v115
    s_add_u32 m0, s30, 81920
    s_nop 0
    buffer_load_dwordx4 v172, s[20:23], s57 offen offset:0 lds
    v_exp_f32 v179, v179
    v_exp_f32 v195, v195
    v_exp_f32 v100, v100
    v_exp_f32 v116, v116
    v_exp_f32 v180, v180
    v_exp_f32 v196, v196
    v_exp_f32 v101, v101
    v_exp_f32 v117, v117
    v_exp_f32 v181, v181
    v_exp_f32 v197, v197
    v_exp_f32 v102, v102
    v_exp_f32 v118, v118
    v_exp_f32 v182, v182
    v_exp_f32 v198, v198
    buffer_load_dwordx4 v173, s[20:23], s57 offen offset:1024 lds
    v_exp_f32 v103, v103
    v_exp_f32 v119, v119
    v_exp_f32 v183, v183
    v_exp_f32 v199, v199
    v_exp_f32 v104, v104
    v_exp_f32 v120, v120
    v_exp_f32 v184, v184
    v_exp_f32 v200, v200
    v_exp_f32 v105, v105
    v_exp_f32 v121, v121
    v_exp_f32 v185, v185
    v_exp_f32 v201, v201
    v_exp_f32 v106, v106
    v_exp_f32 v122, v122
    buffer_load_dwordx4 v174, s[20:23], s57 offen offset:2048 lds
    v_exp_f32 v186, v186
    v_exp_f32 v202, v202
    v_exp_f32 v107, v107
    v_exp_f32 v123, v123
    v_exp_f32 v187, v187
    v_exp_f32 v203, v203
    v_exp_f32 v108, v108
    v_exp_f32 v124, v124
    v_exp_f32 v188, v188
    v_exp_f32 v204, v204
    v_exp_f32 v109, v109
    v_exp_f32 v125, v125
    v_exp_f32 v189, v189
    v_exp_f32 v205, v205
    buffer_load_dwordx4 v175, s[20:23], s57 offen offset:3072 lds
    s_add_u32 s57, s57, 0x40000
    v_exp_f32 v110, v110
    v_exp_f32 v126, v126
    v_exp_f32 v190, v190
    v_exp_f32 v206, v206
    v_exp_f32 v111, v111
    v_exp_f32 v127, v127
    v_exp_f32 v191, v191
    v_exp_f32 v207, v207
    v_pk_add_f32 v[128:129], v[96:97], v[98:99]
    v_pk_add_f32 v[130:131], v[112:113], v[114:115]
    v_pk_add_f32 v[208:209], v[176:177], v[178:179]
    v_pk_add_f32 v[210:211], v[192:193], v[194:195]
    v_pk_add_f32 v[128:129], v[128:129], v[100:101]
    v_pk_add_f32 v[130:131], v[130:131], v[116:117]
    s_add_u32 m0, s30, 98304
    s_nop 0
    buffer_load_dwordx4 v172, s[20:23], s57 offen offset:0 lds
    v_pk_add_f32 v[208:209], v[208:209], v[180:181]
    v_pk_add_f32 v[210:211], v[210:211], v[196:197]
    v_pk_add_f32 v[128:129], v[128:129], v[102:103]
    v_pk_add_f32 v[130:131], v[130:131], v[118:119]
    v_pk_add_f32 v[208:209], v[208:209], v[182:183]
    v_pk_add_f32 v[210:211], v[210:211], v[198:199]
    v_pk_add_f32 v[128:129], v[128:129], v[104:105]
    v_pk_add_f32 v[130:131], v[130:131], v[120:121]
    v_pk_add_f32 v[208:209], v[208:209], v[184:185]
    v_pk_add_f32 v[210:211], v[210:211], v[200:201]
    v_pk_add_f32 v[128:129], v[128:129], v[106:107]
    v_pk_add_f32 v[130:131], v[130:131], v[122:123]
    v_pk_add_f32 v[208:209], v[208:209], v[186:187]
    v_pk_add_f32 v[210:211], v[210:211], v[202:203]
    buffer_load_dwordx4 v173, s[20:23], s57 offen offset:1024 lds
    v_pk_add_f32 v[128:129], v[128:129], v[108:109]
    v_pk_add_f32 v[130:131], v[130:131], v[124:125]
    v_pk_add_f32 v[208:209], v[208:209], v[188:189]
    v_pk_add_f32 v[210:211], v[210:211], v[204:205]
    v_pk_add_f32 v[128:129], v[128:129], v[110:111]
    v_pk_add_f32 v[130:131], v[130:131], v[126:127]
    v_pk_add_f32 v[208:209], v[208:209], v[190:191]
    v_pk_add_f32 v[210:211], v[210:211], v[206:207]
    v_add_f32 v128, v128, v129
    v_add_f32 v130, v130, v131
    v_add_f32 v208, v208, v209
    v_add_f32 v210, v210, v211
    v_mov_b32 v129, v128
    v_mov_b32 v131, v130
    buffer_load_dwordx4 v174, s[20:23], s57 offen offset:2048 lds
    v_mov_b32 v209, v208
    v_mov_b32 v211, v210
    v_permlane32_swap_b32 v128, v129
    v_permlane32_swap_b32 v130, v131
    v_permlane32_swap_b32 v208, v209
    v_permlane32_swap_b32 v210, v211
    v_add_f32 v128, v128, v129
    v_add_f32 v130, v130, v131
    v_add_f32 v208, v208, v209
    v_add_f32 v210, v210, v211
    v_rcp_f32 v130, v130
    v_rcp_f32 v210, v210
    v_mul_f32 v130, v130, v128
    v_mul_f32 v210, v210, v208
    buffer_load_dwordx4 v175, s[20:23], s57 offen offset:3072 lds
    s_add_u32 s57, s57, 0x40000
    v_pk_mul_f32 v[112:113], v[112:113], v[130:131] op_sel_hi:[1,0]
    v_pk_mul_f32 v[192:193], v[192:193], v[210:211] op_sel_hi:[1,0]
    v_pk_mul_f32 v[114:115], v[114:115], v[130:131] op_sel_hi:[1,0]
    v_pk_mul_f32 v[194:195], v[194:195], v[210:211] op_sel_hi:[1,0]
    v_pk_mul_f32 v[116:117], v[116:117], v[130:131] op_sel_hi:[1,0]
    v_pk_mul_f32 v[196:197], v[196:197], v[210:211] op_sel_hi:[1,0]
    v_pk_mul_f32 v[118:119], v[118:119], v[130:131] op_sel_hi:[1,0]
    v_pk_mul_f32 v[198:199], v[198:199], v[210:211] op_sel_hi:[1,0]
    v_pk_mul_f32 v[120:121], v[120:121], v[130:131] op_sel_hi:[1,0]
    v_pk_mul_f32 v[200:201], v[200:201], v[210:211] op_sel_hi:[1,0]
    v_pk_mul_f32 v[122:123], v[122:123], v[130:131] op_sel_hi:[1,0]
    v_pk_mul_f32 v[202:203], v[202:203], v[210:211] op_sel_hi:[1,0]
    v_pk_mul_f32 v[124:125], v[124:125], v[130:131] op_sel_hi:[1,0]
    v_pk_mul_f32 v[204:205], v[204:205], v[210:211] op_sel_hi:[1,0]
    s_xor_b32 s49, s47, 4096
    buffer_load_dwordx4 v[36:39], v7, s[32:35], s49 offen sc1
    v_pk_mul_f32 v[126:127], v[126:127], v[130:131] op_sel_hi:[1,0]
    v_pk_mul_f32 v[206:207], v[206:207], v[210:211] op_sel_hi:[1,0]
    v_cvt_pk_bf16_f32 v136, v96, v97
    s_xor_b32 s49, s48, 512
    buffer_load_dword v9, v26, s[32:35], s49 offen sc1
    v_cvt_pk_bf16_f32 v144, v112, v113
    v_cvt_pk_bf16_f32 v216, v176, v177
    v_cvt_pk_bf16_f32 v224, v192, v193
    s_xor_b32 s49, s47, 8192
    buffer_load_dwordx4 v[40:43], v7, s[32:35], s49 offen sc1
    v_cvt_pk_bf16_f32 v137, v98, v99
    v_cvt_pk_bf16_f32 v145, v114, v115
    v_cvt_pk_bf16_f32 v217, v178, v179
    s_xor_b32 s49, s48, 1024
    buffer_load_dword v10, v26, s[32:35], s49 offen sc1
    v_cvt_pk_bf16_f32 v225, v194, v195
    v_cvt_pk_bf16_f32 v138, v100, v101
    v_cvt_pk_bf16_f32 v146, v116, v117
    s_xor_b32 s49, s47, 12288
    buffer_load_dwordx4 v[44:47], v7, s[32:35], s49 offen sc1
    v_cvt_pk_bf16_f32 v218, v180, v181
    v_cvt_pk_bf16_f32 v226, v196, v197
    v_cvt_pk_bf16_f32 v139, v102, v103
    s_xor_b32 s49, s48, 1536
    buffer_load_dword v11, v26, s[32:35], s49 offen sc1
    v_cvt_pk_bf16_f32 v147, v118, v119
    v_cvt_pk_bf16_f32 v219, v182, v183
    v_cvt_pk_bf16_f32 v227, v198, v199
    s_xor_b32 s49, s47, 16384
    buffer_load_dwordx4 v[48:51], v7, s[32:35], s49 offen sc1
    v_cvt_pk_bf16_f32 v140, v104, v105
    v_cvt_pk_bf16_f32 v148, v120, v121
    v_cvt_pk_bf16_f32 v220, v184, v185
    s_xor_b32 s49, s48, 2048
    buffer_load_dword v12, v26, s[32:35], s49 offen sc1
    v_cvt_pk_bf16_f32 v228, v200, v201
    v_cvt_pk_bf16_f32 v141, v106, v107
    v_cvt_pk_bf16_f32 v149, v122, v123
    s_xor_b32 s49, s47, 20480
    buffer_load_dwordx4 v[52:55], v7, s[32:35], s49 offen sc1
    v_cvt_pk_bf16_f32 v221, v186, v187
    v_cvt_pk_bf16_f32 v229, v202, v203
    v_cvt_pk_bf16_f32 v142, v108, v109
    s_xor_b32 s49, s48, 2560
    buffer_load_dword v13, v26, s[32:35], s49 offen sc1
    v_cvt_pk_bf16_f32 v150, v124, v125
    v_cvt_pk_bf16_f32 v222, v188, v189
    v_cvt_pk_bf16_f32 v230, v204, v205
    s_xor_b32 s49, s47, 24576
    buffer_load_dwordx4 v[56:59], v7, s[32:35], s49 offen sc1
    v_cvt_pk_bf16_f32 v143, v110, v111
    v_cvt_pk_bf16_f32 v151, v126, v127
    v_cvt_pk_bf16_f32 v223, v190, v191
    s_xor_b32 s49, s48, 3072
    buffer_load_dword v14, v26, s[32:35], s49 offen sc1
    v_cvt_pk_bf16_f32 v231, v206, v207
    s_xor_b32 s49, s47, 28672
    buffer_load_dwordx4 v[60:63], v7, s[32:35], s49 offen sc1
    s_xor_b32 s49, s48, 3584
    buffer_load_dword v15, v26, s[32:35], s49 offen sc1
    buffer_load_dword v255, v253, s[32:35], s58 offen offset:256 sc1
    s_lshl_b32 s4, s24, 3
    s_and_b32 s5, s26, 2
    s_lshl_b32 s5, s5, 1
    s_add_u32 s4, s4, s5
    s_add_u32 s4, s4, s62
    s_lshl_b32 s53, s4, 12
    s_add_u32 s53, s53, 4194304
    s_mul_i32 s5, s26, 3670016
    s_add_u32 s27, s53, s5
    s_xor_b32 s31, s27, 0x4000
    s_add_u32 s53, s53, 14680064
    s_lshl_b32 s5, s25, 1
    s_add_u32 s5, s5, s29
    s_lshl_b32 s5, s5, 7
    s_lshl_b32 s54, s4, 16
    s_add_u32 s54, s54, s5
    s_mov_b32 s12, s36
    s_and_b32 s13, s37, 0xffff
    s_mov_b32 s14, 4194304
    s_mov_b32 s15, 0x20000
    s_mov_b32 s16, s42
    s_and_b32 s17, s43, 0xffff
    s_mov_b32 s18, 4194304
    s_mov_b32 s19, 0x20000
    s_lshl_b32 s4, s2, 2
    s_add_u32 s4, s4, s62
    s_lshl_b32 s52, s4, 10
    s_add_u32 s52, s52, 39845888
    v_bfe_u32 v3, v1, 2, 3
    v_lshrrev_b32 v4, 5, v1
    v_lshl_add_u32 v4, v4, 4, v3
    v_lshlrev_b32 v4, 7, v4
    v_lshrrev_b32 v5, 1, v3
    v_lshl_add_u32 v4, v5, 5, v4
    v_and_b32 v5, 3, v1
    v_lshl_add_u32 v160, v5, 3, v4
    v_xor_b32 v161, 32, v160
    v_xor_b32 v162, 64, v160
    v_xor_b32 v163, 96, v160
    v_add_u32 v164, 0x10000, v160
    v_add_u32 v165, 0x10000, v161
    v_add_u32 v166, 0x10000, v162
    v_add_u32 v167, 0x10000, v163
    v_bfe_u32 v4, v1, 2, 2
    v_lshl_add_u32 v4, v2, 3, v4
    v_lshlrev_b32 v4, 8, v4
    v_lshl_add_u32 v4, v3, 5, v4
    v_lshl_add_u32 v4, v5, 3, v4
    s_lshl_b32 s4, s29, 7
    v_xor_b32 v152, s4, v4
    v_xor_b32 v153, 32, v152
    v_xor_b32 v154, 64, v152
    v_xor_b32 v155, 96, v152
    v_xor_b32 v156, 128, v152
    v_xor_b32 v157, 160, v152
    v_xor_b32 v158, 192, v152
    v_xor_b32 v159, 224, v152
    v_and_b32 v3, 15, v1
    v_lshlrev_b32 v4, 2, v2
    v_sub_u32 v6, v3, v4
    v_mov_b32 v4, 0x3f80
    v_mov_b32 v5, 0x3f800000
    v_mov_b32 v240, 0
    v_mov_b32 v241, 0
    v_mov_b32 v244, 0
    v_mov_b32 v245, 0
    v_cmp_eq_u32 vcc, 0, v6
    v_cmp_eq_u32 s[4:5], 1, v6
    s_nop 0
    v_cndmask_b32 v242, 0, v4, vcc
    v_cndmask_b32 v242, v242, v5, s[4:5]
    v_cmp_eq_u32 vcc, 2, v6
    v_cmp_eq_u32 s[4:5], 3, v6
    s_nop 0
    v_cndmask_b32 v243, 0, v4, vcc
    v_cndmask_b32 v243, v243, v5, s[4:5]
    v_lshrrev_b32 v4, 1, v3
    v_lshrrev_b32 v5, 5, v1
    v_xor_b32 v4, v4, v5
    v_lshlrev_b32 v3, 7, v3
    v_lshl_add_u32 v3, v4, 4, v3
    v_bfe_u32 v4, v1, 4, 1
    v_lshl_add_u32 v3, v4, 3, v3
    s_add_u32 s4, s30, 131072
    v_add_u32 v246, s4, v3
    v_xor_b32 v247, 32, v246
    v_xor_b32 v248, 64, v246
    v_xor_b32 v249, 96, v246
    v_add_u32 v252, s4, v7
    s_lshl_b32 s3, s62, 10
    s_add_u32 s3, s3, 159744
    v_add_u32 v25, s3, v7
    v_lshlrev_b32 v27, 1, v1
    v_add_u32 v27, 122880, v27
    v_add_u32 v28, 159744, v7
    s_mov_b32 s50, 0
    s_waitcnt vmcnt(1)
recurrent_scan__linear_kernel_hedgehog__glu_gated_bilinear__prompt_kernel_chk:
    v_max3_u32 v20, v8, v9, v10
    v_max3_u32 v21, v11, v12, v13
    v_max3_u32 v20, v20, v14, v15
    v_max3_u32 v21, v21, v32, v33
    v_max3_u32 v20, v20, v34, v35
    v_max3_u32 v21, v21, v36, v37
    v_max3_u32 v20, v20, v38, v39
    v_max3_u32 v21, v21, v40, v41
    v_max3_u32 v20, v20, v42, v43
    v_max3_u32 v21, v21, v44, v45
    v_max3_u32 v20, v20, v46, v47
    v_max3_u32 v21, v21, v48, v49
    v_max3_u32 v20, v20, v50, v51
    v_max3_u32 v21, v21, v52, v53
    v_max3_u32 v20, v20, v54, v55
    v_max3_u32 v21, v21, v56, v57
    v_max3_u32 v20, v20, v58, v59
    v_max3_u32 v21, v21, v60, v61
    v_max3_u32 v20, v20, v62, v63
    v_max_u32 v20, v20, v21
    v_cmp_eq_u32 vcc, -1, v20
    s_nop 4
    s_cbranch_vccz recurrent_scan__linear_kernel_hedgehog__glu_gated_bilinear__prompt_kernel_got
    s_add_u32 s50, s50, 1
    s_cmp_ge_u32 s50, 200000
    s_cbranch_scc1 recurrent_scan__linear_kernel_hedgehog__glu_gated_bilinear__prompt_kernel_got
    s_xor_b32 s49, s47, 4096
    buffer_load_dwordx4 v[36:39], v7, s[32:35], s49 offen sc1
    s_xor_b32 s49, s48, 512
    buffer_load_dword v9, v26, s[32:35], s49 offen sc1
    s_xor_b32 s49, s47, 8192
    buffer_load_dwordx4 v[40:43], v7, s[32:35], s49 offen sc1
    s_xor_b32 s49, s48, 1024
    buffer_load_dword v10, v26, s[32:35], s49 offen sc1
    s_xor_b32 s49, s47, 12288
    buffer_load_dwordx4 v[44:47], v7, s[32:35], s49 offen sc1
    s_xor_b32 s49, s48, 1536
    buffer_load_dword v11, v26, s[32:35], s49 offen sc1
    s_xor_b32 s49, s47, 16384
    buffer_load_dwordx4 v[48:51], v7, s[32:35], s49 offen sc1
    s_xor_b32 s49, s48, 2048
    buffer_load_dword v12, v26, s[32:35], s49 offen sc1
    s_xor_b32 s49, s47, 20480
    buffer_load_dwordx4 v[52:55], v7, s[32:35], s49 offen sc1
    s_xor_b32 s49, s48, 2560
    buffer_load_dword v13, v26, s[32:35], s49 offen sc1
    s_xor_b32 s49, s47, 24576
    buffer_load_dwordx4 v[56:59], v7, s[32:35], s49 offen sc1
    s_xor_b32 s49, s48, 3072
    buffer_load_dword v14, v26, s[32:35], s49 offen sc1
    s_xor_b32 s49, s47, 28672
    buffer_load_dwordx4 v[60:63], v7, s[32:35], s49 offen sc1
    s_xor_b32 s49, s48, 3584
    buffer_load_dword v15, v26, s[32:35], s49 offen sc1
    s_waitcnt vmcnt(0)
    s_branch recurrent_scan__linear_kernel_hedgehog__glu_gated_bilinear__prompt_kernel_chk
recurrent_scan__linear_kernel_hedgehog__glu_gated_bilinear__prompt_kernel_got:
    s_waitcnt vmcnt(0)
    s_mov_b32 s4, 0
recurrent_scan__linear_kernel_hedgehog__glu_gated_bilinear__prompt_kernel_ph:
    v_cmp_ne_u32 vcc, 0, v255
    s_nop 4
    s_cbranch_vccz recurrent_scan__linear_kernel_hedgehog__glu_gated_bilinear__prompt_kernel_ph_ok
    s_add_u32 s4, s4, 1
    s_cmp_ge_u32 s4, 200000
    s_cbranch_scc1 recurrent_scan__linear_kernel_hedgehog__glu_gated_bilinear__prompt_kernel_ph_ok
    buffer_load_dword v255, v253, s[32:35], s58 offen offset:256 sc1
    s_waitcnt vmcnt(0)
    s_branch recurrent_scan__linear_kernel_hedgehog__glu_gated_bilinear__prompt_kernel_ph
recurrent_scan__linear_kernel_hedgehog__glu_gated_bilinear__prompt_kernel_ph_ok:
    v_mfma_f32_32x32x16_bf16 v[72:87], a[224:227], v[32:35], 0
    v_pk_add_f32 v[8:9], v[8:9], v[12:13]
    buffer_load_dwordx4 a[96:99], v7, s[32:35], s27 offen offset:0 sc1
    v_mfma_f32_32x32x16_bf16 v[72:87], a[224:227], v[36:39], v[72:87]
    v_pk_add_f32 v[10:11], v[10:11], v[14:15]
    buffer_load_dwordx4 a[100:103], v7, s[32:35], s27 offen offset:1024 sc1
    v_mfma_f32_32x32x16_bf16 v[72:87], a[224:227], v[40:43], v[72:87]
    v_pk_add_f32 v[8:9], v[8:9], v[10:11]
    buffer_load_dwordx4 a[104:107], v7, s[32:35], s27 offen offset:2048 sc1
    v_mfma_f32_32x32x16_bf16 v[72:87], a[224:227], v[44:47], v[72:87]
    v_add_f32 v8, v8, v9
    buffer_load_dwordx4 a[108:111], v7, s[32:35], s27 offen offset:3072 sc1
    s_add_u32 s27, s27, 0x40000
    v_mfma_f32_32x32x16_bf16 v[72:87], a[224:227], v[48:51], v[72:87]
    v_cvt_pk_bf16_f32 v8, v8, v8
    buffer_load_dwordx4 a[112:115], v7, s[32:35], s31 offen offset:0 sc1
    v_mfma_f32_32x32x16_bf16 v[72:87], a[224:227], v[52:55], v[72:87]
    ds_write_b16 v27, v8
    buffer_load_dwordx4 a[116:119], v7, s[32:35], s31 offen offset:1024 sc1
    v_mfma_f32_32x32x16_bf16 v[72:87], a[224:227], v[56:59], v[72:87]
    buffer_load_dwordx4 a[120:123], v7, s[32:35], s31 offen offset:2048 sc1
    v_mfma_f32_32x32x16_bf16 v[72:87], a[224:227], v[60:63], v[72:87]
    buffer_load_dwordx4 a[124:127], v7, s[32:35], s31 offen offset:3072 sc1
    s_add_u32 s31, s31, 0x40000
    s_nop 9
    v_cvt_pk_bf16_f32 v72, v72, v73
    v_cvt_pk_bf16_f32 v73, v74, v75
    v_cvt_pk_bf16_f32 v74, v76, v77
    v_cvt_pk_bf16_f32 v75, v78, v79
    ds_write_b128 v25, v[72:75]
    s_waitcnt lgkmcnt(0)
    s_barrier
    ds_read_b64 a[16:17], v30 offset:0
    ds_read_b64 a[18:19], v30 offset:16
    ds_read_b128 a[0:3], v28 offset:0
    ds_read_b64 a[20:21], v30 offset:32
    ds_read_b64 a[22:23], v30 offset:48
    ds_read_b128 a[4:7], v28 offset:1024
    ds_read_b64 a[24:25], v30 offset:64
    ds_read_b64 a[26:27], v30 offset:80
    ds_read_b128 a[8:11], v28 offset:2048
    ds_read_b64 a[28:29], v30 offset:96
    ds_read_b64 a[30:31], v30 offset:112
    ds_read_b128 a[12:15], v28 offset:3072
    s_waitcnt lgkmcnt(9)
    v_mfma_f32_32x32x16_bf16 v[112:127], a[16:19], v[136:139], 0
    buffer_load_dwordx4 a[128:131], v7, s[32:35], s27 offen offset:0 sc1
    v_mfma_f32_32x32x16_bf16 v[192:207], a[16:19], v[216:219], 0
    v_mfma_f32_32x32x16_bf16 v[96:111], a[0:3], v[136:139], 0
    buffer_load_dwordx4 a[132:135], v7, s[32:35], s27 offen offset:1024 sc1
    v_mfma_f32_32x32x16_bf16 v[176:191], a[0:3], v[216:219], 0
    s_waitcnt lgkmcnt(6)
    v_mfma_f32_32x32x16_bf16 v[112:127], a[20:23], v[140:143], v[112:127]
    buffer_load_dwordx4 a[136:139], v7, s[32:35], s27 offen offset:2048 sc1
    v_mfma_f32_32x32x16_bf16 v[192:207], a[20:23], v[220:223], v[192:207]
    v_mfma_f32_32x32x16_bf16 v[96:111], a[4:7], v[140:143], v[96:111]
    buffer_load_dwordx4 a[140:143], v7, s[32:35], s27 offen offset:3072 sc1
    s_add_u32 s27, s27, 0x40000
    v_mfma_f32_32x32x16_bf16 v[176:191], a[4:7], v[220:223], v[176:191]
    s_waitcnt lgkmcnt(3)
    v_mfma_f32_32x32x16_bf16 v[112:127], a[24:27], v[144:147], v[112:127]
    buffer_load_dwordx4 a[144:147], v7, s[32:35], s31 offen offset:0 sc1
    v_mfma_f32_32x32x16_bf16 v[192:207], a[24:27], v[224:227], v[192:207]
    v_mfma_f32_32x32x16_bf16 v[96:111], a[8:11], v[144:147], v[96:111]
    buffer_load_dwordx4 a[148:151], v7, s[32:35], s31 offen offset:1024 sc1
    v_mfma_f32_32x32x16_bf16 v[176:191], a[8:11], v[224:227], v[176:191]
    s_waitcnt lgkmcnt(0)
    v_mfma_f32_32x32x16_bf16 v[112:127], a[28:31], v[148:151], v[112:127]
    buffer_load_dwordx4 a[152:155], v7, s[32:35], s31 offen offset:2048 sc1
    v_mfma_f32_32x32x16_bf16 v[192:207], a[28:31], v[228:231], v[192:207]
    v_mfma_f32_32x32x16_bf16 v[96:111], a[12:15], v[148:151], v[96:111]
    buffer_load_dwordx4 a[156:159], v7, s[32:35], s31 offen offset:3072 sc1
    s_add_u32 s31, s31, 0x40000
    v_mfma_f32_32x32x16_bf16 v[176:191], a[12:15], v[228:231], v[176:191]
    s_nop 5
    v_fmac_f32 v112, 0x358637bd, v128
    v_rcp_f32 v112, v112
    v_fmac_f32 v192, 0x358637bd, v208
    v_rcp_f32 v192, v192
    v_mul_f32 v96, v96, v112
    v_mul_f32 v97, v97, v112
    v_mul_f32 v98, v98, v112
    v_mul_f32 v99, v99, v112
    v_mul_f32 v100, v100, v112
    v_mul_f32 v101, v101, v112
    v_mul_f32 v102, v102, v112
    v_mul_f32 v103, v103, v112
    v_cvt_pk_bf16_f32 v128, v96, v97
    v_cvt_pk_bf16_f32 v129, v98, v99
    v_cvt_pk_bf16_f32 v130, v100, v101
    v_cvt_pk_bf16_f32 v131, v102, v103
    buffer_store_dwordx4 v[128:131], v18, s[32:35], s85 offen offset:0 sc1
    v_mul_f32 v104, v104, v112
    v_mul_f32 v105, v105, v112
    v_mul_f32 v106, v106, v112
    v_mul_f32 v107, v107, v112
    v_mul_f32 v108, v108, v112
    v_mul_f32 v109, v109, v112
    v_mul_f32 v110, v110, v112
    v_mul_f32 v111, v111, v112
    v_cvt_pk_bf16_f32 v132, v104, v105
    v_cvt_pk_bf16_f32 v133, v106, v107
    v_cvt_pk_bf16_f32 v134, v108, v109
    v_cvt_pk_bf16_f32 v135, v110, v111
    buffer_store_dwordx4 v[132:135], v18, s[32:35], s85 offen offset:512 sc1
    v_mul_f32 v176, v176, v192
    v_mul_f32 v177, v177, v192
    v_mul_f32 v178, v178, v192
    v_mul_f32 v179, v179, v192
    v_mul_f32 v180, v180, v192
    v_mul_f32 v181, v181, v192
    v_mul_f32 v182, v182, v192
    v_mul_f32 v183, v183, v192
    v_cvt_pk_bf16_f32 v208, v176, v177
    v_cvt_pk_bf16_f32 v209, v178, v179
    v_cvt_pk_bf16_f32 v210, v180, v181
    v_cvt_pk_bf16_f32 v211, v182, v183
    buffer_store_dwordx4 v[208:211], v31, s[32:35], s85 offen offset:0 sc1
    v_mul_f32 v184, v184, v192
    v_mul_f32 v185, v185, v192
    v_mul_f32 v186, v186, v192
    v_mul_f32 v187, v187, v192
    v_mul_f32 v188, v188, v192
    v_mul_f32 v189, v189, v192
    v_mul_f32 v190, v190, v192
    v_mul_f32 v191, v191, v192
    v_cvt_pk_bf16_f32 v212, v184, v185
    v_cvt_pk_bf16_f32 v213, v186, v187
    v_cvt_pk_bf16_f32 v214, v188, v189
    v_cvt_pk_bf16_f32 v215, v190, v191
    buffer_store_dwordx4 v[212:215], v31, s[32:35], s85 offen offset:512 sc1
    v_mov_b32 v2, 0
    ds_read_b64_tr_b16 v[176:177], v152 offset:0
    ds_read_b64_tr_b16 v[178:179], v152 offset:1024
    ds_read_b64_tr_b16 v[180:181], v152 offset:8192
    ds_read_b64_tr_b16 v[182:183], v152 offset:9216
    ds_read_b64_tr_b16 v[184:185], v153 offset:0
    ds_read_b64_tr_b16 v[186:187], v153 offset:1024
    ds_read_b64_tr_b16 v[188:189], v153 offset:8192
    ds_read_b64_tr_b16 v[190:191], v153 offset:9216
    ds_read_b64_tr_b16 v[192:193], v154 offset:0
    ds_read_b64_tr_b16 v[194:195], v154 offset:1024
    ds_read_b64_tr_b16 v[196:197], v154 offset:8192
    ds_read_b64_tr_b16 v[198:199], v154 offset:9216
    s_waitcnt vmcnt(12) lgkmcnt(8)
    v_mfma_f32_16x16x32_bf16 v[16:19], v[176:179], a[96:99], 0
    ds_read_b64_tr_b16 v[200:201], v155 offset:0
    v_mfma_f32_16x16x32_bf16 v[16:19], v[180:183], a[104:107], v[16:19]
    ds_read_b64_tr_b16 v[202:203], v155 offset:1024
    v_mfma_f32_16x16x32_bf16 v[24:27], v[176:179], a[100:103], 0
    ds_read_b64_tr_b16 v[204:205], v155 offset:8192
    v_mfma_f32_16x16x32_bf16 v[24:27], v[180:183], a[108:111], v[24:27]
    ds_read_b64_tr_b16 v[206:207], v155 offset:9216
    v_mfma_f32_16x16x32_bf16 v[80:83], v[176:179], a[112:115], 0
    buffer_load_dwordx4 a[160:163], v7, s[32:35], s27 offen offset:0 sc1
    v_mfma_f32_16x16x32_bf16 v[80:83], v[180:183], a[120:123], v[80:83]
    v_mfma_f32_16x16x32_bf16 v[88:91], v[176:179], a[116:119], 0
    buffer_load_dwordx4 a[164:167], v7, s[32:35], s27 offen offset:1024 sc1
    v_mfma_f32_16x16x32_bf16 v[88:91], v[180:183], a[124:127], v[88:91]
    s_waitcnt lgkmcnt(8)
    v_mfma_f32_16x16x32_bf16 v[20:23], v[184:187], a[96:99], 0
    ds_read_b64_tr_b16 v[176:177], v156 offset:0
    v_mfma_f32_16x16x32_bf16 v[20:23], v[188:191], a[104:107], v[20:23]
    ds_read_b64_tr_b16 v[178:179], v156 offset:1024
    v_mfma_f32_16x16x32_bf16 v[28:31], v[184:187], a[100:103], 0
    ds_read_b64_tr_b16 v[180:181], v156 offset:8192
    v_mfma_f32_16x16x32_bf16 v[28:31], v[188:191], a[108:111], v[28:31]
    ds_read_b64_tr_b16 v[182:183], v156 offset:9216
    v_mfma_f32_16x16x32_bf16 v[84:87], v[184:187], a[112:115], 0
    buffer_load_dwordx4 a[168:171], v7, s[32:35], s27 offen offset:2048 sc1
    v_mfma_f32_16x16x32_bf16 v[84:87], v[188:191], a[120:123], v[84:87]
    v_mfma_f32_16x16x32_bf16 v[92:95], v[184:187], a[116:119], 0
    buffer_load_dwordx4 a[172:175], v7, s[32:35], s27 offen offset:3072 sc1
    s_add_u32 s27, s27, 0x40000
    v_mfma_f32_16x16x32_bf16 v[92:95], v[188:191], a[124:127], v[92:95]
    s_waitcnt lgkmcnt(8)
    v_mfma_f32_16x16x32_bf16 v[32:35], v[192:195], a[96:99], 0
    ds_read_b64_tr_b16 v[184:185], v157 offset:0
    v_mfma_f32_16x16x32_bf16 v[32:35], v[196:199], a[104:107], v[32:35]
    ds_read_b64_tr_b16 v[186:187], v157 offset:1024
    v_mfma_f32_16x16x32_bf16 v[40:43], v[192:195], a[100:103], 0
    ds_read_b64_tr_b16 v[188:189], v157 offset:8192
    v_mfma_f32_16x16x32_bf16 v[40:43], v[196:199], a[108:111], v[40:43]
    ds_read_b64_tr_b16 v[190:191], v157 offset:9216
    v_mfma_f32_16x16x32_bf16 v[96:99], v[192:195], a[112:115], 0
    buffer_load_dwordx4 a[176:179], v7, s[32:35], s31 offen offset:0 sc1
    v_mfma_f32_16x16x32_bf16 v[96:99], v[196:199], a[120:123], v[96:99]
    v_mfma_f32_16x16x32_bf16 v[104:107], v[192:195], a[116:119], 0
    buffer_load_dwordx4 a[180:183], v7, s[32:35], s31 offen offset:1024 sc1
    v_mfma_f32_16x16x32_bf16 v[104:107], v[196:199], a[124:127], v[104:107]
    s_waitcnt lgkmcnt(8)
    v_mfma_f32_16x16x32_bf16 v[36:39], v[200:203], a[96:99], 0
    ds_read_b64_tr_b16 v[192:193], v158 offset:0
    v_mfma_f32_16x16x32_bf16 v[36:39], v[204:207], a[104:107], v[36:39]
    ds_read_b64_tr_b16 v[194:195], v158 offset:1024
    v_mfma_f32_16x16x32_bf16 v[44:47], v[200:203], a[100:103], 0
    ds_read_b64_tr_b16 v[196:197], v158 offset:8192
    v_mfma_f32_16x16x32_bf16 v[44:47], v[204:207], a[108:111], v[44:47]
    ds_read_b64_tr_b16 v[198:199], v158 offset:9216
    v_mfma_f32_16x16x32_bf16 v[100:103], v[200:203], a[112:115], 0
    buffer_load_dwordx4 a[184:187], v7, s[32:35], s31 offen offset:2048 sc1
    v_mfma_f32_16x16x32_bf16 v[100:103], v[204:207], a[120:123], v[100:103]
    v_mfma_f32_16x16x32_bf16 v[108:111], v[200:203], a[116:119], 0
    buffer_load_dwordx4 a[188:191], v7, s[32:35], s31 offen offset:3072 sc1
    s_add_u32 s31, s31, 0x40000
    v_mfma_f32_16x16x32_bf16 v[108:111], v[204:207], a[124:127], v[108:111]
    s_waitcnt lgkmcnt(8)
    v_mfma_f32_16x16x32_bf16 v[48:51], v[176:179], a[96:99], 0
    ds_read_b64_tr_b16 v[200:201], v159 offset:0
    v_mfma_f32_16x16x32_bf16 v[48:51], v[180:183], a[104:107], v[48:51]
    ds_read_b64_tr_b16 v[202:203], v159 offset:1024
    v_mfma_f32_16x16x32_bf16 v[56:59], v[176:179], a[100:103], 0
    ds_read_b64_tr_b16 v[204:205], v159 offset:8192
    v_mfma_f32_16x16x32_bf16 v[56:59], v[180:183], a[108:111], v[56:59]
    ds_read_b64_tr_b16 v[206:207], v159 offset:9216
    v_mfma_f32_16x16x32_bf16 v[112:115], v[176:179], a[112:115], 0
    v_mfma_f32_16x16x32_bf16 v[112:115], v[180:183], a[120:123], v[112:115]
    v_mfma_f32_16x16x32_bf16 v[120:123], v[176:179], a[116:119], 0
    v_mfma_f32_16x16x32_bf16 v[120:123], v[180:183], a[124:127], v[120:123]
    s_waitcnt lgkmcnt(8)
    v_mfma_f32_16x16x32_bf16 v[52:55], v[184:187], a[96:99], 0
    v_mfma_f32_16x16x32_bf16 v[52:55], v[188:191], a[104:107], v[52:55]
    v_mfma_f32_16x16x32_bf16 v[60:63], v[184:187], a[100:103], 0
    s_waitcnt vmcnt(33) lgkmcnt(0)
    s_barrier
    v_mfma_f32_16x16x32_bf16 v[60:63], v[188:191], a[108:111], v[60:63]
    ds_read_b64_tr_b16 v[176:177], v152 offset:16384
    ds_read_b64_tr_b16 v[178:179], v152 offset:17408
    v_mfma_f32_16x16x32_bf16 v[116:119], v[184:187], a[112:115], 0
    ds_read_b64_tr_b16 v[180:181], v152 offset:24576
    ds_read_b64_tr_b16 v[182:183], v152 offset:25600
    v_mfma_f32_16x16x32_bf16 v[116:119], v[188:191], a[120:123], v[116:119]
    s_add_u32 m0, s30, 0
    s_nop 0
    buffer_load_dwordx4 v168, s[8:11], s28 offen offset:0 lds
    v_mfma_f32_16x16x32_bf16 v[124:127], v[184:187], a[116:119], 0
    v_mfma_f32_16x16x32_bf16 v[124:127], v[188:191], a[124:127], v[124:127]
    buffer_load_dwordx4 v169, s[8:11], s28 offen offset:1024 lds
    v_mfma_f32_16x16x32_bf16 v[64:67], v[192:195], a[96:99], 0
    ds_read_b64_tr_b16 v[184:185], v153 offset:16384
    v_mfma_f32_16x16x32_bf16 v[64:67], v[196:199], a[104:107], v[64:67]
    ds_read_b64_tr_b16 v[186:187], v153 offset:17408
    v_mfma_f32_16x16x32_bf16 v[72:75], v[192:195], a[100:103], 0
    ds_read_b64_tr_b16 v[188:189], v153 offset:24576
    v_mfma_f32_16x16x32_bf16 v[72:75], v[196:199], a[108:111], v[72:75]
    ds_read_b64_tr_b16 v[190:191], v153 offset:25600
    v_mfma_f32_16x16x32_bf16 v[128:131], v[192:195], a[112:115], 0
    buffer_load_dwordx4 v170, s[8:11], s28 offen offset:2048 lds
    v_mfma_f32_16x16x32_bf16 v[128:131], v[196:199], a[120:123], v[128:131]
    v_mfma_f32_16x16x32_bf16 v[136:139], v[192:195], a[116:119], 0
    buffer_load_dwordx4 v171, s[8:11], s28 offen offset:3072 lds
    s_add_u32 s28, s28, 0x20000
    v_mfma_f32_16x16x32_bf16 v[136:139], v[196:199], a[124:127], v[136:139]
    v_mfma_f32_16x16x32_bf16 v[68:71], v[200:203], a[96:99], 0
    ds_read_b64_tr_b16 v[192:193], v154 offset:16384
    v_mfma_f32_16x16x32_bf16 v[68:71], v[204:207], a[104:107], v[68:71]
    ds_read_b64_tr_b16 v[194:195], v154 offset:17408
    v_mfma_f32_16x16x32_bf16 v[76:79], v[200:203], a[100:103], 0
    ds_read_b64_tr_b16 v[196:197], v154 offset:24576
    v_mfma_f32_16x16x32_bf16 v[76:79], v[204:207], a[108:111], v[76:79]
    ds_read_b64_tr_b16 v[198:199], v154 offset:25600
    v_mfma_f32_16x16x32_bf16 v[132:135], v[200:203], a[112:115], 0
    s_add_u32 m0, s30, 114688
    s_nop 0
    buffer_load_dwordx4 v172, s[20:23], s57 offen offset:0 lds
    v_mfma_f32_16x16x32_bf16 v[132:135], v[204:207], a[120:123], v[132:135]
    v_mfma_f32_16x16x32_bf16 v[140:143], v[200:203], a[116:119], 0
    buffer_load_dwordx4 v173, s[20:23], s57 offen offset:1024 lds
    v_mfma_f32_16x16x32_bf16 v[140:143], v[204:207], a[124:127], v[140:143]
    s_waitcnt vmcnt(18) lgkmcnt(8)
    v_mfma_f32_16x16x32_bf16 v[16:19], v[176:179], a[128:131], v[16:19]
    ds_read_b64_tr_b16 v[200:201], v155 offset:16384
    v_mfma_f32_16x16x32_bf16 v[16:19], v[180:183], a[136:139], v[16:19]
    ds_read_b64_tr_b16 v[202:203], v155 offset:17408
    v_mfma_f32_16x16x32_bf16 v[24:27], v[176:179], a[132:135], v[24:27]
    ds_read_b64_tr_b16 v[204:205], v155 offset:24576
    v_mfma_f32_16x16x32_bf16 v[24:27], v[180:183], a[140:143], v[24:27]
    ds_read_b64_tr_b16 v[206:207], v155 offset:25600
    v_mfma_f32_16x16x32_bf16 v[80:83], v[176:179], a[144:147], v[80:83]
    buffer_load_dwordx4 a[96:99], v7, s[32:35], s27 offen offset:0 sc1
    v_mfma_f32_16x16x32_bf16 v[80:83], v[180:183], a[152:155], v[80:83]
    v_mfma_f32_16x16x32_bf16 v[88:91], v[176:179], a[148:151], v[88:91]
    buffer_load_dwordx4 a[100:103], v7, s[32:35], s27 offen offset:1024 sc1
    v_mfma_f32_16x16x32_bf16 v[88:91], v[180:183], a[156:159], v[88:91]
    s_waitcnt lgkmcnt(8)
    v_mfma_f32_16x16x32_bf16 v[20:23], v[184:187], a[128:131], v[20:23]
    ds_read_b64_tr_b16 v[176:177], v156 offset:16384
    v_mfma_f32_16x16x32_bf16 v[20:23], v[188:191], a[136:139], v[20:23]
    ds_read_b64_tr_b16 v[178:179], v156 offset:17408
    v_mfma_f32_16x16x32_bf16 v[28:31], v[184:187], a[132:135], v[28:31]
    ds_read_b64_tr_b16 v[180:181], v156 offset:24576
    v_mfma_f32_16x16x32_bf16 v[28:31], v[188:191], a[140:143], v[28:31]
    ds_read_b64_tr_b16 v[182:183], v156 offset:25600
    v_mfma_f32_16x16x32_bf16 v[84:87], v[184:187], a[144:147], v[84:87]
    buffer_load_dwordx4 a[104:107], v7, s[32:35], s27 offen offset:2048 sc1
    v_mfma_f32_16x16x32_bf16 v[84:87], v[188:191], a[152:155], v[84:87]
    v_mfma_f32_16x16x32_bf16 v[92:95], v[184:187], a[148:151], v[92:95]
    buffer_load_dwordx4 a[108:111], v7, s[32:35], s27 offen offset:3072 sc1
    s_add_u32 s27, s27, 0x40000
    v_mfma_f32_16x16x32_bf16 v[92:95], v[188:191], a[156:159], v[92:95]
    s_waitcnt lgkmcnt(8)
    v_mfma_f32_16x16x32_bf16 v[32:35], v[192:195], a[128:131], v[32:35]
    ds_read_b64_tr_b16 v[184:185], v157 offset:16384
    v_mfma_f32_16x16x32_bf16 v[32:35], v[196:199], a[136:139], v[32:35]
    ds_read_b64_tr_b16 v[186:187], v157 offset:17408
    v_mfma_f32_16x16x32_bf16 v[40:43], v[192:195], a[132:135], v[40:43]
    ds_read_b64_tr_b16 v[188:189], v157 offset:24576
    v_mfma_f32_16x16x32_bf16 v[40:43], v[196:199], a[140:143], v[40:43]
    ds_read_b64_tr_b16 v[190:191], v157 offset:25600
    v_mfma_f32_16x16x32_bf16 v[96:99], v[192:195], a[144:147], v[96:99]
    buffer_load_dwordx4 a[112:115], v7, s[32:35], s31 offen offset:0 sc1
    v_mfma_f32_16x16x32_bf16 v[96:99], v[196:199], a[152:155], v[96:99]
    v_mfma_f32_16x16x32_bf16 v[104:107], v[192:195], a[148:151], v[104:107]
    buffer_load_dwordx4 a[116:119], v7, s[32:35], s31 offen offset:1024 sc1
    v_mfma_f32_16x16x32_bf16 v[104:107], v[196:199], a[156:159], v[104:107]
    s_waitcnt lgkmcnt(8)
    v_mfma_f32_16x16x32_bf16 v[36:39], v[200:203], a[128:131], v[36:39]
    ds_read_b64_tr_b16 v[192:193], v158 offset:16384
    v_mfma_f32_16x16x32_bf16 v[36:39], v[204:207], a[136:139], v[36:39]
    ds_read_b64_tr_b16 v[194:195], v158 offset:17408
    v_mfma_f32_16x16x32_bf16 v[44:47], v[200:203], a[132:135], v[44:47]
    ds_read_b64_tr_b16 v[196:197], v158 offset:24576
    v_mfma_f32_16x16x32_bf16 v[44:47], v[204:207], a[140:143], v[44:47]
    ds_read_b64_tr_b16 v[198:199], v158 offset:25600
    v_mfma_f32_16x16x32_bf16 v[100:103], v[200:203], a[144:147], v[100:103]
    buffer_load_dwordx4 a[120:123], v7, s[32:35], s31 offen offset:2048 sc1
    v_mfma_f32_16x16x32_bf16 v[100:103], v[204:207], a[152:155], v[100:103]
    v_mfma_f32_16x16x32_bf16 v[108:111], v[200:203], a[148:151], v[108:111]
    buffer_load_dwordx4 a[124:127], v7, s[32:35], s31 offen offset:3072 sc1
    s_add_u32 s31, s31, 0x40000
    v_mfma_f32_16x16x32_bf16 v[108:111], v[204:207], a[156:159], v[108:111]
    s_waitcnt lgkmcnt(8)
    v_mfma_f32_16x16x32_bf16 v[48:51], v[176:179], a[128:131], v[48:51]
    ds_read_b64_tr_b16 v[200:201], v159 offset:16384
    v_mfma_f32_16x16x32_bf16 v[48:51], v[180:183], a[136:139], v[48:51]
    ds_read_b64_tr_b16 v[202:203], v159 offset:17408
    v_mfma_f32_16x16x32_bf16 v[56:59], v[176:179], a[132:135], v[56:59]
    ds_read_b64_tr_b16 v[204:205], v159 offset:24576
    v_mfma_f32_16x16x32_bf16 v[56:59], v[180:183], a[140:143], v[56:59]
    ds_read_b64_tr_b16 v[206:207], v159 offset:25600
    v_mfma_f32_16x16x32_bf16 v[112:115], v[176:179], a[144:147], v[112:115]
    buffer_load_dwordx4 v174, s[20:23], s57 offen offset:2048 lds
    v_mfma_f32_16x16x32_bf16 v[112:115], v[180:183], a[152:155], v[112:115]
    v_mfma_f32_16x16x32_bf16 v[120:123], v[176:179], a[148:151], v[120:123]
    buffer_load_dwordx4 v175, s[20:23], s57 offen offset:3072 lds
    s_add_u32 s57, s57, 0x40000
    v_mfma_f32_16x16x32_bf16 v[120:123], v[180:183], a[156:159], v[120:123]
    s_waitcnt lgkmcnt(8)
    v_mfma_f32_16x16x32_bf16 v[52:55], v[184:187], a[128:131], v[52:55]
    v_mfma_f32_16x16x32_bf16 v[52:55], v[188:191], a[136:139], v[52:55]
    v_mfma_f32_16x16x32_bf16 v[60:63], v[184:187], a[132:135], v[60:63]
    s_waitcnt vmcnt(24) lgkmcnt(0)
    s_barrier
    s_cmp_lg_u32 s62, 0
    s_cbranch_scc1 recurrent_scan__linear_kernel_hedgehog__glu_gated_bilinear__prompt_kernel_nf
    s_lshl_b32 s4, s64, 9
    s_lshl_b32 s5, s63, 2
    s_add_u32 s4, s4, s5
    s_add_u32 s4, s4, 29360128
    buffer_store_dword v2, v2, s[32:35], s4 offen offset:384 sc1
recurrent_scan__linear_kernel_hedgehog__glu_gated_bilinear__prompt_kernel_nf:
    v_mfma_f32_16x16x32_bf16 v[60:63], v[188:191], a[140:143], v[60:63]
    ds_read_b64_tr_b16 v[176:177], v152 offset:32768
    ds_read_b64_tr_b16 v[178:179], v152 offset:33792
    v_mfma_f32_16x16x32_bf16 v[116:119], v[184:187], a[144:147], v[116:119]
    ds_read_b64_tr_b16 v[180:181], v152 offset:40960
    ds_read_b64_tr_b16 v[182:183], v152 offset:41984
    v_mfma_f32_16x16x32_bf16 v[116:119], v[188:191], a[152:155], v[116:119]
    s_add_u32 m0, s30, 16384
    s_nop 0
    buffer_load_dwordx4 v168, s[8:11], s28 offen offset:0 lds
    v_mfma_f32_16x16x32_bf16 v[124:127], v[184:187], a[148:151], v[124:127]
    v_mfma_f32_16x16x32_bf16 v[124:127], v[188:191], a[156:159], v[124:127]
    buffer_load_dwordx4 v169, s[8:11], s28 offen offset:1024 lds
    v_mfma_f32_16x16x32_bf16 v[64:67], v[192:195], a[128:131], v[64:67]
    ds_read_b64_tr_b16 v[184:185], v153 offset:32768
    v_mfma_f32_16x16x32_bf16 v[64:67], v[196:199], a[136:139], v[64:67]
    ds_read_b64_tr_b16 v[186:187], v153 offset:33792
    v_mfma_f32_16x16x32_bf16 v[72:75], v[192:195], a[132:135], v[72:75]
    ds_read_b64_tr_b16 v[188:189], v153 offset:40960
    v_mfma_f32_16x16x32_bf16 v[72:75], v[196:199], a[140:143], v[72:75]
    ds_read_b64_tr_b16 v[190:191], v153 offset:41984
    v_mfma_f32_16x16x32_bf16 v[128:131], v[192:195], a[144:147], v[128:131]
    buffer_load_dwordx4 v170, s[8:11], s28 offen offset:2048 lds
    v_mfma_f32_16x16x32_bf16 v[128:131], v[196:199], a[152:155], v[128:131]
    v_mfma_f32_16x16x32_bf16 v[136:139], v[192:195], a[148:151], v[136:139]
    buffer_load_dwordx4 v171, s[8:11], s28 offen offset:3072 lds
    s_add_u32 s28, s28, 0x20000
    v_mfma_f32_16x16x32_bf16 v[136:139], v[196:199], a[156:159], v[136:139]
    v_mfma_f32_16x16x32_bf16 v[68:71], v[200:203], a[128:131], v[68:71]
    ds_read_b64_tr_b16 v[192:193], v154 offset:32768
    v_mfma_f32_16x16x32_bf16 v[68:71], v[204:207], a[136:139], v[68:71]
    ds_read_b64_tr_b16 v[194:195], v154 offset:33792
    v_mfma_f32_16x16x32_bf16 v[76:79], v[200:203], a[132:135], v[76:79]
    ds_read_b64_tr_b16 v[196:197], v154 offset:40960
    v_mfma_f32_16x16x32_bf16 v[76:79], v[204:207], a[140:143], v[76:79]
    ds_read_b64_tr_b16 v[198:199], v154 offset:41984
    v_mfma_f32_16x16x32_bf16 v[132:135], v[200:203], a[144:147], v[132:135]
    s_add_u32 m0, s30, 131072
    s_add_u32 s5, s54, 0
    buffer_load_dwordx4 v250, s[12:15], s5 offen lds
    v_mfma_f32_16x16x32_bf16 v[132:135], v[204:207], a[152:155], v[132:135]
    v_mfma_f32_16x16x32_bf16 v[140:143], v[200:203], a[148:151], v[140:143]
    s_add_u32 m0, s30, 132096
    s_add_u32 s5, s54, 16384
    buffer_load_dwordx4 v251, s[12:15], s5 offen lds
    v_mfma_f32_16x16x32_bf16 v[140:143], v[204:207], a[156:159], v[140:143]
    s_waitcnt vmcnt(22) lgkmcnt(8)
    v_mfma_f32_16x16x32_bf16 v[16:19], v[176:179], a[160:163], v[16:19]
    ds_read_b64_tr_b16 v[200:201], v155 offset:32768
    v_mfma_f32_16x16x32_bf16 v[16:19], v[180:183], a[168:171], v[16:19]
    ds_read_b64_tr_b16 v[202:203], v155 offset:33792
    v_mfma_f32_16x16x32_bf16 v[24:27], v[176:179], a[164:167], v[24:27]
    ds_read_b64_tr_b16 v[204:205], v155 offset:40960
    v_mfma_f32_16x16x32_bf16 v[24:27], v[180:183], a[172:175], v[24:27]
    ds_read_b64_tr_b16 v[206:207], v155 offset:41984
    v_mfma_f32_16x16x32_bf16 v[80:83], v[176:179], a[176:179], v[80:83]
    buffer_load_dwordx4 a[128:131], v7, s[32:35], s27 offen offset:0 sc1
    v_mfma_f32_16x16x32_bf16 v[80:83], v[180:183], a[184:187], v[80:83]
    v_mfma_f32_16x16x32_bf16 v[88:91], v[176:179], a[180:183], v[88:91]
    buffer_load_dwordx4 a[132:135], v7, s[32:35], s27 offen offset:1024 sc1
    v_mfma_f32_16x16x32_bf16 v[88:91], v[180:183], a[188:191], v[88:91]
    s_waitcnt lgkmcnt(8)
    v_mfma_f32_16x16x32_bf16 v[20:23], v[184:187], a[160:163], v[20:23]
    ds_read_b64_tr_b16 v[176:177], v156 offset:32768
    v_mfma_f32_16x16x32_bf16 v[20:23], v[188:191], a[168:171], v[20:23]
    ds_read_b64_tr_b16 v[178:179], v156 offset:33792
    v_mfma_f32_16x16x32_bf16 v[28:31], v[184:187], a[164:167], v[28:31]
    ds_read_b64_tr_b16 v[180:181], v156 offset:40960
    v_mfma_f32_16x16x32_bf16 v[28:31], v[188:191], a[172:175], v[28:31]
    ds_read_b64_tr_b16 v[182:183], v156 offset:41984
    v_mfma_f32_16x16x32_bf16 v[84:87], v[184:187], a[176:179], v[84:87]
    buffer_load_dwordx4 a[136:139], v7, s[32:35], s27 offen offset:2048 sc1
    v_mfma_f32_16x16x32_bf16 v[84:87], v[188:191], a[184:187], v[84:87]
    v_mfma_f32_16x16x32_bf16 v[92:95], v[184:187], a[180:183], v[92:95]
    buffer_load_dwordx4 a[140:143], v7, s[32:35], s27 offen offset:3072 sc1
    s_add_u32 s27, s27, 0x40000
    v_mfma_f32_16x16x32_bf16 v[92:95], v[188:191], a[188:191], v[92:95]
    s_waitcnt lgkmcnt(8)
    v_mfma_f32_16x16x32_bf16 v[32:35], v[192:195], a[160:163], v[32:35]
    ds_read_b64_tr_b16 v[184:185], v157 offset:32768
    v_mfma_f32_16x16x32_bf16 v[32:35], v[196:199], a[168:171], v[32:35]
    ds_read_b64_tr_b16 v[186:187], v157 offset:33792
    v_mfma_f32_16x16x32_bf16 v[40:43], v[192:195], a[164:167], v[40:43]
    ds_read_b64_tr_b16 v[188:189], v157 offset:40960
    v_mfma_f32_16x16x32_bf16 v[40:43], v[196:199], a[172:175], v[40:43]
    ds_read_b64_tr_b16 v[190:191], v157 offset:41984
    v_mfma_f32_16x16x32_bf16 v[96:99], v[192:195], a[176:179], v[96:99]
    buffer_load_dwordx4 a[144:147], v7, s[32:35], s31 offen offset:0 sc1
    v_mfma_f32_16x16x32_bf16 v[96:99], v[196:199], a[184:187], v[96:99]
    v_mfma_f32_16x16x32_bf16 v[104:107], v[192:195], a[180:183], v[104:107]
    buffer_load_dwordx4 a[148:151], v7, s[32:35], s31 offen offset:1024 sc1
    v_mfma_f32_16x16x32_bf16 v[104:107], v[196:199], a[188:191], v[104:107]
    s_waitcnt lgkmcnt(8)
    v_mfma_f32_16x16x32_bf16 v[36:39], v[200:203], a[160:163], v[36:39]
    ds_read_b64_tr_b16 v[192:193], v158 offset:32768
    v_mfma_f32_16x16x32_bf16 v[36:39], v[204:207], a[168:171], v[36:39]
    ds_read_b64_tr_b16 v[194:195], v158 offset:33792
    v_mfma_f32_16x16x32_bf16 v[44:47], v[200:203], a[164:167], v[44:47]
    ds_read_b64_tr_b16 v[196:197], v158 offset:40960
    v_mfma_f32_16x16x32_bf16 v[44:47], v[204:207], a[172:175], v[44:47]
    ds_read_b64_tr_b16 v[198:199], v158 offset:41984
    v_mfma_f32_16x16x32_bf16 v[100:103], v[200:203], a[176:179], v[100:103]
    buffer_load_dwordx4 a[152:155], v7, s[32:35], s31 offen offset:2048 sc1
    v_mfma_f32_16x16x32_bf16 v[100:103], v[204:207], a[184:187], v[100:103]
    v_mfma_f32_16x16x32_bf16 v[108:111], v[200:203], a[180:183], v[108:111]
    buffer_load_dwordx4 a[156:159], v7, s[32:35], s31 offen offset:3072 sc1
    s_add_u32 s31, s31, 0x40000
    v_mfma_f32_16x16x32_bf16 v[108:111], v[204:207], a[188:191], v[108:111]
    s_waitcnt lgkmcnt(8)
    v_mfma_f32_16x16x32_bf16 v[48:51], v[176:179], a[160:163], v[48:51]
    ds_read_b64_tr_b16 v[200:201], v159 offset:32768
    v_mfma_f32_16x16x32_bf16 v[48:51], v[180:183], a[168:171], v[48:51]
    ds_read_b64_tr_b16 v[202:203], v159 offset:33792
    v_mfma_f32_16x16x32_bf16 v[56:59], v[176:179], a[164:167], v[56:59]
    ds_read_b64_tr_b16 v[204:205], v159 offset:40960
    v_mfma_f32_16x16x32_bf16 v[56:59], v[180:183], a[172:175], v[56:59]
    ds_read_b64_tr_b16 v[206:207], v159 offset:41984
    v_mfma_f32_16x16x32_bf16 v[112:115], v[176:179], a[176:179], v[112:115]
    s_add_u32 m0, s30, 133120
    s_add_u32 s5, s54, 32768
    buffer_load_dwordx4 v250, s[12:15], s5 offen lds
    v_mfma_f32_16x16x32_bf16 v[112:115], v[180:183], a[184:187], v[112:115]
    v_mfma_f32_16x16x32_bf16 v[120:123], v[176:179], a[180:183], v[120:123]
    s_add_u32 m0, s30, 134144
    s_add_u32 s5, s54, 49152
    buffer_load_dwordx4 v251, s[12:15], s5 offen lds
    v_mfma_f32_16x16x32_bf16 v[120:123], v[180:183], a[188:191], v[120:123]
    s_waitcnt lgkmcnt(8)
    v_mfma_f32_16x16x32_bf16 v[52:55], v[184:187], a[160:163], v[52:55]
    v_mfma_f32_16x16x32_bf16 v[52:55], v[188:191], a[168:171], v[52:55]
    v_mfma_f32_16x16x32_bf16 v[60:63], v[184:187], a[164:167], v[60:63]
    s_waitcnt vmcnt(63) lgkmcnt(0)
    s_barrier
    v_mfma_f32_16x16x32_bf16 v[60:63], v[188:191], a[172:175], v[60:63]
    ds_read_b64_tr_b16 v[176:177], v152 offset:49152
    ds_read_b64_tr_b16 v[178:179], v152 offset:50176
    v_mfma_f32_16x16x32_bf16 v[116:119], v[184:187], a[176:179], v[116:119]
    ds_read_b64_tr_b16 v[180:181], v152 offset:57344
    ds_read_b64_tr_b16 v[182:183], v152 offset:58368
    v_mfma_f32_16x16x32_bf16 v[116:119], v[188:191], a[184:187], v[116:119]
    s_add_u32 m0, s30, 32768
    s_nop 0
    buffer_load_dwordx4 v168, s[8:11], s28 offen offset:0 lds
    v_mfma_f32_16x16x32_bf16 v[124:127], v[184:187], a[180:183], v[124:127]
    v_mfma_f32_16x16x32_bf16 v[124:127], v[188:191], a[188:191], v[124:127]
    buffer_load_dwordx4 v169, s[8:11], s28 offen offset:1024 lds
    v_mfma_f32_16x16x32_bf16 v[64:67], v[192:195], a[160:163], v[64:67]
    ds_read_b64_tr_b16 v[184:185], v153 offset:49152
    v_mfma_f32_16x16x32_bf16 v[64:67], v[196:199], a[168:171], v[64:67]
    ds_read_b64_tr_b16 v[186:187], v153 offset:50176
    v_mfma_f32_16x16x32_bf16 v[72:75], v[192:195], a[164:167], v[72:75]
    ds_read_b64_tr_b16 v[188:189], v153 offset:57344
    v_mfma_f32_16x16x32_bf16 v[72:75], v[196:199], a[172:175], v[72:75]
    ds_read_b64_tr_b16 v[190:191], v153 offset:58368
    v_mfma_f32_16x16x32_bf16 v[128:131], v[192:195], a[176:179], v[128:131]
    buffer_load_dwordx4 v170, s[8:11], s28 offen offset:2048 lds
    v_mfma_f32_16x16x32_bf16 v[128:131], v[196:199], a[184:187], v[128:131]
    v_mfma_f32_16x16x32_bf16 v[136:139], v[192:195], a[180:183], v[136:139]
    buffer_load_dwordx4 v171, s[8:11], s28 offen offset:3072 lds
    s_add_u32 s28, s28, 0x20000
    v_mfma_f32_16x16x32_bf16 v[136:139], v[196:199], a[188:191], v[136:139]
    v_mfma_f32_16x16x32_bf16 v[68:71], v[200:203], a[160:163], v[68:71]
    ds_read_b64_tr_b16 v[192:193], v154 offset:49152
    v_mfma_f32_16x16x32_bf16 v[68:71], v[204:207], a[168:171], v[68:71]
    ds_read_b64_tr_b16 v[194:195], v154 offset:50176
    v_mfma_f32_16x16x32_bf16 v[76:79], v[200:203], a[164:167], v[76:79]
    ds_read_b64_tr_b16 v[196:197], v154 offset:57344
    v_mfma_f32_16x16x32_bf16 v[76:79], v[204:207], a[172:175], v[76:79]
    ds_read_b64_tr_b16 v[198:199], v154 offset:58368
    v_mfma_f32_16x16x32_bf16 v[132:135], v[200:203], a[176:179], v[132:135]
    v_mfma_f32_16x16x32_bf16 v[132:135], v[204:207], a[184:187], v[132:135]
    v_mfma_f32_16x16x32_bf16 v[140:143], v[200:203], a[180:183], v[140:143]
    v_mfma_f32_16x16x32_bf16 v[140:143], v[204:207], a[188:191], v[140:143]
    s_waitcnt vmcnt(22) lgkmcnt(8)
    v_mfma_f32_16x16x32_bf16 v[16:19], v[176:179], a[96:99], v[16:19]
    ds_read_b64_tr_b16 v[200:201], v155 offset:49152
    v_mfma_f32_16x16x32_bf16 v[16:19], v[180:183], a[104:107], v[16:19]
    ds_read_b64_tr_b16 v[202:203], v155 offset:50176
    v_mfma_f32_16x16x32_bf16 v[24:27], v[176:179], a[100:103], v[24:27]
    ds_read_b64_tr_b16 v[204:205], v155 offset:57344
    v_mfma_f32_16x16x32_bf16 v[24:27], v[180:183], a[108:111], v[24:27]
    ds_read_b64_tr_b16 v[206:207], v155 offset:58368
    v_mfma_f32_16x16x32_bf16 v[80:83], v[176:179], a[112:115], v[80:83]
    buffer_load_dwordx4 a[160:163], v7, s[32:35], s27 offen offset:0 sc1
    v_mfma_f32_16x16x32_bf16 v[80:83], v[180:183], a[120:123], v[80:83]
    v_mfma_f32_16x16x32_bf16 v[88:91], v[176:179], a[116:119], v[88:91]
    buffer_load_dwordx4 a[164:167], v7, s[32:35], s27 offen offset:1024 sc1
    v_mfma_f32_16x16x32_bf16 v[88:91], v[180:183], a[124:127], v[88:91]
    s_waitcnt lgkmcnt(8)
    v_mfma_f32_16x16x32_bf16 v[20:23], v[184:187], a[96:99], v[20:23]
    ds_read_b64_tr_b16 v[176:177], v156 offset:49152
    v_mfma_f32_16x16x32_bf16 v[20:23], v[188:191], a[104:107], v[20:23]
    ds_read_b64_tr_b16 v[178:179], v156 offset:50176
    v_mfma_f32_16x16x32_bf16 v[28:31], v[184:187], a[100:103], v[28:31]
    ds_read_b64_tr_b16 v[180:181], v156 offset:57344
    v_mfma_f32_16x16x32_bf16 v[28:31], v[188:191], a[108:111], v[28:31]
    ds_read_b64_tr_b16 v[182:183], v156 offset:58368
    v_mfma_f32_16x16x32_bf16 v[84:87], v[184:187], a[112:115], v[84:87]
    buffer_load_dwordx4 a[168:171], v7, s[32:35], s27 offen offset:2048 sc1
    v_mfma_f32_16x16x32_bf16 v[84:87], v[188:191], a[120:123], v[84:87]
    v_mfma_f32_16x16x32_bf16 v[92:95], v[184:187], a[116:119], v[92:95]
    buffer_load_dwordx4 a[172:175], v7, s[32:35], s27 offen offset:3072 sc1
    s_add_u32 s27, s27, 0x40000
    v_mfma_f32_16x16x32_bf16 v[92:95], v[188:191], a[124:127], v[92:95]
    s_waitcnt lgkmcnt(8)
    v_mfma_f32_16x16x32_bf16 v[32:35], v[192:195], a[96:99], v[32:35]
    ds_read_b64_tr_b16 v[184:185], v157 offset:49152
    v_mfma_f32_16x16x32_bf16 v[32:35], v[196:199], a[104:107], v[32:35]
    ds_read_b64_tr_b16 v[186:187], v157 offset:50176
    v_mfma_f32_16x16x32_bf16 v[40:43], v[192:195], a[100:103], v[40:43]
    ds_read_b64_tr_b16 v[188:189], v157 offset:57344
    v_mfma_f32_16x16x32_bf16 v[40:43], v[196:199], a[108:111], v[40:43]
    ds_read_b64_tr_b16 v[190:191], v157 offset:58368
    v_mfma_f32_16x16x32_bf16 v[96:99], v[192:195], a[112:115], v[96:99]
    buffer_load_dwordx4 a[176:179], v7, s[32:35], s31 offen offset:0 sc1
    v_mfma_f32_16x16x32_bf16 v[96:99], v[196:199], a[120:123], v[96:99]
    v_mfma_f32_16x16x32_bf16 v[104:107], v[192:195], a[116:119], v[104:107]
    buffer_load_dwordx4 a[180:183], v7, s[32:35], s31 offen offset:1024 sc1
    v_mfma_f32_16x16x32_bf16 v[104:107], v[196:199], a[124:127], v[104:107]
    s_waitcnt lgkmcnt(8)
    v_mfma_f32_16x16x32_bf16 v[36:39], v[200:203], a[96:99], v[36:39]
    ds_read_b64_tr_b16 v[192:193], v158 offset:49152
    v_mfma_f32_16x16x32_bf16 v[36:39], v[204:207], a[104:107], v[36:39]
    ds_read_b64_tr_b16 v[194:195], v158 offset:50176
    v_mfma_f32_16x16x32_bf16 v[44:47], v[200:203], a[100:103], v[44:47]
    ds_read_b64_tr_b16 v[196:197], v158 offset:57344
    v_mfma_f32_16x16x32_bf16 v[44:47], v[204:207], a[108:111], v[44:47]
    ds_read_b64_tr_b16 v[198:199], v158 offset:58368
    v_mfma_f32_16x16x32_bf16 v[100:103], v[200:203], a[112:115], v[100:103]
    buffer_load_dwordx4 a[184:187], v7, s[32:35], s31 offen offset:2048 sc1
    v_mfma_f32_16x16x32_bf16 v[100:103], v[204:207], a[120:123], v[100:103]
    v_mfma_f32_16x16x32_bf16 v[108:111], v[200:203], a[116:119], v[108:111]
    buffer_load_dwordx4 a[188:191], v7, s[32:35], s31 offen offset:3072 sc1
    s_add_u32 s31, s31, 0x40000
    v_mfma_f32_16x16x32_bf16 v[108:111], v[204:207], a[124:127], v[108:111]
    s_waitcnt lgkmcnt(8)
    buffer_load_dword v255, v254, s[32:35], s58 offen offset:384 sc1
    v_mfma_f32_16x16x32_bf16 v[48:51], v[176:179], a[96:99], v[48:51]
    ds_read_b64_tr_b16 v[200:201], v159 offset:49152
    v_mfma_f32_16x16x32_bf16 v[48:51], v[180:183], a[104:107], v[48:51]
    ds_read_b64_tr_b16 v[202:203], v159 offset:50176
    v_mfma_f32_16x16x32_bf16 v[56:59], v[176:179], a[100:103], v[56:59]
    ds_read_b64_tr_b16 v[204:205], v159 offset:57344
    v_mfma_f32_16x16x32_bf16 v[56:59], v[180:183], a[108:111], v[56:59]
    ds_read_b64_tr_b16 v[206:207], v159 offset:58368
    v_mfma_f32_16x16x32_bf16 v[112:115], v[176:179], a[112:115], v[112:115]
    v_mfma_f32_16x16x32_bf16 v[112:115], v[180:183], a[120:123], v[112:115]
    v_mfma_f32_16x16x32_bf16 v[120:123], v[176:179], a[116:119], v[120:123]
    v_mfma_f32_16x16x32_bf16 v[120:123], v[180:183], a[124:127], v[120:123]
    s_waitcnt lgkmcnt(8)
    v_mfma_f32_16x16x32_bf16 v[52:55], v[184:187], a[96:99], v[52:55]
    v_mfma_f32_16x16x32_bf16 v[52:55], v[188:191], a[104:107], v[52:55]
    v_mfma_f32_16x16x32_bf16 v[60:63], v[184:187], a[100:103], v[60:63]
    s_waitcnt vmcnt(41) lgkmcnt(0)
    s_barrier
    v_mfma_f32_16x16x32_bf16 v[60:63], v[188:191], a[108:111], v[60:63]
    ds_read_b64_tr_b16 v[176:177], v152 offset:0
    ds_read_b64_tr_b16 v[178:179], v152 offset:1024
    v_mfma_f32_16x16x32_bf16 v[116:119], v[184:187], a[112:115], v[116:119]
    ds_read_b64_tr_b16 v[180:181], v152 offset:8192
    ds_read_b64_tr_b16 v[182:183], v152 offset:9216
    v_mfma_f32_16x16x32_bf16 v[116:119], v[188:191], a[120:123], v[116:119]
    s_add_u32 m0, s30, 49152
    s_nop 0
    buffer_load_dwordx4 v168, s[8:11], s28 offen offset:0 lds
    v_mfma_f32_16x16x32_bf16 v[124:127], v[184:187], a[116:119], v[124:127]
    v_mfma_f32_16x16x32_bf16 v[124:127], v[188:191], a[124:127], v[124:127]
    buffer_load_dwordx4 v169, s[8:11], s28 offen offset:1024 lds
    v_mfma_f32_16x16x32_bf16 v[64:67], v[192:195], a[96:99], v[64:67]
    ds_read_b64_tr_b16 v[184:185], v153 offset:0
    v_mfma_f32_16x16x32_bf16 v[64:67], v[196:199], a[104:107], v[64:67]
    ds_read_b64_tr_b16 v[186:187], v153 offset:1024
    v_mfma_f32_16x16x32_bf16 v[72:75], v[192:195], a[100:103], v[72:75]
    ds_read_b64_tr_b16 v[188:189], v153 offset:8192
    v_mfma_f32_16x16x32_bf16 v[72:75], v[196:199], a[108:111], v[72:75]
    ds_read_b64_tr_b16 v[190:191], v153 offset:9216
    v_mfma_f32_16x16x32_bf16 v[128:131], v[192:195], a[112:115], v[128:131]
    buffer_load_dwordx4 v170, s[8:11], s28 offen offset:2048 lds
    v_mfma_f32_16x16x32_bf16 v[128:131], v[196:199], a[120:123], v[128:131]
    v_mfma_f32_16x16x32_bf16 v[136:139], v[192:195], a[116:119], v[136:139]
    buffer_load_dwordx4 v171, s[8:11], s28 offen offset:3072 lds
    s_add_u32 s28, s28, 0x20000
    v_mfma_f32_16x16x32_bf16 v[136:139], v[196:199], a[124:127], v[136:139]
    v_mfma_f32_16x16x32_bf16 v[68:71], v[200:203], a[96:99], v[68:71]
    ds_read_b64_tr_b16 v[192:193], v154 offset:0
    v_mfma_f32_16x16x32_bf16 v[68:71], v[204:207], a[104:107], v[68:71]
    ds_read_b64_tr_b16 v[194:195], v154 offset:1024
    v_mfma_f32_16x16x32_bf16 v[76:79], v[200:203], a[100:103], v[76:79]
    ds_read_b64_tr_b16 v[196:197], v154 offset:8192
    v_mfma_f32_16x16x32_bf16 v[76:79], v[204:207], a[108:111], v[76:79]
    ds_read_b64_tr_b16 v[198:199], v154 offset:9216
    v_mfma_f32_16x16x32_bf16 v[132:135], v[200:203], a[112:115], v[132:135]
    v_mfma_f32_16x16x32_bf16 v[132:135], v[204:207], a[120:123], v[132:135]
    v_mfma_f32_16x16x32_bf16 v[140:143], v[200:203], a[116:119], v[140:143]
    v_mfma_f32_16x16x32_bf16 v[140:143], v[204:207], a[124:127], v[140:143]
    s_waitcnt vmcnt(19) lgkmcnt(8)
    v_mfma_f32_16x16x32_bf16 v[16:19], v[176:179], a[128:131], v[16:19]
    ds_read_b64_tr_b16 v[200:201], v155 offset:0
    v_mfma_f32_16x16x32_bf16 v[16:19], v[180:183], a[136:139], v[16:19]
    ds_read_b64_tr_b16 v[202:203], v155 offset:1024
    v_mfma_f32_16x16x32_bf16 v[24:27], v[176:179], a[132:135], v[24:27]
    ds_read_b64_tr_b16 v[204:205], v155 offset:8192
    v_mfma_f32_16x16x32_bf16 v[24:27], v[180:183], a[140:143], v[24:27]
    ds_read_b64_tr_b16 v[206:207], v155 offset:9216
    v_mfma_f32_16x16x32_bf16 v[80:83], v[176:179], a[144:147], v[80:83]
    buffer_load_dwordx4 a[96:99], v7, s[32:35], s27 offen offset:0 sc1
    v_mfma_f32_16x16x32_bf16 v[80:83], v[180:183], a[152:155], v[80:83]
    v_mfma_f32_16x16x32_bf16 v[88:91], v[176:179], a[148:151], v[88:91]
    buffer_load_dwordx4 a[100:103], v7, s[32:35], s27 offen offset:1024 sc1
    v_mfma_f32_16x16x32_bf16 v[88:91], v[180:183], a[156:159], v[88:91]
    s_waitcnt lgkmcnt(8)
    v_mfma_f32_16x16x32_bf16 v[20:23], v[184:187], a[128:131], v[20:23]
    ds_read_b64_tr_b16 v[176:177], v156 offset:0
    v_mfma_f32_16x16x32_bf16 v[20:23], v[188:191], a[136:139], v[20:23]
    ds_read_b64_tr_b16 v[178:179], v156 offset:1024
    v_mfma_f32_16x16x32_bf16 v[28:31], v[184:187], a[132:135], v[28:31]
    ds_read_b64_tr_b16 v[180:181], v156 offset:8192
    v_mfma_f32_16x16x32_bf16 v[28:31], v[188:191], a[140:143], v[28:31]
    ds_read_b64_tr_b16 v[182:183], v156 offset:9216
    v_mfma_f32_16x16x32_bf16 v[84:87], v[184:187], a[144:147], v[84:87]
    buffer_load_dwordx4 a[104:107], v7, s[32:35], s27 offen offset:2048 sc1
    v_mfma_f32_16x16x32_bf16 v[84:87], v[188:191], a[152:155], v[84:87]
    v_mfma_f32_16x16x32_bf16 v[92:95], v[184:187], a[148:151], v[92:95]
    buffer_load_dwordx4 a[108:111], v7, s[32:35], s27 offen offset:3072 sc1
    s_add_u32 s27, s27, 0x40000
    v_mfma_f32_16x16x32_bf16 v[92:95], v[188:191], a[156:159], v[92:95]
    s_waitcnt lgkmcnt(8)
    v_mfma_f32_16x16x32_bf16 v[32:35], v[192:195], a[128:131], v[32:35]
    ds_read_b64_tr_b16 v[184:185], v157 offset:0
    v_mfma_f32_16x16x32_bf16 v[32:35], v[196:199], a[136:139], v[32:35]
    ds_read_b64_tr_b16 v[186:187], v157 offset:1024
    v_mfma_f32_16x16x32_bf16 v[40:43], v[192:195], a[132:135], v[40:43]
    ds_read_b64_tr_b16 v[188:189], v157 offset:8192
    v_mfma_f32_16x16x32_bf16 v[40:43], v[196:199], a[140:143], v[40:43]
    ds_read_b64_tr_b16 v[190:191], v157 offset:9216
    v_mfma_f32_16x16x32_bf16 v[96:99], v[192:195], a[144:147], v[96:99]
    buffer_load_dwordx4 a[112:115], v7, s[32:35], s31 offen offset:0 sc1
    v_mfma_f32_16x16x32_bf16 v[96:99], v[196:199], a[152:155], v[96:99]
    v_mfma_f32_16x16x32_bf16 v[104:107], v[192:195], a[148:151], v[104:107]
    buffer_load_dwordx4 a[116:119], v7, s[32:35], s31 offen offset:1024 sc1
    v_mfma_f32_16x16x32_bf16 v[104:107], v[196:199], a[156:159], v[104:107]
    s_waitcnt lgkmcnt(8)
    v_mfma_f32_16x16x32_bf16 v[36:39], v[200:203], a[128:131], v[36:39]
    ds_read_b64_tr_b16 v[192:193], v158 offset:0
    v_mfma_f32_16x16x32_bf16 v[36:39], v[204:207], a[136:139], v[36:39]
    ds_read_b64_tr_b16 v[194:195], v158 offset:1024
    v_mfma_f32_16x16x32_bf16 v[44:47], v[200:203], a[132:135], v[44:47]
    ds_read_b64_tr_b16 v[196:197], v158 offset:8192
    v_mfma_f32_16x16x32_bf16 v[44:47], v[204:207], a[140:143], v[44:47]
    ds_read_b64_tr_b16 v[198:199], v158 offset:9216
    v_mfma_f32_16x16x32_bf16 v[100:103], v[200:203], a[144:147], v[100:103]
    buffer_load_dwordx4 a[120:123], v7, s[32:35], s31 offen offset:2048 sc1
    v_mfma_f32_16x16x32_bf16 v[100:103], v[204:207], a[152:155], v[100:103]
    v_mfma_f32_16x16x32_bf16 v[108:111], v[200:203], a[148:151], v[108:111]
    buffer_load_dwordx4 a[124:127], v7, s[32:35], s31 offen offset:3072 sc1
    s_add_u32 s31, s31, 0x40000
    v_mfma_f32_16x16x32_bf16 v[108:111], v[204:207], a[156:159], v[108:111]
    s_waitcnt lgkmcnt(8)
    s_waitcnt vmcnt(12)
    s_mov_b32 s4, 0
recurrent_scan__linear_kernel_hedgehog__glu_gated_bilinear__prompt_kernel_po:
    v_cmp_ne_u32 vcc, 0, v255
    s_nop 4
    s_cbranch_vccz recurrent_scan__linear_kernel_hedgehog__glu_gated_bilinear__prompt_kernel_po_ok
    s_add_u32 s4, s4, 1
    s_cmp_ge_u32 s4, 200000
    s_cbranch_scc1 recurrent_scan__linear_kernel_hedgehog__glu_gated_bilinear__prompt_kernel_po_ok
    buffer_load_dword v255, v254, s[32:35], s58 offen offset:384 sc1
    s_waitcnt vmcnt(0)
    s_branch recurrent_scan__linear_kernel_hedgehog__glu_gated_bilinear__prompt_kernel_po
recurrent_scan__linear_kernel_hedgehog__glu_gated_bilinear__prompt_kernel_po_ok:
    v_mfma_f32_16x16x32_bf16 v[48:51], v[176:179], a[128:131], v[48:51]
    ds_read_b64_tr_b16 v[200:201], v159 offset:0
    v_mfma_f32_16x16x32_bf16 v[48:51], v[180:183], a[136:139], v[48:51]
    ds_read_b64_tr_b16 v[202:203], v159 offset:1024
    v_mfma_f32_16x16x32_bf16 v[56:59], v[176:179], a[132:135], v[56:59]
    ds_read_b64_tr_b16 v[204:205], v159 offset:8192
    v_mfma_f32_16x16x32_bf16 v[56:59], v[180:183], a[140:143], v[56:59]
    ds_read_b64_tr_b16 v[206:207], v159 offset:9216
    v_mfma_f32_16x16x32_bf16 v[112:115], v[176:179], a[144:147], v[112:115]
    buffer_load_dwordx4 a[0:3], v7, s[32:35], s53 offen offset:0 sc1
    v_mfma_f32_16x16x32_bf16 v[112:115], v[180:183], a[152:155], v[112:115]
    v_mfma_f32_16x16x32_bf16 v[120:123], v[176:179], a[148:151], v[120:123]
    buffer_load_dwordx4 a[4:7], v7, s[32:35], s53 offen offset:1024 sc1
    v_mfma_f32_16x16x32_bf16 v[120:123], v[180:183], a[156:159], v[120:123]
    s_waitcnt lgkmcnt(8)
    v_mfma_f32_16x16x32_bf16 v[52:55], v[184:187], a[128:131], v[52:55]
    v_mfma_f32_16x16x32_bf16 v[52:55], v[188:191], a[136:139], v[52:55]
    v_mfma_f32_16x16x32_bf16 v[60:63], v[184:187], a[132:135], v[60:63]
    s_waitcnt vmcnt(39) lgkmcnt(0)
    s_barrier
    v_mfma_f32_16x16x32_bf16 v[60:63], v[188:191], a[140:143], v[60:63]
    ds_read_b64_tr_b16 v[176:177], v152 offset:16384
    ds_read_b64_tr_b16 v[178:179], v152 offset:17408
    v_mfma_f32_16x16x32_bf16 v[116:119], v[184:187], a[144:147], v[116:119]
    ds_read_b64_tr_b16 v[180:181], v152 offset:24576
    ds_read_b64_tr_b16 v[182:183], v152 offset:25600
    v_mfma_f32_16x16x32_bf16 v[116:119], v[188:191], a[152:155], v[116:119]
    s_add_u32 m0, s30, 0
    s_nop 0
    buffer_load_dwordx4 v168, s[8:11], s28 offen offset:0 lds
    v_mfma_f32_16x16x32_bf16 v[124:127], v[184:187], a[148:151], v[124:127]
    v_mfma_f32_16x16x32_bf16 v[124:127], v[188:191], a[156:159], v[124:127]
    buffer_load_dwordx4 v169, s[8:11], s28 offen offset:1024 lds
    v_mfma_f32_16x16x32_bf16 v[64:67], v[192:195], a[128:131], v[64:67]
    ds_read_b64_tr_b16 v[184:185], v153 offset:16384
    v_mfma_f32_16x16x32_bf16 v[64:67], v[196:199], a[136:139], v[64:67]
    ds_read_b64_tr_b16 v[186:187], v153 offset:17408
    v_mfma_f32_16x16x32_bf16 v[72:75], v[192:195], a[132:135], v[72:75]
    ds_read_b64_tr_b16 v[188:189], v153 offset:24576
    v_mfma_f32_16x16x32_bf16 v[72:75], v[196:199], a[140:143], v[72:75]
    ds_read_b64_tr_b16 v[190:191], v153 offset:25600
    v_mfma_f32_16x16x32_bf16 v[128:131], v[192:195], a[144:147], v[128:131]
    buffer_load_dwordx4 v170, s[8:11], s28 offen offset:2048 lds
    v_mfma_f32_16x16x32_bf16 v[128:131], v[196:199], a[152:155], v[128:131]
    v_mfma_f32_16x16x32_bf16 v[136:139], v[192:195], a[148:151], v[136:139]
    buffer_load_dwordx4 v171, s[8:11], s28 offen offset:3072 lds
    s_add_u32 s28, s28, 0x20000
    v_mfma_f32_16x16x32_bf16 v[136:139], v[196:199], a[156:159], v[136:139]
    v_mfma_f32_16x16x32_bf16 v[68:71], v[200:203], a[128:131], v[68:71]
    ds_read_b64_tr_b16 v[192:193], v154 offset:16384
    v_mfma_f32_16x16x32_bf16 v[68:71], v[204:207], a[136:139], v[68:71]
    ds_read_b64_tr_b16 v[194:195], v154 offset:17408
    v_mfma_f32_16x16x32_bf16 v[76:79], v[200:203], a[132:135], v[76:79]
    ds_read_b64_tr_b16 v[196:197], v154 offset:24576
    v_mfma_f32_16x16x32_bf16 v[76:79], v[204:207], a[140:143], v[76:79]
    ds_read_b64_tr_b16 v[198:199], v154 offset:25600
    v_mfma_f32_16x16x32_bf16 v[132:135], v[200:203], a[144:147], v[132:135]
    buffer_load_dwordx4 a[8:11], v7, s[32:35], s53 offen offset:2048 sc1
    v_mfma_f32_16x16x32_bf16 v[132:135], v[204:207], a[152:155], v[132:135]
    v_mfma_f32_16x16x32_bf16 v[140:143], v[200:203], a[148:151], v[140:143]
    buffer_load_dwordx4 a[12:15], v7, s[32:35], s53 offen offset:3072 sc1
    s_add_u32 s53, s53, 0x40000
    v_mfma_f32_16x16x32_bf16 v[140:143], v[204:207], a[156:159], v[140:143]
    s_waitcnt vmcnt(21) lgkmcnt(8)
    v_mfma_f32_16x16x32_bf16 v[16:19], v[176:179], a[160:163], v[16:19]
    ds_read_b64_tr_b16 v[200:201], v155 offset:16384
    v_mfma_f32_16x16x32_bf16 v[16:19], v[180:183], a[168:171], v[16:19]
    ds_read_b64_tr_b16 v[202:203], v155 offset:17408
    v_mfma_f32_16x16x32_bf16 v[24:27], v[176:179], a[164:167], v[24:27]
    ds_read_b64_tr_b16 v[204:205], v155 offset:24576
    v_mfma_f32_16x16x32_bf16 v[24:27], v[180:183], a[172:175], v[24:27]
    ds_read_b64_tr_b16 v[206:207], v155 offset:25600
    v_mfma_f32_16x16x32_bf16 v[80:83], v[176:179], a[176:179], v[80:83]
    buffer_load_dwordx4 a[128:131], v7, s[32:35], s27 offen offset:0 sc1
    v_mfma_f32_16x16x32_bf16 v[80:83], v[180:183], a[184:187], v[80:83]
    v_mfma_f32_16x16x32_bf16 v[88:91], v[176:179], a[180:183], v[88:91]
    buffer_load_dwordx4 a[132:135], v7, s[32:35], s27 offen offset:1024 sc1
    v_mfma_f32_16x16x32_bf16 v[88:91], v[180:183], a[188:191], v[88:91]
    s_waitcnt lgkmcnt(8)
    v_mfma_f32_16x16x32_bf16 v[20:23], v[184:187], a[160:163], v[20:23]
    ds_read_b64_tr_b16 v[176:177], v156 offset:16384
    v_mfma_f32_16x16x32_bf16 v[20:23], v[188:191], a[168:171], v[20:23]
    ds_read_b64_tr_b16 v[178:179], v156 offset:17408
    v_mfma_f32_16x16x32_bf16 v[28:31], v[184:187], a[164:167], v[28:31]
    ds_read_b64_tr_b16 v[180:181], v156 offset:24576
    v_mfma_f32_16x16x32_bf16 v[28:31], v[188:191], a[172:175], v[28:31]
    ds_read_b64_tr_b16 v[182:183], v156 offset:25600
    v_mfma_f32_16x16x32_bf16 v[84:87], v[184:187], a[176:179], v[84:87]
    buffer_load_dwordx4 a[136:139], v7, s[32:35], s27 offen offset:2048 sc1
    v_mfma_f32_16x16x32_bf16 v[84:87], v[188:191], a[184:187], v[84:87]
    v_mfma_f32_16x16x32_bf16 v[92:95], v[184:187], a[180:183], v[92:95]
    buffer_load_dwordx4 a[140:143], v7, s[32:35], s27 offen offset:3072 sc1
    s_add_u32 s27, s27, 0x40000
    v_mfma_f32_16x16x32_bf16 v[92:95], v[188:191], a[188:191], v[92:95]
    s_waitcnt lgkmcnt(8)
    v_mfma_f32_16x16x32_bf16 v[32:35], v[192:195], a[160:163], v[32:35]
    ds_read_b64_tr_b16 v[184:185], v157 offset:16384
    v_mfma_f32_16x16x32_bf16 v[32:35], v[196:199], a[168:171], v[32:35]
    ds_read_b64_tr_b16 v[186:187], v157 offset:17408
    v_mfma_f32_16x16x32_bf16 v[40:43], v[192:195], a[164:167], v[40:43]
    ds_read_b64_tr_b16 v[188:189], v157 offset:24576
    v_mfma_f32_16x16x32_bf16 v[40:43], v[196:199], a[172:175], v[40:43]
    ds_read_b64_tr_b16 v[190:191], v157 offset:25600
    v_mfma_f32_16x16x32_bf16 v[96:99], v[192:195], a[176:179], v[96:99]
    buffer_load_dwordx4 a[144:147], v7, s[32:35], s31 offen offset:0 sc1
    v_mfma_f32_16x16x32_bf16 v[96:99], v[196:199], a[184:187], v[96:99]
    v_mfma_f32_16x16x32_bf16 v[104:107], v[192:195], a[180:183], v[104:107]
    buffer_load_dwordx4 a[148:151], v7, s[32:35], s31 offen offset:1024 sc1
    v_mfma_f32_16x16x32_bf16 v[104:107], v[196:199], a[188:191], v[104:107]
    s_waitcnt lgkmcnt(8)
    v_mfma_f32_16x16x32_bf16 v[36:39], v[200:203], a[160:163], v[36:39]
    ds_read_b64_tr_b16 v[192:193], v158 offset:16384
    v_mfma_f32_16x16x32_bf16 v[36:39], v[204:207], a[168:171], v[36:39]
    ds_read_b64_tr_b16 v[194:195], v158 offset:17408
    v_mfma_f32_16x16x32_bf16 v[44:47], v[200:203], a[164:167], v[44:47]
    ds_read_b64_tr_b16 v[196:197], v158 offset:24576
    v_mfma_f32_16x16x32_bf16 v[44:47], v[204:207], a[172:175], v[44:47]
    ds_read_b64_tr_b16 v[198:199], v158 offset:25600
    v_mfma_f32_16x16x32_bf16 v[100:103], v[200:203], a[176:179], v[100:103]
    buffer_load_dwordx4 a[152:155], v7, s[32:35], s31 offen offset:2048 sc1
    v_mfma_f32_16x16x32_bf16 v[100:103], v[204:207], a[184:187], v[100:103]
    v_mfma_f32_16x16x32_bf16 v[108:111], v[200:203], a[180:183], v[108:111]
    buffer_load_dwordx4 a[156:159], v7, s[32:35], s31 offen offset:3072 sc1
    s_add_u32 s31, s31, 0x40000
    v_mfma_f32_16x16x32_bf16 v[108:111], v[204:207], a[188:191], v[108:111]
    s_waitcnt lgkmcnt(8)
    v_mfma_f32_16x16x32_bf16 v[48:51], v[176:179], a[160:163], v[48:51]
    ds_read_b64_tr_b16 v[200:201], v159 offset:16384
    v_mfma_f32_16x16x32_bf16 v[48:51], v[180:183], a[168:171], v[48:51]
    ds_read_b64_tr_b16 v[202:203], v159 offset:17408
    v_mfma_f32_16x16x32_bf16 v[56:59], v[176:179], a[164:167], v[56:59]
    ds_read_b64_tr_b16 v[204:205], v159 offset:24576
    v_mfma_f32_16x16x32_bf16 v[56:59], v[180:183], a[172:175], v[56:59]
    ds_read_b64_tr_b16 v[206:207], v159 offset:25600
    v_mfma_f32_16x16x32_bf16 v[112:115], v[176:179], a[176:179], v[112:115]
    buffer_load_dwordx4 a[16:19], v7, s[32:35], s53 offen offset:0 sc1
    v_mfma_f32_16x16x32_bf16 v[112:115], v[180:183], a[184:187], v[112:115]
    v_mfma_f32_16x16x32_bf16 v[120:123], v[176:179], a[180:183], v[120:123]
    buffer_load_dwordx4 a[20:23], v7, s[32:35], s53 offen offset:1024 sc1
    v_mfma_f32_16x16x32_bf16 v[120:123], v[180:183], a[188:191], v[120:123]
    s_waitcnt lgkmcnt(8)
    v_mfma_f32_16x16x32_bf16 v[52:55], v[184:187], a[160:163], v[52:55]
    v_mfma_f32_16x16x32_bf16 v[52:55], v[188:191], a[168:171], v[52:55]
    v_mfma_f32_16x16x32_bf16 v[60:63], v[184:187], a[164:167], v[60:63]
    s_waitcnt vmcnt(39) lgkmcnt(0)
    s_barrier
    v_mfma_f32_16x16x32_bf16 v[60:63], v[188:191], a[172:175], v[60:63]
    ds_read_b64_tr_b16 v[176:177], v152 offset:32768
    ds_read_b64_tr_b16 v[178:179], v152 offset:33792
    v_mfma_f32_16x16x32_bf16 v[116:119], v[184:187], a[176:179], v[116:119]
    ds_read_b64_tr_b16 v[180:181], v152 offset:40960
    ds_read_b64_tr_b16 v[182:183], v152 offset:41984
    v_mfma_f32_16x16x32_bf16 v[116:119], v[188:191], a[184:187], v[116:119]
    s_add_u32 m0, s30, 16384
    s_nop 0
    buffer_load_dwordx4 v168, s[8:11], s28 offen offset:0 lds
    v_mfma_f32_16x16x32_bf16 v[124:127], v[184:187], a[180:183], v[124:127]
    v_mfma_f32_16x16x32_bf16 v[124:127], v[188:191], a[188:191], v[124:127]
    buffer_load_dwordx4 v169, s[8:11], s28 offen offset:1024 lds
    v_mfma_f32_16x16x32_bf16 v[64:67], v[192:195], a[160:163], v[64:67]
    ds_read_b64_tr_b16 v[184:185], v153 offset:32768
    v_mfma_f32_16x16x32_bf16 v[64:67], v[196:199], a[168:171], v[64:67]
    ds_read_b64_tr_b16 v[186:187], v153 offset:33792
    v_mfma_f32_16x16x32_bf16 v[72:75], v[192:195], a[164:167], v[72:75]
    ds_read_b64_tr_b16 v[188:189], v153 offset:40960
    v_mfma_f32_16x16x32_bf16 v[72:75], v[196:199], a[172:175], v[72:75]
    ds_read_b64_tr_b16 v[190:191], v153 offset:41984
    v_mfma_f32_16x16x32_bf16 v[128:131], v[192:195], a[176:179], v[128:131]
    buffer_load_dwordx4 v170, s[8:11], s28 offen offset:2048 lds
    v_mfma_f32_16x16x32_bf16 v[128:131], v[196:199], a[184:187], v[128:131]
    v_mfma_f32_16x16x32_bf16 v[136:139], v[192:195], a[180:183], v[136:139]
    buffer_load_dwordx4 v171, s[8:11], s28 offen offset:3072 lds
    s_add_u32 s28, s28, 0x20000
    v_mfma_f32_16x16x32_bf16 v[136:139], v[196:199], a[188:191], v[136:139]
    v_mfma_f32_16x16x32_bf16 v[68:71], v[200:203], a[160:163], v[68:71]
    ds_read_b64_tr_b16 v[192:193], v154 offset:32768
    v_mfma_f32_16x16x32_bf16 v[68:71], v[204:207], a[168:171], v[68:71]
    ds_read_b64_tr_b16 v[194:195], v154 offset:33792
    v_mfma_f32_16x16x32_bf16 v[76:79], v[200:203], a[164:167], v[76:79]
    ds_read_b64_tr_b16 v[196:197], v154 offset:40960
    v_mfma_f32_16x16x32_bf16 v[76:79], v[204:207], a[172:175], v[76:79]
    ds_read_b64_tr_b16 v[198:199], v154 offset:41984
    v_mfma_f32_16x16x32_bf16 v[132:135], v[200:203], a[176:179], v[132:135]
    buffer_load_dwordx4 a[24:27], v7, s[32:35], s53 offen offset:2048 sc1
    v_mfma_f32_16x16x32_bf16 v[132:135], v[204:207], a[184:187], v[132:135]
    v_mfma_f32_16x16x32_bf16 v[140:143], v[200:203], a[180:183], v[140:143]
    buffer_load_dwordx4 a[28:31], v7, s[32:35], s53 offen offset:3072 sc1
    s_add_u32 s53, s53, 0x40000
    v_mfma_f32_16x16x32_bf16 v[140:143], v[204:207], a[188:191], v[140:143]
    s_waitcnt vmcnt(24) lgkmcnt(8)
    v_mfma_f32_16x16x32_bf16 v[16:19], v[176:179], a[96:99], v[16:19]
    ds_read_b64_tr_b16 v[200:201], v155 offset:32768
    v_mfma_f32_16x16x32_bf16 v[16:19], v[180:183], a[104:107], v[16:19]
    ds_read_b64_tr_b16 v[202:203], v155 offset:33792
    v_mfma_f32_16x16x32_bf16 v[24:27], v[176:179], a[100:103], v[24:27]
    ds_read_b64_tr_b16 v[204:205], v155 offset:40960
    v_mfma_f32_16x16x32_bf16 v[24:27], v[180:183], a[108:111], v[24:27]
    ds_read_b64_tr_b16 v[206:207], v155 offset:41984
    v_mfma_f32_16x16x32_bf16 v[80:83], v[176:179], a[112:115], v[80:83]
    buffer_load_dwordx4 a[160:163], v7, s[32:35], s27 offen offset:0 sc1
    v_mfma_f32_16x16x32_bf16 v[80:83], v[180:183], a[120:123], v[80:83]
    v_mfma_f32_16x16x32_bf16 v[88:91], v[176:179], a[116:119], v[88:91]
    buffer_load_dwordx4 a[164:167], v7, s[32:35], s27 offen offset:1024 sc1
    v_mfma_f32_16x16x32_bf16 v[88:91], v[180:183], a[124:127], v[88:91]
    s_waitcnt lgkmcnt(8)
    v_mfma_f32_16x16x32_bf16 v[20:23], v[184:187], a[96:99], v[20:23]
    ds_read_b64_tr_b16 v[176:177], v156 offset:32768
    v_mfma_f32_16x16x32_bf16 v[20:23], v[188:191], a[104:107], v[20:23]
    ds_read_b64_tr_b16 v[178:179], v156 offset:33792
    v_mfma_f32_16x16x32_bf16 v[28:31], v[184:187], a[100:103], v[28:31]
    ds_read_b64_tr_b16 v[180:181], v156 offset:40960
    v_mfma_f32_16x16x32_bf16 v[28:31], v[188:191], a[108:111], v[28:31]
    ds_read_b64_tr_b16 v[182:183], v156 offset:41984
    v_mfma_f32_16x16x32_bf16 v[84:87], v[184:187], a[112:115], v[84:87]
    buffer_load_dwordx4 a[168:171], v7, s[32:35], s27 offen offset:2048 sc1
    v_mfma_f32_16x16x32_bf16 v[84:87], v[188:191], a[120:123], v[84:87]
    v_mfma_f32_16x16x32_bf16 v[92:95], v[184:187], a[116:119], v[92:95]
    buffer_load_dwordx4 a[172:175], v7, s[32:35], s27 offen offset:3072 sc1
    s_add_u32 s27, s27, 0x40000
    v_mfma_f32_16x16x32_bf16 v[92:95], v[188:191], a[124:127], v[92:95]
    s_waitcnt lgkmcnt(8)
    v_mfma_f32_16x16x32_bf16 v[32:35], v[192:195], a[96:99], v[32:35]
    ds_read_b64_tr_b16 v[184:185], v157 offset:32768
    v_mfma_f32_16x16x32_bf16 v[32:35], v[196:199], a[104:107], v[32:35]
    ds_read_b64_tr_b16 v[186:187], v157 offset:33792
    v_mfma_f32_16x16x32_bf16 v[40:43], v[192:195], a[100:103], v[40:43]
    ds_read_b64_tr_b16 v[188:189], v157 offset:40960
    v_mfma_f32_16x16x32_bf16 v[40:43], v[196:199], a[108:111], v[40:43]
    ds_read_b64_tr_b16 v[190:191], v157 offset:41984
    v_mfma_f32_16x16x32_bf16 v[96:99], v[192:195], a[112:115], v[96:99]
    buffer_load_dwordx4 a[176:179], v7, s[32:35], s31 offen offset:0 sc1
    v_mfma_f32_16x16x32_bf16 v[96:99], v[196:199], a[120:123], v[96:99]
    v_mfma_f32_16x16x32_bf16 v[104:107], v[192:195], a[116:119], v[104:107]
    buffer_load_dwordx4 a[180:183], v7, s[32:35], s31 offen offset:1024 sc1
    v_mfma_f32_16x16x32_bf16 v[104:107], v[196:199], a[124:127], v[104:107]
    s_waitcnt lgkmcnt(8)
    v_mfma_f32_16x16x32_bf16 v[36:39], v[200:203], a[96:99], v[36:39]
    ds_read_b64_tr_b16 v[192:193], v158 offset:32768
    v_mfma_f32_16x16x32_bf16 v[36:39], v[204:207], a[104:107], v[36:39]
    ds_read_b64_tr_b16 v[194:195], v158 offset:33792
    v_mfma_f32_16x16x32_bf16 v[44:47], v[200:203], a[100:103], v[44:47]
    ds_read_b64_tr_b16 v[196:197], v158 offset:40960
    v_mfma_f32_16x16x32_bf16 v[44:47], v[204:207], a[108:111], v[44:47]
    ds_read_b64_tr_b16 v[198:199], v158 offset:41984
    v_mfma_f32_16x16x32_bf16 v[100:103], v[200:203], a[112:115], v[100:103]
    buffer_load_dwordx4 a[184:187], v7, s[32:35], s31 offen offset:2048 sc1
    v_mfma_f32_16x16x32_bf16 v[100:103], v[204:207], a[120:123], v[100:103]
    v_mfma_f32_16x16x32_bf16 v[108:111], v[200:203], a[116:119], v[108:111]
    buffer_load_dwordx4 a[188:191], v7, s[32:35], s31 offen offset:3072 sc1
    s_add_u32 s31, s31, 0x40000
    v_mfma_f32_16x16x32_bf16 v[108:111], v[204:207], a[124:127], v[108:111]
    s_waitcnt lgkmcnt(8)
    v_mfma_f32_16x16x32_bf16 v[48:51], v[176:179], a[96:99], v[48:51]
    ds_read_b64_tr_b16 v[200:201], v159 offset:32768
    v_mfma_f32_16x16x32_bf16 v[48:51], v[180:183], a[104:107], v[48:51]
    ds_read_b64_tr_b16 v[202:203], v159 offset:33792
    v_mfma_f32_16x16x32_bf16 v[56:59], v[176:179], a[100:103], v[56:59]
    ds_read_b64_tr_b16 v[204:205], v159 offset:40960
    v_mfma_f32_16x16x32_bf16 v[56:59], v[180:183], a[108:111], v[56:59]
    ds_read_b64_tr_b16 v[206:207], v159 offset:41984
    v_mfma_f32_16x16x32_bf16 v[112:115], v[176:179], a[112:115], v[112:115]
    buffer_load_dwordx4 a[32:35], v7, s[32:35], s53 offen offset:0 sc1
    v_mfma_f32_16x16x32_bf16 v[112:115], v[180:183], a[120:123], v[112:115]
    v_mfma_f32_16x16x32_bf16 v[120:123], v[176:179], a[116:119], v[120:123]
    buffer_load_dwordx4 a[36:39], v7, s[32:35], s53 offen offset:1024 sc1
    v_mfma_f32_16x16x32_bf16 v[120:123], v[180:183], a[124:127], v[120:123]
    s_waitcnt lgkmcnt(8)
    v_mfma_f32_16x16x32_bf16 v[52:55], v[184:187], a[96:99], v[52:55]
    v_mfma_f32_16x16x32_bf16 v[52:55], v[188:191], a[104:107], v[52:55]
    v_mfma_f32_16x16x32_bf16 v[60:63], v[184:187], a[100:103], v[60:63]
    s_waitcnt vmcnt(42) lgkmcnt(0)
    s_barrier
    v_mfma_f32_16x16x32_bf16 v[60:63], v[188:191], a[108:111], v[60:63]
    ds_read_b64_tr_b16 v[176:177], v152 offset:49152
    ds_read_b64_tr_b16 v[178:179], v152 offset:50176
    v_mfma_f32_16x16x32_bf16 v[116:119], v[184:187], a[112:115], v[116:119]
    ds_read_b64_tr_b16 v[180:181], v152 offset:57344
    ds_read_b64_tr_b16 v[182:183], v152 offset:58368
    v_mfma_f32_16x16x32_bf16 v[116:119], v[188:191], a[120:123], v[116:119]
    s_add_u32 m0, s30, 32768
    s_nop 0
    buffer_load_dwordx4 v168, s[8:11], s28 offen offset:0 lds
    v_mfma_f32_16x16x32_bf16 v[124:127], v[184:187], a[116:119], v[124:127]
    v_mfma_f32_16x16x32_bf16 v[124:127], v[188:191], a[124:127], v[124:127]
    buffer_load_dwordx4 v169, s[8:11], s28 offen offset:1024 lds
    v_mfma_f32_16x16x32_bf16 v[64:67], v[192:195], a[96:99], v[64:67]
    ds_read_b64_tr_b16 v[184:185], v153 offset:49152
    v_mfma_f32_16x16x32_bf16 v[64:67], v[196:199], a[104:107], v[64:67]
    ds_read_b64_tr_b16 v[186:187], v153 offset:50176
    v_mfma_f32_16x16x32_bf16 v[72:75], v[192:195], a[100:103], v[72:75]
    ds_read_b64_tr_b16 v[188:189], v153 offset:57344
    v_mfma_f32_16x16x32_bf16 v[72:75], v[196:199], a[108:111], v[72:75]
    ds_read_b64_tr_b16 v[190:191], v153 offset:58368
    v_mfma_f32_16x16x32_bf16 v[128:131], v[192:195], a[112:115], v[128:131]
    buffer_load_dwordx4 v170, s[8:11], s28 offen offset:2048 lds
    v_mfma_f32_16x16x32_bf16 v[128:131], v[196:199], a[120:123], v[128:131]
    v_mfma_f32_16x16x32_bf16 v[136:139], v[192:195], a[116:119], v[136:139]
    buffer_load_dwordx4 v171, s[8:11], s28 offen offset:3072 lds
    s_add_u32 s28, s28, 0x20000
    v_mfma_f32_16x16x32_bf16 v[136:139], v[196:199], a[124:127], v[136:139]
    v_mfma_f32_16x16x32_bf16 v[68:71], v[200:203], a[96:99], v[68:71]
    ds_read_b64_tr_b16 v[192:193], v154 offset:49152
    v_mfma_f32_16x16x32_bf16 v[68:71], v[204:207], a[104:107], v[68:71]
    ds_read_b64_tr_b16 v[194:195], v154 offset:50176
    v_mfma_f32_16x16x32_bf16 v[76:79], v[200:203], a[100:103], v[76:79]
    ds_read_b64_tr_b16 v[196:197], v154 offset:57344
    v_mfma_f32_16x16x32_bf16 v[76:79], v[204:207], a[108:111], v[76:79]
    ds_read_b64_tr_b16 v[198:199], v154 offset:58368
    v_mfma_f32_16x16x32_bf16 v[132:135], v[200:203], a[112:115], v[132:135]
    buffer_load_dwordx4 a[40:43], v7, s[32:35], s53 offen offset:2048 sc1
    v_mfma_f32_16x16x32_bf16 v[132:135], v[204:207], a[120:123], v[132:135]
    v_mfma_f32_16x16x32_bf16 v[140:143], v[200:203], a[116:119], v[140:143]
    buffer_load_dwordx4 a[44:47], v7, s[32:35], s53 offen offset:3072 sc1
    s_add_u32 s53, s53, 0x40000
    v_mfma_f32_16x16x32_bf16 v[140:143], v[204:207], a[124:127], v[140:143]
    s_waitcnt vmcnt(24) lgkmcnt(8)
    v_mfma_f32_16x16x32_bf16 v[16:19], v[176:179], a[128:131], v[16:19]
    ds_read_b64_tr_b16 v[200:201], v155 offset:49152
    v_mfma_f32_16x16x32_bf16 v[16:19], v[180:183], a[136:139], v[16:19]
    ds_read_b64_tr_b16 v[202:203], v155 offset:50176
    v_mfma_f32_16x16x32_bf16 v[24:27], v[176:179], a[132:135], v[24:27]
    ds_read_b64_tr_b16 v[204:205], v155 offset:57344
    v_mfma_f32_16x16x32_bf16 v[24:27], v[180:183], a[140:143], v[24:27]
    ds_read_b64_tr_b16 v[206:207], v155 offset:58368
    v_mfma_f32_16x16x32_bf16 v[80:83], v[176:179], a[144:147], v[80:83]
    buffer_load_dwordx4 a[96:99], v7, s[32:35], s27 offen offset:0 sc1
    v_mfma_f32_16x16x32_bf16 v[80:83], v[180:183], a[152:155], v[80:83]
    v_mfma_f32_16x16x32_bf16 v[88:91], v[176:179], a[148:151], v[88:91]
    buffer_load_dwordx4 a[100:103], v7, s[32:35], s27 offen offset:1024 sc1
    v_mfma_f32_16x16x32_bf16 v[88:91], v[180:183], a[156:159], v[88:91]
    s_waitcnt lgkmcnt(8)
    v_mfma_f32_16x16x32_bf16 v[20:23], v[184:187], a[128:131], v[20:23]
    ds_read_b64_tr_b16 v[176:177], v156 offset:49152
    v_mfma_f32_16x16x32_bf16 v[20:23], v[188:191], a[136:139], v[20:23]
    ds_read_b64_tr_b16 v[178:179], v156 offset:50176
    v_mfma_f32_16x16x32_bf16 v[28:31], v[184:187], a[132:135], v[28:31]
    ds_read_b64_tr_b16 v[180:181], v156 offset:57344
    v_mfma_f32_16x16x32_bf16 v[28:31], v[188:191], a[140:143], v[28:31]
    ds_read_b64_tr_b16 v[182:183], v156 offset:58368
    v_mfma_f32_16x16x32_bf16 v[84:87], v[184:187], a[144:147], v[84:87]
    buffer_load_dwordx4 a[104:107], v7, s[32:35], s27 offen offset:2048 sc1
    v_mfma_f32_16x16x32_bf16 v[84:87], v[188:191], a[152:155], v[84:87]
    v_mfma_f32_16x16x32_bf16 v[92:95], v[184:187], a[148:151], v[92:95]
    buffer_load_dwordx4 a[108:111], v7, s[32:35], s27 offen offset:3072 sc1
    s_add_u32 s27, s27, 0x40000
    v_mfma_f32_16x16x32_bf16 v[92:95], v[188:191], a[156:159], v[92:95]
    s_waitcnt lgkmcnt(8)
    v_mfma_f32_16x16x32_bf16 v[32:35], v[192:195], a[128:131], v[32:35]
    ds_read_b64_tr_b16 v[184:185], v157 offset:49152
    v_mfma_f32_16x16x32_bf16 v[32:35], v[196:199], a[136:139], v[32:35]
    ds_read_b64_tr_b16 v[186:187], v157 offset:50176
    v_mfma_f32_16x16x32_bf16 v[40:43], v[192:195], a[132:135], v[40:43]
    ds_read_b64_tr_b16 v[188:189], v157 offset:57344
    v_mfma_f32_16x16x32_bf16 v[40:43], v[196:199], a[140:143], v[40:43]
    ds_read_b64_tr_b16 v[190:191], v157 offset:58368
    v_mfma_f32_16x16x32_bf16 v[96:99], v[192:195], a[144:147], v[96:99]
    buffer_load_dwordx4 a[112:115], v7, s[32:35], s31 offen offset:0 sc1
    v_mfma_f32_16x16x32_bf16 v[96:99], v[196:199], a[152:155], v[96:99]
    v_mfma_f32_16x16x32_bf16 v[104:107], v[192:195], a[148:151], v[104:107]
    buffer_load_dwordx4 a[116:119], v7, s[32:35], s31 offen offset:1024 sc1
    v_mfma_f32_16x16x32_bf16 v[104:107], v[196:199], a[156:159], v[104:107]
    s_waitcnt lgkmcnt(8)
    v_mfma_f32_16x16x32_bf16 v[36:39], v[200:203], a[128:131], v[36:39]
    ds_read_b64_tr_b16 v[192:193], v158 offset:49152
    v_mfma_f32_16x16x32_bf16 v[36:39], v[204:207], a[136:139], v[36:39]
    ds_read_b64_tr_b16 v[194:195], v158 offset:50176
    v_mfma_f32_16x16x32_bf16 v[44:47], v[200:203], a[132:135], v[44:47]
    ds_read_b64_tr_b16 v[196:197], v158 offset:57344
    v_mfma_f32_16x16x32_bf16 v[44:47], v[204:207], a[140:143], v[44:47]
    ds_read_b64_tr_b16 v[198:199], v158 offset:58368
    v_mfma_f32_16x16x32_bf16 v[100:103], v[200:203], a[144:147], v[100:103]
    buffer_load_dwordx4 a[120:123], v7, s[32:35], s31 offen offset:2048 sc1
    v_mfma_f32_16x16x32_bf16 v[100:103], v[204:207], a[152:155], v[100:103]
    v_mfma_f32_16x16x32_bf16 v[108:111], v[200:203], a[148:151], v[108:111]
    buffer_load_dwordx4 a[124:127], v7, s[32:35], s31 offen offset:3072 sc1
    s_add_u32 s31, s31, 0x40000
    v_mfma_f32_16x16x32_bf16 v[108:111], v[204:207], a[156:159], v[108:111]
    s_waitcnt lgkmcnt(8)
    v_mfma_f32_16x16x32_bf16 v[48:51], v[176:179], a[128:131], v[48:51]
    ds_read_b64_tr_b16 v[200:201], v159 offset:49152
    v_mfma_f32_16x16x32_bf16 v[48:51], v[180:183], a[136:139], v[48:51]
    ds_read_b64_tr_b16 v[202:203], v159 offset:50176
    v_mfma_f32_16x16x32_bf16 v[56:59], v[176:179], a[132:135], v[56:59]
    ds_read_b64_tr_b16 v[204:205], v159 offset:57344
    v_mfma_f32_16x16x32_bf16 v[56:59], v[180:183], a[140:143], v[56:59]
    ds_read_b64_tr_b16 v[206:207], v159 offset:58368
    v_mfma_f32_16x16x32_bf16 v[112:115], v[176:179], a[144:147], v[112:115]
    buffer_load_dwordx4 a[48:51], v7, s[32:35], s53 offen offset:0 sc1
    v_mfma_f32_16x16x32_bf16 v[112:115], v[180:183], a[152:155], v[112:115]
    v_mfma_f32_16x16x32_bf16 v[120:123], v[176:179], a[148:151], v[120:123]
    buffer_load_dwordx4 a[52:55], v7, s[32:35], s53 offen offset:1024 sc1
    v_mfma_f32_16x16x32_bf16 v[120:123], v[180:183], a[156:159], v[120:123]
    s_waitcnt lgkmcnt(8)
    v_mfma_f32_16x16x32_bf16 v[52:55], v[184:187], a[128:131], v[52:55]
    v_mfma_f32_16x16x32_bf16 v[52:55], v[188:191], a[136:139], v[52:55]
    v_mfma_f32_16x16x32_bf16 v[60:63], v[184:187], a[132:135], v[60:63]
    s_waitcnt vmcnt(44) lgkmcnt(0)
    s_barrier
    v_mfma_f32_16x16x32_bf16 v[60:63], v[188:191], a[140:143], v[60:63]
    ds_read_b64_tr_b16 v[176:177], v152 offset:0
    ds_read_b64_tr_b16 v[178:179], v152 offset:1024
    v_mfma_f32_16x16x32_bf16 v[116:119], v[184:187], a[144:147], v[116:119]
    ds_read_b64_tr_b16 v[180:181], v152 offset:8192
    ds_read_b64_tr_b16 v[182:183], v152 offset:9216
    v_mfma_f32_16x16x32_bf16 v[116:119], v[188:191], a[152:155], v[116:119]
    s_add_u32 m0, s30, 49152
    s_nop 0
    buffer_load_dwordx4 v168, s[8:11], s28 offen offset:0 lds
    v_mfma_f32_16x16x32_bf16 v[124:127], v[184:187], a[148:151], v[124:127]
    v_mfma_f32_16x16x32_bf16 v[124:127], v[188:191], a[156:159], v[124:127]
    buffer_load_dwordx4 v169, s[8:11], s28 offen offset:1024 lds
    v_mfma_f32_16x16x32_bf16 v[64:67], v[192:195], a[128:131], v[64:67]
    ds_read_b64_tr_b16 v[184:185], v153 offset:0
    v_mfma_f32_16x16x32_bf16 v[64:67], v[196:199], a[136:139], v[64:67]
    ds_read_b64_tr_b16 v[186:187], v153 offset:1024
    v_mfma_f32_16x16x32_bf16 v[72:75], v[192:195], a[132:135], v[72:75]
    ds_read_b64_tr_b16 v[188:189], v153 offset:8192
    v_mfma_f32_16x16x32_bf16 v[72:75], v[196:199], a[140:143], v[72:75]
    ds_read_b64_tr_b16 v[190:191], v153 offset:9216
    v_mfma_f32_16x16x32_bf16 v[128:131], v[192:195], a[144:147], v[128:131]
    buffer_load_dwordx4 v170, s[8:11], s28 offen offset:2048 lds
    v_mfma_f32_16x16x32_bf16 v[128:131], v[196:199], a[152:155], v[128:131]
    v_mfma_f32_16x16x32_bf16 v[136:139], v[192:195], a[148:151], v[136:139]
    buffer_load_dwordx4 v171, s[8:11], s28 offen offset:3072 lds
    s_add_u32 s28, s28, 0x20000
    v_mfma_f32_16x16x32_bf16 v[136:139], v[196:199], a[156:159], v[136:139]
    v_mfma_f32_16x16x32_bf16 v[68:71], v[200:203], a[128:131], v[68:71]
    ds_read_b64_tr_b16 v[192:193], v154 offset:0
    v_mfma_f32_16x16x32_bf16 v[68:71], v[204:207], a[136:139], v[68:71]
    ds_read_b64_tr_b16 v[194:195], v154 offset:1024
    v_mfma_f32_16x16x32_bf16 v[76:79], v[200:203], a[132:135], v[76:79]
    ds_read_b64_tr_b16 v[196:197], v154 offset:8192
    v_mfma_f32_16x16x32_bf16 v[76:79], v[204:207], a[140:143], v[76:79]
    ds_read_b64_tr_b16 v[198:199], v154 offset:9216
    v_mfma_f32_16x16x32_bf16 v[132:135], v[200:203], a[144:147], v[132:135]
    buffer_load_dwordx4 a[56:59], v7, s[32:35], s53 offen offset:2048 sc1
    v_mfma_f32_16x16x32_bf16 v[132:135], v[204:207], a[152:155], v[132:135]
    v_mfma_f32_16x16x32_bf16 v[140:143], v[200:203], a[148:151], v[140:143]
    buffer_load_dwordx4 a[60:63], v7, s[32:35], s53 offen offset:3072 sc1
    s_add_u32 s53, s53, 0x40000
    v_mfma_f32_16x16x32_bf16 v[140:143], v[204:207], a[156:159], v[140:143]
    s_waitcnt vmcnt(24) lgkmcnt(8)
    v_mfma_f32_16x16x32_bf16 v[16:19], v[176:179], a[160:163], v[16:19]
    ds_read_b64_tr_b16 v[200:201], v155 offset:0
    v_mfma_f32_16x16x32_bf16 v[16:19], v[180:183], a[168:171], v[16:19]
    ds_read_b64_tr_b16 v[202:203], v155 offset:1024
    v_mfma_f32_16x16x32_bf16 v[24:27], v[176:179], a[164:167], v[24:27]
    ds_read_b64_tr_b16 v[204:205], v155 offset:8192
    v_mfma_f32_16x16x32_bf16 v[24:27], v[180:183], a[172:175], v[24:27]
    ds_read_b64_tr_b16 v[206:207], v155 offset:9216
    v_mfma_f32_16x16x32_bf16 v[80:83], v[176:179], a[176:179], v[80:83]
    buffer_load_dwordx4 a[128:131], v7, s[32:35], s27 offen offset:0 sc1
    v_mfma_f32_16x16x32_bf16 v[80:83], v[180:183], a[184:187], v[80:83]
    v_mfma_f32_16x16x32_bf16 v[88:91], v[176:179], a[180:183], v[88:91]
    buffer_load_dwordx4 a[132:135], v7, s[32:35], s27 offen offset:1024 sc1
    v_mfma_f32_16x16x32_bf16 v[88:91], v[180:183], a[188:191], v[88:91]
    s_waitcnt lgkmcnt(8)
    v_mfma_f32_16x16x32_bf16 v[20:23], v[184:187], a[160:163], v[20:23]
    ds_read_b64_tr_b16 v[176:177], v156 offset:0
    v_mfma_f32_16x16x32_bf16 v[20:23], v[188:191], a[168:171], v[20:23]
    ds_read_b64_tr_b16 v[178:179], v156 offset:1024
    v_mfma_f32_16x16x32_bf16 v[28:31], v[184:187], a[164:167], v[28:31]
    ds_read_b64_tr_b16 v[180:181], v156 offset:8192
    v_mfma_f32_16x16x32_bf16 v[28:31], v[188:191], a[172:175], v[28:31]
    ds_read_b64_tr_b16 v[182:183], v156 offset:9216
    v_mfma_f32_16x16x32_bf16 v[84:87], v[184:187], a[176:179], v[84:87]
    buffer_load_dwordx4 a[136:139], v7, s[32:35], s27 offen offset:2048 sc1
    v_mfma_f32_16x16x32_bf16 v[84:87], v[188:191], a[184:187], v[84:87]
    v_mfma_f32_16x16x32_bf16 v[92:95], v[184:187], a[180:183], v[92:95]
    buffer_load_dwordx4 a[140:143], v7, s[32:35], s27 offen offset:3072 sc1
    s_add_u32 s27, s27, 0x40000
    v_mfma_f32_16x16x32_bf16 v[92:95], v[188:191], a[188:191], v[92:95]
    s_waitcnt lgkmcnt(8)
    v_mfma_f32_16x16x32_bf16 v[32:35], v[192:195], a[160:163], v[32:35]
    ds_read_b64_tr_b16 v[184:185], v157 offset:0
    v_mfma_f32_16x16x32_bf16 v[32:35], v[196:199], a[168:171], v[32:35]
    ds_read_b64_tr_b16 v[186:187], v157 offset:1024
    v_mfma_f32_16x16x32_bf16 v[40:43], v[192:195], a[164:167], v[40:43]
    ds_read_b64_tr_b16 v[188:189], v157 offset:8192
    v_mfma_f32_16x16x32_bf16 v[40:43], v[196:199], a[172:175], v[40:43]
    ds_read_b64_tr_b16 v[190:191], v157 offset:9216
    v_mfma_f32_16x16x32_bf16 v[96:99], v[192:195], a[176:179], v[96:99]
    buffer_load_dwordx4 a[144:147], v7, s[32:35], s31 offen offset:0 sc1
    v_mfma_f32_16x16x32_bf16 v[96:99], v[196:199], a[184:187], v[96:99]
    v_mfma_f32_16x16x32_bf16 v[104:107], v[192:195], a[180:183], v[104:107]
    buffer_load_dwordx4 a[148:151], v7, s[32:35], s31 offen offset:1024 sc1
    v_mfma_f32_16x16x32_bf16 v[104:107], v[196:199], a[188:191], v[104:107]
    s_waitcnt lgkmcnt(8)
    v_mfma_f32_16x16x32_bf16 v[36:39], v[200:203], a[160:163], v[36:39]
    ds_read_b64_tr_b16 v[192:193], v158 offset:0
    v_mfma_f32_16x16x32_bf16 v[36:39], v[204:207], a[168:171], v[36:39]
    ds_read_b64_tr_b16 v[194:195], v158 offset:1024
    v_mfma_f32_16x16x32_bf16 v[44:47], v[200:203], a[164:167], v[44:47]
    ds_read_b64_tr_b16 v[196:197], v158 offset:8192
    v_mfma_f32_16x16x32_bf16 v[44:47], v[204:207], a[172:175], v[44:47]
    ds_read_b64_tr_b16 v[198:199], v158 offset:9216
    v_mfma_f32_16x16x32_bf16 v[100:103], v[200:203], a[176:179], v[100:103]
    buffer_load_dwordx4 a[152:155], v7, s[32:35], s31 offen offset:2048 sc1
    v_mfma_f32_16x16x32_bf16 v[100:103], v[204:207], a[184:187], v[100:103]
    v_mfma_f32_16x16x32_bf16 v[108:111], v[200:203], a[180:183], v[108:111]
    buffer_load_dwordx4 a[156:159], v7, s[32:35], s31 offen offset:3072 sc1
    s_add_u32 s31, s31, 0x40000
    v_mfma_f32_16x16x32_bf16 v[108:111], v[204:207], a[188:191], v[108:111]
    s_waitcnt lgkmcnt(8)
    v_mfma_f32_16x16x32_bf16 v[48:51], v[176:179], a[160:163], v[48:51]
    ds_read_b64_tr_b16 v[200:201], v159 offset:0
    v_mfma_f32_16x16x32_bf16 v[48:51], v[180:183], a[168:171], v[48:51]
    ds_read_b64_tr_b16 v[202:203], v159 offset:1024
    v_mfma_f32_16x16x32_bf16 v[56:59], v[176:179], a[164:167], v[56:59]
    ds_read_b64_tr_b16 v[204:205], v159 offset:8192
    v_mfma_f32_16x16x32_bf16 v[56:59], v[180:183], a[172:175], v[56:59]
    ds_read_b64_tr_b16 v[206:207], v159 offset:9216
    v_mfma_f32_16x16x32_bf16 v[112:115], v[176:179], a[176:179], v[112:115]
    buffer_load_dwordx4 a[64:67], v7, s[32:35], s53 offen offset:0 sc1
    v_mfma_f32_16x16x32_bf16 v[112:115], v[180:183], a[184:187], v[112:115]
    v_mfma_f32_16x16x32_bf16 v[120:123], v[176:179], a[180:183], v[120:123]
    buffer_load_dwordx4 a[68:71], v7, s[32:35], s53 offen offset:1024 sc1
    v_mfma_f32_16x16x32_bf16 v[120:123], v[180:183], a[188:191], v[120:123]
    s_waitcnt lgkmcnt(8)
    v_mfma_f32_16x16x32_bf16 v[52:55], v[184:187], a[160:163], v[52:55]
    v_mfma_f32_16x16x32_bf16 v[52:55], v[188:191], a[168:171], v[52:55]
    v_mfma_f32_16x16x32_bf16 v[60:63], v[184:187], a[164:167], v[60:63]
    s_waitcnt vmcnt(44) lgkmcnt(0)
    s_barrier
    v_mfma_f32_16x16x32_bf16 v[60:63], v[188:191], a[172:175], v[60:63]
    ds_read_b64_tr_b16 v[176:177], v152 offset:16384
    ds_read_b64_tr_b16 v[178:179], v152 offset:17408
    v_mfma_f32_16x16x32_bf16 v[116:119], v[184:187], a[176:179], v[116:119]
    ds_read_b64_tr_b16 v[180:181], v152 offset:24576
    ds_read_b64_tr_b16 v[182:183], v152 offset:25600
    v_mfma_f32_16x16x32_bf16 v[116:119], v[188:191], a[184:187], v[116:119]
    s_add_u32 m0, s30, 0
    s_nop 0
    buffer_load_dwordx4 v168, s[8:11], s28 offen offset:0 lds
    v_mfma_f32_16x16x32_bf16 v[124:127], v[184:187], a[180:183], v[124:127]
    v_mfma_f32_16x16x32_bf16 v[124:127], v[188:191], a[188:191], v[124:127]
    buffer_load_dwordx4 v169, s[8:11], s28 offen offset:1024 lds
    v_mfma_f32_16x16x32_bf16 v[64:67], v[192:195], a[160:163], v[64:67]
    ds_read_b64_tr_b16 v[184:185], v153 offset:16384
    v_mfma_f32_16x16x32_bf16 v[64:67], v[196:199], a[168:171], v[64:67]
    ds_read_b64_tr_b16 v[186:187], v153 offset:17408
    v_mfma_f32_16x16x32_bf16 v[72:75], v[192:195], a[164:167], v[72:75]
    ds_read_b64_tr_b16 v[188:189], v153 offset:24576
    v_mfma_f32_16x16x32_bf16 v[72:75], v[196:199], a[172:175], v[72:75]
    ds_read_b64_tr_b16 v[190:191], v153 offset:25600
    v_mfma_f32_16x16x32_bf16 v[128:131], v[192:195], a[176:179], v[128:131]
    buffer_load_dwordx4 v170, s[8:11], s28 offen offset:2048 lds
    v_mfma_f32_16x16x32_bf16 v[128:131], v[196:199], a[184:187], v[128:131]
    v_mfma_f32_16x16x32_bf16 v[136:139], v[192:195], a[180:183], v[136:139]
    buffer_load_dwordx4 v171, s[8:11], s28 offen offset:3072 lds
    s_add_u32 s28, s28, 0x20000
    v_mfma_f32_16x16x32_bf16 v[136:139], v[196:199], a[188:191], v[136:139]
    v_mfma_f32_16x16x32_bf16 v[68:71], v[200:203], a[160:163], v[68:71]
    ds_read_b64_tr_b16 v[192:193], v154 offset:16384
    v_mfma_f32_16x16x32_bf16 v[68:71], v[204:207], a[168:171], v[68:71]
    ds_read_b64_tr_b16 v[194:195], v154 offset:17408
    v_mfma_f32_16x16x32_bf16 v[76:79], v[200:203], a[164:167], v[76:79]
    ds_read_b64_tr_b16 v[196:197], v154 offset:24576
    v_mfma_f32_16x16x32_bf16 v[76:79], v[204:207], a[172:175], v[76:79]
    ds_read_b64_tr_b16 v[198:199], v154 offset:25600
    v_mfma_f32_16x16x32_bf16 v[132:135], v[200:203], a[176:179], v[132:135]
    buffer_load_dwordx4 a[72:75], v7, s[32:35], s53 offen offset:2048 sc1
    v_mfma_f32_16x16x32_bf16 v[132:135], v[204:207], a[184:187], v[132:135]
    v_mfma_f32_16x16x32_bf16 v[140:143], v[200:203], a[180:183], v[140:143]
    buffer_load_dwordx4 a[76:79], v7, s[32:35], s53 offen offset:3072 sc1
    s_add_u32 s53, s53, 0x40000
    v_mfma_f32_16x16x32_bf16 v[140:143], v[204:207], a[188:191], v[140:143]
    s_waitcnt vmcnt(24) lgkmcnt(8)
    v_mfma_f32_16x16x32_bf16 v[16:19], v[176:179], a[96:99], v[16:19]
    ds_read_b64_tr_b16 v[200:201], v155 offset:16384
    v_mfma_f32_16x16x32_bf16 v[16:19], v[180:183], a[104:107], v[16:19]
    ds_read_b64_tr_b16 v[202:203], v155 offset:17408
    v_mfma_f32_16x16x32_bf16 v[24:27], v[176:179], a[100:103], v[24:27]
    ds_read_b64_tr_b16 v[204:205], v155 offset:24576
    v_mfma_f32_16x16x32_bf16 v[24:27], v[180:183], a[108:111], v[24:27]
    ds_read_b64_tr_b16 v[206:207], v155 offset:25600
    v_mfma_f32_16x16x32_bf16 v[80:83], v[176:179], a[112:115], v[80:83]
    buffer_load_dwordx4 a[160:163], v7, s[32:35], s27 offen offset:0 sc1
    v_mfma_f32_16x16x32_bf16 v[80:83], v[180:183], a[120:123], v[80:83]
    v_mfma_f32_16x16x32_bf16 v[88:91], v[176:179], a[116:119], v[88:91]
    buffer_load_dwordx4 a[164:167], v7, s[32:35], s27 offen offset:1024 sc1
    v_mfma_f32_16x16x32_bf16 v[88:91], v[180:183], a[124:127], v[88:91]
    s_waitcnt lgkmcnt(8)
    v_mfma_f32_16x16x32_bf16 v[20:23], v[184:187], a[96:99], v[20:23]
    ds_read_b64_tr_b16 v[176:177], v156 offset:16384
    v_mfma_f32_16x16x32_bf16 v[20:23], v[188:191], a[104:107], v[20:23]
    ds_read_b64_tr_b16 v[178:179], v156 offset:17408
    v_mfma_f32_16x16x32_bf16 v[28:31], v[184:187], a[100:103], v[28:31]
    ds_read_b64_tr_b16 v[180:181], v156 offset:24576
    v_mfma_f32_16x16x32_bf16 v[28:31], v[188:191], a[108:111], v[28:31]
    ds_read_b64_tr_b16 v[182:183], v156 offset:25600
    v_mfma_f32_16x16x32_bf16 v[84:87], v[184:187], a[112:115], v[84:87]
    buffer_load_dwordx4 a[168:171], v7, s[32:35], s27 offen offset:2048 sc1
    v_mfma_f32_16x16x32_bf16 v[84:87], v[188:191], a[120:123], v[84:87]
    v_mfma_f32_16x16x32_bf16 v[92:95], v[184:187], a[116:119], v[92:95]
    buffer_load_dwordx4 a[172:175], v7, s[32:35], s27 offen offset:3072 sc1
    s_add_u32 s27, s27, 0x40000
    v_mfma_f32_16x16x32_bf16 v[92:95], v[188:191], a[124:127], v[92:95]
    s_waitcnt lgkmcnt(8)
    v_mfma_f32_16x16x32_bf16 v[32:35], v[192:195], a[96:99], v[32:35]
    ds_read_b64_tr_b16 v[184:185], v157 offset:16384
    v_mfma_f32_16x16x32_bf16 v[32:35], v[196:199], a[104:107], v[32:35]
    ds_read_b64_tr_b16 v[186:187], v157 offset:17408
    v_mfma_f32_16x16x32_bf16 v[40:43], v[192:195], a[100:103], v[40:43]
    ds_read_b64_tr_b16 v[188:189], v157 offset:24576
    v_mfma_f32_16x16x32_bf16 v[40:43], v[196:199], a[108:111], v[40:43]
    ds_read_b64_tr_b16 v[190:191], v157 offset:25600
    v_mfma_f32_16x16x32_bf16 v[96:99], v[192:195], a[112:115], v[96:99]
    buffer_load_dwordx4 a[176:179], v7, s[32:35], s31 offen offset:0 sc1
    v_mfma_f32_16x16x32_bf16 v[96:99], v[196:199], a[120:123], v[96:99]
    v_mfma_f32_16x16x32_bf16 v[104:107], v[192:195], a[116:119], v[104:107]
    buffer_load_dwordx4 a[180:183], v7, s[32:35], s31 offen offset:1024 sc1
    v_mfma_f32_16x16x32_bf16 v[104:107], v[196:199], a[124:127], v[104:107]
    s_waitcnt lgkmcnt(8)
    v_mfma_f32_16x16x32_bf16 v[36:39], v[200:203], a[96:99], v[36:39]
    ds_read_b64_tr_b16 v[192:193], v158 offset:16384
    v_mfma_f32_16x16x32_bf16 v[36:39], v[204:207], a[104:107], v[36:39]
    ds_read_b64_tr_b16 v[194:195], v158 offset:17408
    v_mfma_f32_16x16x32_bf16 v[44:47], v[200:203], a[100:103], v[44:47]
    ds_read_b64_tr_b16 v[196:197], v158 offset:24576
    v_mfma_f32_16x16x32_bf16 v[44:47], v[204:207], a[108:111], v[44:47]
    ds_read_b64_tr_b16 v[198:199], v158 offset:25600
    v_mfma_f32_16x16x32_bf16 v[100:103], v[200:203], a[112:115], v[100:103]
    buffer_load_dwordx4 a[184:187], v7, s[32:35], s31 offen offset:2048 sc1
    v_mfma_f32_16x16x32_bf16 v[100:103], v[204:207], a[120:123], v[100:103]
    v_mfma_f32_16x16x32_bf16 v[108:111], v[200:203], a[116:119], v[108:111]
    buffer_load_dwordx4 a[188:191], v7, s[32:35], s31 offen offset:3072 sc1
    s_add_u32 s31, s31, 0x40000
    v_mfma_f32_16x16x32_bf16 v[108:111], v[204:207], a[124:127], v[108:111]
    s_waitcnt lgkmcnt(8)
    v_mfma_f32_16x16x32_bf16 v[48:51], v[176:179], a[96:99], v[48:51]
    ds_read_b64_tr_b16 v[200:201], v159 offset:16384
    v_mfma_f32_16x16x32_bf16 v[48:51], v[180:183], a[104:107], v[48:51]
    ds_read_b64_tr_b16 v[202:203], v159 offset:17408
    v_mfma_f32_16x16x32_bf16 v[56:59], v[176:179], a[100:103], v[56:59]
    ds_read_b64_tr_b16 v[204:205], v159 offset:24576
    v_mfma_f32_16x16x32_bf16 v[56:59], v[180:183], a[108:111], v[56:59]
    ds_read_b64_tr_b16 v[206:207], v159 offset:25600
    v_mfma_f32_16x16x32_bf16 v[112:115], v[176:179], a[112:115], v[112:115]
    buffer_load_dwordx4 a[80:83], v7, s[32:35], s53 offen offset:0 sc1
    v_mfma_f32_16x16x32_bf16 v[112:115], v[180:183], a[120:123], v[112:115]
    v_mfma_f32_16x16x32_bf16 v[120:123], v[176:179], a[116:119], v[120:123]
    buffer_load_dwordx4 a[84:87], v7, s[32:35], s53 offen offset:1024 sc1
    v_mfma_f32_16x16x32_bf16 v[120:123], v[180:183], a[124:127], v[120:123]
    s_waitcnt lgkmcnt(8)
    v_mfma_f32_16x16x32_bf16 v[52:55], v[184:187], a[96:99], v[52:55]
    v_mfma_f32_16x16x32_bf16 v[52:55], v[188:191], a[104:107], v[52:55]
    v_mfma_f32_16x16x32_bf16 v[60:63], v[184:187], a[100:103], v[60:63]
    s_waitcnt vmcnt(44) lgkmcnt(0)
    s_barrier
    v_mfma_f32_16x16x32_bf16 v[60:63], v[188:191], a[108:111], v[60:63]
    ds_read_b64_tr_b16 v[176:177], v152 offset:32768
    ds_read_b64_tr_b16 v[178:179], v152 offset:33792
    v_mfma_f32_16x16x32_bf16 v[116:119], v[184:187], a[112:115], v[116:119]
    ds_read_b64_tr_b16 v[180:181], v152 offset:40960
    ds_read_b64_tr_b16 v[182:183], v152 offset:41984
    v_mfma_f32_16x16x32_bf16 v[116:119], v[188:191], a[120:123], v[116:119]
    s_add_u32 m0, s30, 16384
    s_nop 0
    buffer_load_dwordx4 v168, s[8:11], s28 offen offset:0 lds
    v_mfma_f32_16x16x32_bf16 v[124:127], v[184:187], a[116:119], v[124:127]
    v_mfma_f32_16x16x32_bf16 v[124:127], v[188:191], a[124:127], v[124:127]
    buffer_load_dwordx4 v169, s[8:11], s28 offen offset:1024 lds
    v_mfma_f32_16x16x32_bf16 v[64:67], v[192:195], a[96:99], v[64:67]
    ds_read_b64_tr_b16 v[184:185], v153 offset:32768
    v_mfma_f32_16x16x32_bf16 v[64:67], v[196:199], a[104:107], v[64:67]
    ds_read_b64_tr_b16 v[186:187], v153 offset:33792
    v_mfma_f32_16x16x32_bf16 v[72:75], v[192:195], a[100:103], v[72:75]
    ds_read_b64_tr_b16 v[188:189], v153 offset:40960
    v_mfma_f32_16x16x32_bf16 v[72:75], v[196:199], a[108:111], v[72:75]
    ds_read_b64_tr_b16 v[190:191], v153 offset:41984
    v_mfma_f32_16x16x32_bf16 v[128:131], v[192:195], a[112:115], v[128:131]
    buffer_load_dwordx4 v170, s[8:11], s28 offen offset:2048 lds
    v_mfma_f32_16x16x32_bf16 v[128:131], v[196:199], a[120:123], v[128:131]
    v_mfma_f32_16x16x32_bf16 v[136:139], v[192:195], a[116:119], v[136:139]
    buffer_load_dwordx4 v171, s[8:11], s28 offen offset:3072 lds
    s_add_u32 s28, s28, 0x20000
    v_mfma_f32_16x16x32_bf16 v[136:139], v[196:199], a[124:127], v[136:139]
    v_mfma_f32_16x16x32_bf16 v[68:71], v[200:203], a[96:99], v[68:71]
    ds_read_b64_tr_b16 v[192:193], v154 offset:32768
    v_mfma_f32_16x16x32_bf16 v[68:71], v[204:207], a[104:107], v[68:71]
    ds_read_b64_tr_b16 v[194:195], v154 offset:33792
    v_mfma_f32_16x16x32_bf16 v[76:79], v[200:203], a[100:103], v[76:79]
    ds_read_b64_tr_b16 v[196:197], v154 offset:40960
    v_mfma_f32_16x16x32_bf16 v[76:79], v[204:207], a[108:111], v[76:79]
    ds_read_b64_tr_b16 v[198:199], v154 offset:41984
    v_mfma_f32_16x16x32_bf16 v[132:135], v[200:203], a[112:115], v[132:135]
    buffer_load_dwordx4 a[88:91], v7, s[32:35], s53 offen offset:2048 sc1
    v_mfma_f32_16x16x32_bf16 v[132:135], v[204:207], a[120:123], v[132:135]
    v_mfma_f32_16x16x32_bf16 v[140:143], v[200:203], a[116:119], v[140:143]
    buffer_load_dwordx4 a[92:95], v7, s[32:35], s53 offen offset:3072 sc1
    s_add_u32 s53, s53, 0x40000
    v_mfma_f32_16x16x32_bf16 v[140:143], v[204:207], a[124:127], v[140:143]
    s_waitcnt vmcnt(24) lgkmcnt(8)
    v_mfma_f32_16x16x32_bf16 v[16:19], v[176:179], a[128:131], v[16:19]
    ds_read_b64_tr_b16 v[200:201], v155 offset:32768
    v_mfma_f32_16x16x32_bf16 v[16:19], v[180:183], a[136:139], v[16:19]
    ds_read_b64_tr_b16 v[202:203], v155 offset:33792
    v_mfma_f32_16x16x32_bf16 v[24:27], v[176:179], a[132:135], v[24:27]
    ds_read_b64_tr_b16 v[204:205], v155 offset:40960
    v_mfma_f32_16x16x32_bf16 v[24:27], v[180:183], a[140:143], v[24:27]
    ds_read_b64_tr_b16 v[206:207], v155 offset:41984
    v_mfma_f32_16x16x32_bf16 v[80:83], v[176:179], a[144:147], v[80:83]
    buffer_load_dwordx4 a[96:99], v7, s[32:35], s27 offen offset:0 sc1
    v_mfma_f32_16x16x32_bf16 v[80:83], v[180:183], a[152:155], v[80:83]
    v_mfma_f32_16x16x32_bf16 v[88:91], v[176:179], a[148:151], v[88:91]
    buffer_load_dwordx4 a[100:103], v7, s[32:35], s27 offen offset:1024 sc1
    v_mfma_f32_16x16x32_bf16 v[88:91], v[180:183], a[156:159], v[88:91]
    s_waitcnt lgkmcnt(8)
    v_mfma_f32_16x16x32_bf16 v[20:23], v[184:187], a[128:131], v[20:23]
    ds_read_b64_tr_b16 v[176:177], v156 offset:32768
    v_mfma_f32_16x16x32_bf16 v[20:23], v[188:191], a[136:139], v[20:23]
    ds_read_b64_tr_b16 v[178:179], v156 offset:33792
    v_mfma_f32_16x16x32_bf16 v[28:31], v[184:187], a[132:135], v[28:31]
    ds_read_b64_tr_b16 v[180:181], v156 offset:40960
    v_mfma_f32_16x16x32_bf16 v[28:31], v[188:191], a[140:143], v[28:31]
    ds_read_b64_tr_b16 v[182:183], v156 offset:41984
    v_mfma_f32_16x16x32_bf16 v[84:87], v[184:187], a[144:147], v[84:87]
    buffer_load_dwordx4 a[104:107], v7, s[32:35], s27 offen offset:2048 sc1
    v_mfma_f32_16x16x32_bf16 v[84:87], v[188:191], a[152:155], v[84:87]
    v_mfma_f32_16x16x32_bf16 v[92:95], v[184:187], a[148:151], v[92:95]
    buffer_load_dwordx4 a[108:111], v7, s[32:35], s27 offen offset:3072 sc1
    s_add_u32 s27, s27, 0x40000
    v_mfma_f32_16x16x32_bf16 v[92:95], v[188:191], a[156:159], v[92:95]
    s_waitcnt lgkmcnt(8)
    v_mfma_f32_16x16x32_bf16 v[32:35], v[192:195], a[128:131], v[32:35]
    ds_read_b64_tr_b16 v[184:185], v157 offset:32768
    v_mfma_f32_16x16x32_bf16 v[32:35], v[196:199], a[136:139], v[32:35]
    ds_read_b64_tr_b16 v[186:187], v157 offset:33792
    v_mfma_f32_16x16x32_bf16 v[40:43], v[192:195], a[132:135], v[40:43]
    ds_read_b64_tr_b16 v[188:189], v157 offset:40960
    v_mfma_f32_16x16x32_bf16 v[40:43], v[196:199], a[140:143], v[40:43]
    ds_read_b64_tr_b16 v[190:191], v157 offset:41984
    v_mfma_f32_16x16x32_bf16 v[96:99], v[192:195], a[144:147], v[96:99]
    buffer_load_dwordx4 a[112:115], v7, s[32:35], s31 offen offset:0 sc1
    v_mfma_f32_16x16x32_bf16 v[96:99], v[196:199], a[152:155], v[96:99]
    v_mfma_f32_16x16x32_bf16 v[104:107], v[192:195], a[148:151], v[104:107]
    buffer_load_dwordx4 a[116:119], v7, s[32:35], s31 offen offset:1024 sc1
    v_mfma_f32_16x16x32_bf16 v[104:107], v[196:199], a[156:159], v[104:107]
    s_waitcnt lgkmcnt(8)
    v_mfma_f32_16x16x32_bf16 v[36:39], v[200:203], a[128:131], v[36:39]
    ds_read_b64_tr_b16 v[192:193], v158 offset:32768
    v_mfma_f32_16x16x32_bf16 v[36:39], v[204:207], a[136:139], v[36:39]
    ds_read_b64_tr_b16 v[194:195], v158 offset:33792
    v_mfma_f32_16x16x32_bf16 v[44:47], v[200:203], a[132:135], v[44:47]
    ds_read_b64_tr_b16 v[196:197], v158 offset:40960
    v_mfma_f32_16x16x32_bf16 v[44:47], v[204:207], a[140:143], v[44:47]
    ds_read_b64_tr_b16 v[198:199], v158 offset:41984
    v_mfma_f32_16x16x32_bf16 v[100:103], v[200:203], a[144:147], v[100:103]
    buffer_load_dwordx4 a[120:123], v7, s[32:35], s31 offen offset:2048 sc1
    v_mfma_f32_16x16x32_bf16 v[100:103], v[204:207], a[152:155], v[100:103]
    v_mfma_f32_16x16x32_bf16 v[108:111], v[200:203], a[148:151], v[108:111]
    buffer_load_dwordx4 a[124:127], v7, s[32:35], s31 offen offset:3072 sc1
    s_add_u32 s31, s31, 0x40000
    v_mfma_f32_16x16x32_bf16 v[108:111], v[204:207], a[156:159], v[108:111]
    s_waitcnt lgkmcnt(8)
    v_mfma_f32_16x16x32_bf16 v[48:51], v[176:179], a[128:131], v[48:51]
    ds_read_b64_tr_b16 v[200:201], v159 offset:32768
    v_mfma_f32_16x16x32_bf16 v[48:51], v[180:183], a[136:139], v[48:51]
    ds_read_b64_tr_b16 v[202:203], v159 offset:33792
    v_mfma_f32_16x16x32_bf16 v[56:59], v[176:179], a[132:135], v[56:59]
    ds_read_b64_tr_b16 v[204:205], v159 offset:40960
    v_mfma_f32_16x16x32_bf16 v[56:59], v[180:183], a[140:143], v[56:59]
    ds_read_b64_tr_b16 v[206:207], v159 offset:41984
    v_mfma_f32_16x16x32_bf16 v[112:115], v[176:179], a[144:147], v[112:115]
    buffer_load_dwordx4 a[192:195], v7, s[32:35], s53 offen offset:0 sc1
    v_mfma_f32_16x16x32_bf16 v[112:115], v[180:183], a[152:155], v[112:115]
    v_mfma_f32_16x16x32_bf16 v[120:123], v[176:179], a[148:151], v[120:123]
    buffer_load_dwordx4 a[196:199], v7, s[32:35], s53 offen offset:1024 sc1
    v_mfma_f32_16x16x32_bf16 v[120:123], v[180:183], a[156:159], v[120:123]
    s_waitcnt lgkmcnt(8)
    v_mfma_f32_16x16x32_bf16 v[52:55], v[184:187], a[128:131], v[52:55]
    v_mfma_f32_16x16x32_bf16 v[52:55], v[188:191], a[136:139], v[52:55]
    v_mfma_f32_16x16x32_bf16 v[60:63], v[184:187], a[132:135], v[60:63]
    s_waitcnt vmcnt(44) lgkmcnt(0)
    s_barrier
    v_mfma_f32_16x16x32_bf16 v[60:63], v[188:191], a[140:143], v[60:63]
    ds_read_b64_tr_b16 v[176:177], v152 offset:49152
    ds_read_b64_tr_b16 v[178:179], v152 offset:50176
    v_mfma_f32_16x16x32_bf16 v[116:119], v[184:187], a[144:147], v[116:119]
    ds_read_b64_tr_b16 v[180:181], v152 offset:57344
    ds_read_b64_tr_b16 v[182:183], v152 offset:58368
    v_mfma_f32_16x16x32_bf16 v[116:119], v[188:191], a[152:155], v[116:119]
    buffer_load_dwordx4 a[200:203], v7, s[32:35], s53 offen offset:2048 sc1
    v_mfma_f32_16x16x32_bf16 v[124:127], v[184:187], a[148:151], v[124:127]
    v_mfma_f32_16x16x32_bf16 v[124:127], v[188:191], a[156:159], v[124:127]
    buffer_load_dwordx4 a[204:207], v7, s[32:35], s53 offen offset:3072 sc1
    s_add_u32 s53, s53, 0x40000
    v_mfma_f32_16x16x32_bf16 v[64:67], v[192:195], a[128:131], v[64:67]
    ds_read_b64_tr_b16 v[184:185], v153 offset:49152
    v_mfma_f32_16x16x32_bf16 v[64:67], v[196:199], a[136:139], v[64:67]
    ds_read_b64_tr_b16 v[186:187], v153 offset:50176
    v_mfma_f32_16x16x32_bf16 v[72:75], v[192:195], a[132:135], v[72:75]
    ds_read_b64_tr_b16 v[188:189], v153 offset:57344
    v_mfma_f32_16x16x32_bf16 v[72:75], v[196:199], a[140:143], v[72:75]
    ds_read_b64_tr_b16 v[190:191], v153 offset:58368
    v_mfma_f32_16x16x32_bf16 v[128:131], v[192:195], a[144:147], v[128:131]
    buffer_load_dwordx4 a[208:211], v7, s[32:35], s53 offen offset:0 sc1
    v_mfma_f32_16x16x32_bf16 v[128:131], v[196:199], a[152:155], v[128:131]
    v_mfma_f32_16x16x32_bf16 v[136:139], v[192:195], a[148:151], v[136:139]
    buffer_load_dwordx4 a[212:215], v7, s[32:35], s53 offen offset:1024 sc1
    v_mfma_f32_16x16x32_bf16 v[136:139], v[196:199], a[156:159], v[136:139]
    v_mfma_f32_16x16x32_bf16 v[68:71], v[200:203], a[128:131], v[68:71]
    ds_read_b64_tr_b16 v[192:193], v154 offset:49152
    v_mfma_f32_16x16x32_bf16 v[68:71], v[204:207], a[136:139], v[68:71]
    ds_read_b64_tr_b16 v[194:195], v154 offset:50176
    v_mfma_f32_16x16x32_bf16 v[76:79], v[200:203], a[132:135], v[76:79]
    ds_read_b64_tr_b16 v[196:197], v154 offset:57344
    v_mfma_f32_16x16x32_bf16 v[76:79], v[204:207], a[140:143], v[76:79]
    ds_read_b64_tr_b16 v[198:199], v154 offset:58368
    v_mfma_f32_16x16x32_bf16 v[132:135], v[200:203], a[144:147], v[132:135]
    buffer_load_dwordx4 a[216:219], v7, s[32:35], s53 offen offset:2048 sc1
    v_mfma_f32_16x16x32_bf16 v[132:135], v[204:207], a[152:155], v[132:135]
    v_mfma_f32_16x16x32_bf16 v[140:143], v[200:203], a[148:151], v[140:143]
    buffer_load_dwordx4 a[220:223], v7, s[32:35], s53 offen offset:3072 sc1
    s_add_u32 s53, s53, 0x40000
    v_mfma_f32_16x16x32_bf16 v[140:143], v[204:207], a[156:159], v[140:143]
    s_waitcnt vmcnt(24) lgkmcnt(8)
    v_mfma_f32_16x16x32_bf16 v[16:19], v[176:179], a[160:163], v[16:19]
    ds_read_b64_tr_b16 v[200:201], v155 offset:49152
    v_mfma_f32_16x16x32_bf16 v[16:19], v[180:183], a[168:171], v[16:19]
    ds_read_b64_tr_b16 v[202:203], v155 offset:50176
    v_mfma_f32_16x16x32_bf16 v[24:27], v[176:179], a[164:167], v[24:27]
    ds_read_b64_tr_b16 v[204:205], v155 offset:57344
    v_mfma_f32_16x16x32_bf16 v[24:27], v[180:183], a[172:175], v[24:27]
    ds_read_b64_tr_b16 v[206:207], v155 offset:58368
    v_mfma_f32_16x16x32_bf16 v[80:83], v[176:179], a[176:179], v[80:83]
    buffer_load_dwordx4 a[128:131], v7, s[32:35], s27 offen offset:0 sc1
    v_mfma_f32_16x16x32_bf16 v[80:83], v[180:183], a[184:187], v[80:83]
    v_mfma_f32_16x16x32_bf16 v[88:91], v[176:179], a[180:183], v[88:91]
    buffer_load_dwordx4 a[132:135], v7, s[32:35], s27 offen offset:1024 sc1
    v_mfma_f32_16x16x32_bf16 v[88:91], v[180:183], a[188:191], v[88:91]
    s_waitcnt lgkmcnt(8)
    v_mfma_f32_16x16x32_bf16 v[20:23], v[184:187], a[160:163], v[20:23]
    ds_read_b64_tr_b16 v[176:177], v156 offset:49152
    v_mfma_f32_16x16x32_bf16 v[20:23], v[188:191], a[168:171], v[20:23]
    ds_read_b64_tr_b16 v[178:179], v156 offset:50176
    v_mfma_f32_16x16x32_bf16 v[28:31], v[184:187], a[164:167], v[28:31]
    ds_read_b64_tr_b16 v[180:181], v156 offset:57344
    v_mfma_f32_16x16x32_bf16 v[28:31], v[188:191], a[172:175], v[28:31]
    ds_read_b64_tr_b16 v[182:183], v156 offset:58368
    v_mfma_f32_16x16x32_bf16 v[84:87], v[184:187], a[176:179], v[84:87]
    buffer_load_dwordx4 a[136:139], v7, s[32:35], s27 offen offset:2048 sc1
    v_mfma_f32_16x16x32_bf16 v[84:87], v[188:191], a[184:187], v[84:87]
    v_mfma_f32_16x16x32_bf16 v[92:95], v[184:187], a[180:183], v[92:95]
    buffer_load_dwordx4 a[140:143], v7, s[32:35], s27 offen offset:3072 sc1
    s_add_u32 s27, s27, 0x40000
    v_mfma_f32_16x16x32_bf16 v[92:95], v[188:191], a[188:191], v[92:95]
    s_waitcnt lgkmcnt(8)
    v_mfma_f32_16x16x32_bf16 v[32:35], v[192:195], a[160:163], v[32:35]
    ds_read_b64_tr_b16 v[184:185], v157 offset:49152
    v_mfma_f32_16x16x32_bf16 v[32:35], v[196:199], a[168:171], v[32:35]
    ds_read_b64_tr_b16 v[186:187], v157 offset:50176
    v_mfma_f32_16x16x32_bf16 v[40:43], v[192:195], a[164:167], v[40:43]
    ds_read_b64_tr_b16 v[188:189], v157 offset:57344
    v_mfma_f32_16x16x32_bf16 v[40:43], v[196:199], a[172:175], v[40:43]
    ds_read_b64_tr_b16 v[190:191], v157 offset:58368
    v_mfma_f32_16x16x32_bf16 v[96:99], v[192:195], a[176:179], v[96:99]
    buffer_load_dwordx4 a[144:147], v7, s[32:35], s31 offen offset:0 sc1
    v_mfma_f32_16x16x32_bf16 v[96:99], v[196:199], a[184:187], v[96:99]
    v_mfma_f32_16x16x32_bf16 v[104:107], v[192:195], a[180:183], v[104:107]
    buffer_load_dwordx4 a[148:151], v7, s[32:35], s31 offen offset:1024 sc1
    v_mfma_f32_16x16x32_bf16 v[104:107], v[196:199], a[188:191], v[104:107]
    s_waitcnt lgkmcnt(8)
    v_mfma_f32_16x16x32_bf16 v[36:39], v[200:203], a[160:163], v[36:39]
    ds_read_b64_tr_b16 v[192:193], v158 offset:49152
    v_mfma_f32_16x16x32_bf16 v[36:39], v[204:207], a[168:171], v[36:39]
    ds_read_b64_tr_b16 v[194:195], v158 offset:50176
    v_mfma_f32_16x16x32_bf16 v[44:47], v[200:203], a[164:167], v[44:47]
    ds_read_b64_tr_b16 v[196:197], v158 offset:57344
    v_mfma_f32_16x16x32_bf16 v[44:47], v[204:207], a[172:175], v[44:47]
    ds_read_b64_tr_b16 v[198:199], v158 offset:58368
    v_mfma_f32_16x16x32_bf16 v[100:103], v[200:203], a[176:179], v[100:103]
    buffer_load_dwordx4 a[152:155], v7, s[32:35], s31 offen offset:2048 sc1
    v_mfma_f32_16x16x32_bf16 v[100:103], v[204:207], a[184:187], v[100:103]
    v_mfma_f32_16x16x32_bf16 v[108:111], v[200:203], a[180:183], v[108:111]
    buffer_load_dwordx4 a[156:159], v7, s[32:35], s31 offen offset:3072 sc1
    s_add_u32 s31, s31, 0x40000
    v_mfma_f32_16x16x32_bf16 v[108:111], v[204:207], a[188:191], v[108:111]
    s_waitcnt lgkmcnt(8)
    v_mfma_f32_16x16x32_bf16 v[48:51], v[176:179], a[160:163], v[48:51]
    ds_read_b64_tr_b16 v[200:201], v159 offset:49152
    v_mfma_f32_16x16x32_bf16 v[48:51], v[180:183], a[168:171], v[48:51]
    ds_read_b64_tr_b16 v[202:203], v159 offset:50176
    v_mfma_f32_16x16x32_bf16 v[56:59], v[176:179], a[164:167], v[56:59]
    ds_read_b64_tr_b16 v[204:205], v159 offset:57344
    v_mfma_f32_16x16x32_bf16 v[56:59], v[180:183], a[172:175], v[56:59]
    ds_read_b64_tr_b16 v[206:207], v159 offset:58368
    v_mfma_f32_16x16x32_bf16 v[112:115], v[176:179], a[176:179], v[112:115]
    s_add_u32 m0, s30, 32768
    s_nop 0
    buffer_load_dwordx4 v172, s[20:23], s57 offen offset:0 lds
    v_mfma_f32_16x16x32_bf16 v[112:115], v[180:183], a[184:187], v[112:115]
    v_mfma_f32_16x16x32_bf16 v[120:123], v[176:179], a[180:183], v[120:123]
    buffer_load_dwordx4 v173, s[20:23], s57 offen offset:1024 lds
    v_mfma_f32_16x16x32_bf16 v[120:123], v[180:183], a[188:191], v[120:123]
    s_waitcnt lgkmcnt(8)
    v_mfma_f32_16x16x32_bf16 v[52:55], v[184:187], a[160:163], v[52:55]
    v_mfma_f32_16x16x32_bf16 v[52:55], v[188:191], a[168:171], v[52:55]
    v_mfma_f32_16x16x32_bf16 v[60:63], v[184:187], a[164:167], v[60:63]
    s_waitcnt vmcnt(44) lgkmcnt(0)
    s_barrier
    v_mfma_f32_16x16x32_bf16 v[60:63], v[188:191], a[172:175], v[60:63]
    ds_read_b64_tr_b16 v[176:177], v156 offset:0
    ds_read_b64_tr_b16 v[178:179], v156 offset:1024
    v_mfma_f32_16x16x32_bf16 v[116:119], v[184:187], a[176:179], v[116:119]
    ds_read_b64_tr_b16 v[180:181], v156 offset:8192
    ds_read_b64_tr_b16 v[182:183], v156 offset:9216
    v_mfma_f32_16x16x32_bf16 v[116:119], v[188:191], a[184:187], v[116:119]
    buffer_load_dwordx4 v174, s[20:23], s57 offen offset:2048 lds
    v_mfma_f32_16x16x32_bf16 v[124:127], v[184:187], a[180:183], v[124:127]
    v_mfma_f32_16x16x32_bf16 v[124:127], v[188:191], a[188:191], v[124:127]
    buffer_load_dwordx4 v175, s[20:23], s57 offen offset:3072 lds
    s_add_u32 s57, s57, 0x40000
    v_mfma_f32_16x16x32_bf16 v[64:67], v[192:195], a[160:163], v[64:67]
    ds_read_b64_tr_b16 v[184:185], v157 offset:0
    v_mfma_f32_16x16x32_bf16 v[64:67], v[196:199], a[168:171], v[64:67]
    ds_read_b64_tr_b16 v[186:187], v157 offset:1024
    v_mfma_f32_16x16x32_bf16 v[72:75], v[192:195], a[164:167], v[72:75]
    ds_read_b64_tr_b16 v[188:189], v157 offset:8192
    v_mfma_f32_16x16x32_bf16 v[72:75], v[196:199], a[172:175], v[72:75]
    ds_read_b64_tr_b16 v[190:191], v157 offset:9216
    v_mfma_f32_16x16x32_bf16 v[128:131], v[192:195], a[176:179], v[128:131]
    buffer_load_dwordx4 a[224:227], v7, s[32:35], s53 offen offset:0 sc1
    v_mfma_f32_16x16x32_bf16 v[128:131], v[196:199], a[184:187], v[128:131]
    v_mfma_f32_16x16x32_bf16 v[136:139], v[192:195], a[180:183], v[136:139]
    buffer_load_dwordx4 a[228:231], v7, s[32:35], s53 offen offset:1024 sc1
    v_mfma_f32_16x16x32_bf16 v[136:139], v[196:199], a[188:191], v[136:139]
    v_mfma_f32_16x16x32_bf16 v[68:71], v[200:203], a[160:163], v[68:71]
    ds_read_b64_tr_b16 v[192:193], v158 offset:0
    v_mfma_f32_16x16x32_bf16 v[68:71], v[204:207], a[168:171], v[68:71]
    ds_read_b64_tr_b16 v[194:195], v158 offset:1024
    v_mfma_f32_16x16x32_bf16 v[76:79], v[200:203], a[164:167], v[76:79]
    ds_read_b64_tr_b16 v[196:197], v158 offset:8192
    v_mfma_f32_16x16x32_bf16 v[76:79], v[204:207], a[172:175], v[76:79]
    ds_read_b64_tr_b16 v[198:199], v158 offset:9216
    v_mfma_f32_16x16x32_bf16 v[132:135], v[200:203], a[176:179], v[132:135]
    buffer_load_dwordx4 a[232:235], v7, s[32:35], s53 offen offset:2048 sc1
    v_mfma_f32_16x16x32_bf16 v[132:135], v[204:207], a[184:187], v[132:135]
    v_mfma_f32_16x16x32_bf16 v[140:143], v[200:203], a[180:183], v[140:143]
    buffer_load_dwordx4 a[236:239], v7, s[32:35], s53 offen offset:3072 sc1
    s_add_u32 s53, s53, 0x40000
    v_mfma_f32_16x16x32_bf16 v[140:143], v[204:207], a[188:191], v[140:143]
    s_waitcnt vmcnt(24) lgkmcnt(8)
    v_mfma_f32_16x16x32_bf16 v[48:51], v[176:179], a[96:99], v[48:51]
    ds_read_b64_tr_b16 v[200:201], v159 offset:0
    v_mfma_f32_16x16x32_bf16 v[48:51], v[180:183], a[104:107], v[48:51]
    ds_read_b64_tr_b16 v[202:203], v159 offset:1024
    v_mfma_f32_16x16x32_bf16 v[56:59], v[176:179], a[100:103], v[56:59]
    ds_read_b64_tr_b16 v[204:205], v159 offset:8192
    v_mfma_f32_16x16x32_bf16 v[56:59], v[180:183], a[108:111], v[56:59]
    ds_read_b64_tr_b16 v[206:207], v159 offset:9216
    v_mfma_f32_16x16x32_bf16 v[112:115], v[176:179], a[112:115], v[112:115]
    buffer_load_dwordx4 a[240:243], v7, s[32:35], s53 offen offset:0 sc1
    v_mfma_f32_16x16x32_bf16 v[112:115], v[180:183], a[120:123], v[112:115]
    v_mfma_f32_16x16x32_bf16 v[120:123], v[176:179], a[116:119], v[120:123]
    buffer_load_dwordx4 a[244:247], v7, s[32:35], s53 offen offset:1024 sc1
    v_mfma_f32_16x16x32_bf16 v[120:123], v[180:183], a[124:127], v[120:123]
    s_waitcnt lgkmcnt(8)
    v_mfma_f32_16x16x32_bf16 v[52:55], v[184:187], a[96:99], v[52:55]
    v_mfma_f32_16x16x32_bf16 v[52:55], v[188:191], a[104:107], v[52:55]
    v_mfma_f32_16x16x32_bf16 v[60:63], v[184:187], a[100:103], v[60:63]
    s_waitcnt vmcnt(36) lgkmcnt(0)
    s_barrier
    v_mfma_f32_16x16x32_bf16 v[60:63], v[188:191], a[108:111], v[60:63]
    ds_read_b64_tr_b16 v[176:177], v156 offset:16384
    ds_read_b64_tr_b16 v[178:179], v156 offset:17408
    v_mfma_f32_16x16x32_bf16 v[116:119], v[184:187], a[112:115], v[116:119]
    ds_read_b64_tr_b16 v[180:181], v156 offset:24576
    ds_read_b64_tr_b16 v[182:183], v156 offset:25600
    v_mfma_f32_16x16x32_bf16 v[116:119], v[188:191], a[120:123], v[116:119]
    buffer_load_dwordx4 a[248:251], v7, s[32:35], s53 offen offset:2048 sc1
    v_mfma_f32_16x16x32_bf16 v[124:127], v[184:187], a[116:119], v[124:127]
    v_mfma_f32_16x16x32_bf16 v[124:127], v[188:191], a[124:127], v[124:127]
    buffer_load_dwordx4 a[252:255], v7, s[32:35], s53 offen offset:3072 sc1
    s_add_u32 s53, s53, 0x40000
    v_mfma_f32_16x16x32_bf16 v[64:67], v[192:195], a[96:99], v[64:67]
    ds_read_b64_tr_b16 v[184:185], v157 offset:16384
    v_mfma_f32_16x16x32_bf16 v[64:67], v[196:199], a[104:107], v[64:67]
    ds_read_b64_tr_b16 v[186:187], v157 offset:17408
    v_mfma_f32_16x16x32_bf16 v[72:75], v[192:195], a[100:103], v[72:75]
    ds_read_b64_tr_b16 v[188:189], v157 offset:24576
    v_mfma_f32_16x16x32_bf16 v[72:75], v[196:199], a[108:111], v[72:75]
    ds_read_b64_tr_b16 v[190:191], v157 offset:25600
    v_mfma_f32_16x16x32_bf16 v[128:131], v[192:195], a[112:115], v[128:131]
    s_add_u32 m0, s30, 49152
    s_nop 0
    buffer_load_dwordx4 v172, s[20:23], s57 offen offset:0 lds
    v_mfma_f32_16x16x32_bf16 v[128:131], v[196:199], a[120:123], v[128:131]
    v_mfma_f32_16x16x32_bf16 v[136:139], v[192:195], a[116:119], v[136:139]
    buffer_load_dwordx4 v173, s[20:23], s57 offen offset:1024 lds
    v_mfma_f32_16x16x32_bf16 v[136:139], v[196:199], a[124:127], v[136:139]
    v_mfma_f32_16x16x32_bf16 v[68:71], v[200:203], a[96:99], v[68:71]
    ds_read_b64_tr_b16 v[192:193], v158 offset:16384
    v_mfma_f32_16x16x32_bf16 v[68:71], v[204:207], a[104:107], v[68:71]
    ds_read_b64_tr_b16 v[194:195], v158 offset:17408
    v_mfma_f32_16x16x32_bf16 v[76:79], v[200:203], a[100:103], v[76:79]
    ds_read_b64_tr_b16 v[196:197], v158 offset:24576
    v_mfma_f32_16x16x32_bf16 v[76:79], v[204:207], a[108:111], v[76:79]
    ds_read_b64_tr_b16 v[198:199], v158 offset:25600
    v_mfma_f32_16x16x32_bf16 v[132:135], v[200:203], a[112:115], v[132:135]
    buffer_load_dwordx4 v174, s[20:23], s57 offen offset:2048 lds
    v_mfma_f32_16x16x32_bf16 v[132:135], v[204:207], a[120:123], v[132:135]
    v_mfma_f32_16x16x32_bf16 v[140:143], v[200:203], a[116:119], v[140:143]
    buffer_load_dwordx4 v175, s[20:23], s57 offen offset:3072 lds
    s_add_u32 s57, s57, 0x40000
    v_mfma_f32_16x16x32_bf16 v[140:143], v[204:207], a[124:127], v[140:143]
    s_waitcnt vmcnt(16) lgkmcnt(8)
    v_mfma_f32_16x16x32_bf16 v[48:51], v[176:179], a[128:131], v[48:51]
    ds_read_b64_tr_b16 v[200:201], v159 offset:16384
    v_mfma_f32_16x16x32_bf16 v[48:51], v[180:183], a[136:139], v[48:51]
    ds_read_b64_tr_b16 v[202:203], v159 offset:17408
    v_mfma_f32_16x16x32_bf16 v[56:59], v[176:179], a[132:135], v[56:59]
    ds_read_b64_tr_b16 v[204:205], v159 offset:24576
    v_mfma_f32_16x16x32_bf16 v[56:59], v[180:183], a[140:143], v[56:59]
    ds_read_b64_tr_b16 v[206:207], v159 offset:25600
    v_mfma_f32_16x16x32_bf16 v[112:115], v[176:179], a[144:147], v[112:115]
    buffer_load_dwordx4 a[160:163], v7, s[32:35], s53 offen offset:0 sc1
    v_mfma_f32_16x16x32_bf16 v[112:115], v[180:183], a[152:155], v[112:115]
    v_mfma_f32_16x16x32_bf16 v[120:123], v[176:179], a[148:151], v[120:123]
    buffer_load_dwordx4 a[164:167], v7, s[32:35], s53 offen offset:1024 sc1
    v_mfma_f32_16x16x32_bf16 v[120:123], v[180:183], a[156:159], v[120:123]
    s_waitcnt lgkmcnt(8)
    v_mfma_f32_16x16x32_bf16 v[52:55], v[184:187], a[128:131], v[52:55]
    ds_read_b64_tr_b16 v[176:177], v152 offset:0
    v_mfma_f32_16x16x32_bf16 v[52:55], v[188:191], a[136:139], v[52:55]
    ds_read_b64_tr_b16 v[178:179], v152 offset:1024
    v_mfma_f32_16x16x32_bf16 v[60:63], v[184:187], a[132:135], v[60:63]
    ds_read_b64_tr_b16 v[180:181], v152 offset:8192
    v_mfma_f32_16x16x32_bf16 v[60:63], v[188:191], a[140:143], v[60:63]
    ds_read_b64_tr_b16 v[182:183], v152 offset:9216
    v_mfma_f32_16x16x32_bf16 v[116:119], v[184:187], a[144:147], v[116:119]
    buffer_load_dwordx4 a[168:171], v7, s[32:35], s53 offen offset:2048 sc1
    v_mfma_f32_16x16x32_bf16 v[116:119], v[188:191], a[152:155], v[116:119]
    v_mfma_f32_16x16x32_bf16 v[124:127], v[184:187], a[148:151], v[124:127]
    buffer_load_dwordx4 a[172:175], v7, s[32:35], s53 offen offset:3072 sc1
    s_add_u32 s53, s53, 0x40000
    v_mfma_f32_16x16x32_bf16 v[124:127], v[188:191], a[156:159], v[124:127]
    s_waitcnt lgkmcnt(8)
    v_mfma_f32_16x16x32_bf16 v[64:67], v[192:195], a[128:131], v[64:67]
    ds_read_b64_tr_b16 v[184:185], v153 offset:0
    v_mfma_f32_16x16x32_bf16 v[64:67], v[196:199], a[136:139], v[64:67]
    ds_read_b64_tr_b16 v[186:187], v153 offset:1024
    v_mfma_f32_16x16x32_bf16 v[72:75], v[192:195], a[132:135], v[72:75]
    ds_read_b64_tr_b16 v[188:189], v153 offset:8192
    v_mfma_f32_16x16x32_bf16 v[72:75], v[196:199], a[140:143], v[72:75]
    ds_read_b64_tr_b16 v[190:191], v153 offset:9216
    v_mfma_f32_16x16x32_bf16 v[128:131], v[192:195], a[144:147], v[128:131]
    buffer_load_dwordx4 a[176:179], v7, s[32:35], s53 offen offset:0 sc1
    v_mfma_f32_16x16x32_bf16 v[128:131], v[196:199], a[152:155], v[128:131]
    v_mfma_f32_16x16x32_bf16 v[136:139], v[192:195], a[148:151], v[136:139]
    buffer_load_dwordx4 a[180:183], v7, s[32:35], s53 offen offset:1024 sc1
    v_mfma_f32_16x16x32_bf16 v[136:139], v[196:199], a[156:159], v[136:139]
    s_waitcnt lgkmcnt(8)
    v_mfma_f32_16x16x32_bf16 v[68:71], v[200:203], a[128:131], v[68:71]
    ds_read_b64_tr_b16 v[192:193], v154 offset:0
    v_mfma_f32_16x16x32_bf16 v[68:71], v[204:207], a[136:139], v[68:71]
    ds_read_b64_tr_b16 v[194:195], v154 offset:1024
    v_mfma_f32_16x16x32_bf16 v[76:79], v[200:203], a[132:135], v[76:79]
    ds_read_b64_tr_b16 v[196:197], v154 offset:8192
    v_mfma_f32_16x16x32_bf16 v[76:79], v[204:207], a[140:143], v[76:79]
    ds_read_b64_tr_b16 v[198:199], v154 offset:9216
    v_mfma_f32_16x16x32_bf16 v[132:135], v[200:203], a[144:147], v[132:135]
    buffer_load_dwordx4 a[184:187], v7, s[32:35], s53 offen offset:2048 sc1
    v_mfma_f32_16x16x32_bf16 v[132:135], v[204:207], a[152:155], v[132:135]
    v_mfma_f32_16x16x32_bf16 v[140:143], v[200:203], a[148:151], v[140:143]
    buffer_load_dwordx4 a[188:191], v7, s[32:35], s53 offen offset:3072 sc1
    s_add_u32 s53, s53, 0x40000
    v_mfma_f32_16x16x32_bf16 v[140:143], v[204:207], a[156:159], v[140:143]
    s_waitcnt lgkmcnt(8)
    v_mfma_f32_16x16x32_bf16 v[16:19], v[176:179], a[96:99], v[16:19]
    ds_read_b64_tr_b16 v[200:201], v155 offset:0
    v_mfma_f32_16x16x32_bf16 v[16:19], v[180:183], a[104:107], v[16:19]
    ds_read_b64_tr_b16 v[202:203], v155 offset:1024
    v_mfma_f32_16x16x32_bf16 v[24:27], v[176:179], a[100:103], v[24:27]
    ds_read_b64_tr_b16 v[204:205], v155 offset:8192
    v_mfma_f32_16x16x32_bf16 v[24:27], v[180:183], a[108:111], v[24:27]
    ds_read_b64_tr_b16 v[206:207], v155 offset:9216
    v_mfma_f32_16x16x32_bf16 v[80:83], v[176:179], a[112:115], v[80:83]
    v_mfma_f32_16x16x32_bf16 v[80:83], v[180:183], a[120:123], v[80:83]
    v_mfma_f32_16x16x32_bf16 v[88:91], v[176:179], a[116:119], v[88:91]
    v_mfma_f32_16x16x32_bf16 v[88:91], v[180:183], a[124:127], v[88:91]
    s_waitcnt lgkmcnt(8)
    v_mfma_f32_16x16x32_bf16 v[20:23], v[184:187], a[96:99], v[20:23]
    v_cvt_pk_bf16_f32 v48, v48, v49
    v_min_u32 v48, s46, v48
    ds_read_b64_tr_b16 v[176:177], v152 offset:16384
    v_mfma_f32_16x16x32_bf16 v[20:23], v[188:191], a[104:107], v[20:23]
    v_cvt_pk_bf16_f32 v49, v50, v51
    v_min_u32 v49, s46, v49
    ds_read_b64_tr_b16 v[178:179], v152 offset:17408
    v_mfma_f32_16x16x32_bf16 v[28:31], v[184:187], a[100:103], v[28:31]
    v_cvt_pk_bf16_f32 v50, v52, v53
    v_min_u32 v50, s46, v50
    ds_read_b64_tr_b16 v[180:181], v152 offset:24576
    v_mfma_f32_16x16x32_bf16 v[28:31], v[188:191], a[108:111], v[28:31]
    v_cvt_pk_bf16_f32 v51, v54, v55
    v_min_u32 v51, s46, v51
    ds_read_b64_tr_b16 v[182:183], v152 offset:25600
    v_mfma_f32_16x16x32_bf16 v[84:87], v[184:187], a[112:115], v[84:87]
    v_cvt_pk_bf16_f32 v52, v56, v57
    v_min_u32 v52, s46, v52
    s_xor_b32 s5, s52, 8192
    s_add_u32 s5, s5, 0
    buffer_store_dwordx4 v[48:51], v7, s[32:35], s5 offen sc1
    v_mfma_f32_16x16x32_bf16 v[84:87], v[188:191], a[120:123], v[84:87]
    v_cvt_pk_bf16_f32 v53, v58, v59
    v_min_u32 v53, s46, v53
    v_mfma_f32_16x16x32_bf16 v[92:95], v[184:187], a[116:119], v[92:95]
    v_cvt_pk_bf16_f32 v54, v60, v61
    v_min_u32 v54, s46, v54
    v_mfma_f32_16x16x32_bf16 v[92:95], v[188:191], a[124:127], v[92:95]
    v_cvt_pk_bf16_f32 v55, v62, v63
    v_min_u32 v55, s46, v55
    s_waitcnt lgkmcnt(8)
    v_mfma_f32_16x16x32_bf16 v[32:35], v[192:195], a[96:99], v[32:35]
    v_cvt_pk_bf16_f32 v56, v64, v65
    v_min_u32 v56, s46, v56
    ds_read_b64_tr_b16 v[184:185], v153 offset:16384
    v_mfma_f32_16x16x32_bf16 v[32:35], v[196:199], a[104:107], v[32:35]
    v_cvt_pk_bf16_f32 v57, v66, v67
    v_min_u32 v57, s46, v57
    ds_read_b64_tr_b16 v[186:187], v153 offset:17408
    v_mfma_f32_16x16x32_bf16 v[40:43], v[192:195], a[100:103], v[40:43]
    v_cvt_pk_bf16_f32 v58, v68, v69
    v_min_u32 v58, s46, v58
    ds_read_b64_tr_b16 v[188:189], v153 offset:24576
    v_mfma_f32_16x16x32_bf16 v[40:43], v[196:199], a[108:111], v[40:43]
    v_cvt_pk_bf16_f32 v59, v70, v71
    v_min_u32 v59, s46, v59
    ds_read_b64_tr_b16 v[190:191], v153 offset:25600
    v_mfma_f32_16x16x32_bf16 v[96:99], v[192:195], a[112:115], v[96:99]
    v_cvt_pk_bf16_f32 v60, v72, v73
    v_min_u32 v60, s46, v60
    s_xor_b32 s5, s52, 8192
    s_add_u32 s5, s5, 1048576
    buffer_store_dwordx4 v[52:55], v7, s[32:35], s5 offen sc1
    v_mfma_f32_16x16x32_bf16 v[96:99], v[196:199], a[120:123], v[96:99]
    v_cvt_pk_bf16_f32 v61, v74, v75
    v_min_u32 v61, s46, v61
    v_mfma_f32_16x16x32_bf16 v[104:107], v[192:195], a[116:119], v[104:107]
    v_cvt_pk_bf16_f32 v62, v76, v77
    v_min_u32 v62, s46, v62
    s_xor_b32 s5, s52, 8192
    s_add_u32 s5, s5, 2097152
    buffer_store_dwordx4 v[56:59], v7, s[32:35], s5 offen sc1
    v_mfma_f32_16x16x32_bf16 v[104:107], v[196:199], a[124:127], v[104:107]
    v_cvt_pk_bf16_f32 v63, v78, v79
    v_min_u32 v63, s46, v63
    s_waitcnt lgkmcnt(8)
    v_mfma_f32_16x16x32_bf16 v[36:39], v[200:203], a[96:99], v[36:39]
    v_cvt_pk_bf16_f32 v112, v112, v113
    v_min_u32 v112, s46, v112
    ds_read_b64_tr_b16 v[192:193], v154 offset:16384
    v_mfma_f32_16x16x32_bf16 v[36:39], v[204:207], a[104:107], v[36:39]
    v_cvt_pk_bf16_f32 v113, v114, v115
    v_min_u32 v113, s46, v113
    ds_read_b64_tr_b16 v[194:195], v154 offset:17408
    v_mfma_f32_16x16x32_bf16 v[44:47], v[200:203], a[100:103], v[44:47]
    v_cvt_pk_bf16_f32 v114, v116, v117
    v_min_u32 v114, s46, v114
    ds_read_b64_tr_b16 v[196:197], v154 offset:24576
    v_mfma_f32_16x16x32_bf16 v[44:47], v[204:207], a[108:111], v[44:47]
    v_cvt_pk_bf16_f32 v115, v118, v119
    v_min_u32 v115, s46, v115
    ds_read_b64_tr_b16 v[198:199], v154 offset:25600
    v_mfma_f32_16x16x32_bf16 v[100:103], v[200:203], a[112:115], v[100:103]
    v_cvt_pk_bf16_f32 v116, v120, v121
    v_min_u32 v116, s46, v116
    s_xor_b32 s5, s52, 8192
    s_add_u32 s5, s5, 3145728
    buffer_store_dwordx4 v[60:63], v7, s[32:35], s5 offen sc1
    v_mfma_f32_16x16x32_bf16 v[100:103], v[204:207], a[120:123], v[100:103]
    v_cvt_pk_bf16_f32 v117, v122, v123
    v_min_u32 v117, s46, v117
    v_mfma_f32_16x16x32_bf16 v[108:111], v[200:203], a[116:119], v[108:111]
    v_cvt_pk_bf16_f32 v118, v124, v125
    v_min_u32 v118, s46, v118
    s_xor_b32 s5, s52, 24576
    s_add_u32 s5, s5, 8388608
    buffer_store_dwordx4 v[112:115], v7, s[32:35], s5 offen sc1
    v_mfma_f32_16x16x32_bf16 v[108:111], v[204:207], a[124:127], v[108:111]
    v_cvt_pk_bf16_f32 v119, v126, v127
    v_min_u32 v119, s46, v119
    s_waitcnt lgkmcnt(8)
    v_mfma_f32_16x16x32_bf16 v[16:19], v[176:179], a[128:131], v[16:19]
    v_cvt_pk_bf16_f32 v120, v128, v129
    v_min_u32 v120, s46, v120
    ds_read_b64_tr_b16 v[200:201], v155 offset:16384
    v_mfma_f32_16x16x32_bf16 v[16:19], v[180:183], a[136:139], v[16:19]
    v_cvt_pk_bf16_f32 v121, v130, v131
    v_min_u32 v121, s46, v121
    ds_read_b64_tr_b16 v[202:203], v155 offset:17408
    v_mfma_f32_16x16x32_bf16 v[24:27], v[176:179], a[132:135], v[24:27]
    v_cvt_pk_bf16_f32 v122, v132, v133
    v_min_u32 v122, s46, v122
    ds_read_b64_tr_b16 v[204:205], v155 offset:24576
    v_mfma_f32_16x16x32_bf16 v[24:27], v[180:183], a[140:143], v[24:27]
    v_cvt_pk_bf16_f32 v123, v134, v135
    v_min_u32 v123, s46, v123
    ds_read_b64_tr_b16 v[206:207], v155 offset:25600
    v_mfma_f32_16x16x32_bf16 v[80:83], v[176:179], a[144:147], v[80:83]
    v_cvt_pk_bf16_f32 v124, v136, v137
    v_min_u32 v124, s46, v124
    s_xor_b32 s5, s52, 24576
    s_add_u32 s5, s5, 9437184
    buffer_store_dwordx4 v[116:119], v7, s[32:35], s5 offen sc1
    v_mfma_f32_16x16x32_bf16 v[80:83], v[180:183], a[152:155], v[80:83]
    v_cvt_pk_bf16_f32 v125, v138, v139
    v_min_u32 v125, s46, v125
    v_mfma_f32_16x16x32_bf16 v[88:91], v[176:179], a[148:151], v[88:91]
    v_cvt_pk_bf16_f32 v126, v140, v141
    v_min_u32 v126, s46, v126
    s_xor_b32 s5, s52, 24576
    s_add_u32 s5, s5, 10485760
    buffer_store_dwordx4 v[120:123], v7, s[32:35], s5 offen sc1
    v_mfma_f32_16x16x32_bf16 v[88:91], v[180:183], a[156:159], v[88:91]
    v_cvt_pk_bf16_f32 v127, v142, v143
    v_min_u32 v127, s46, v127
    s_waitcnt lgkmcnt(8)
    v_mfma_f32_16x16x32_bf16 v[20:23], v[184:187], a[128:131], v[20:23]
    v_mfma_f32_16x16x32_bf16 v[20:23], v[188:191], a[136:139], v[20:23]
    v_mfma_f32_16x16x32_bf16 v[28:31], v[184:187], a[132:135], v[28:31]
    s_waitcnt vmcnt(63) lgkmcnt(0)
    s_barrier
    v_mfma_f32_16x16x32_bf16 v[28:31], v[188:191], a[140:143], v[28:31]
    v_mfma_f32_16x16x32_bf16 v[84:87], v[184:187], a[144:147], v[84:87]
    v_mfma_f32_16x16x32_bf16 v[84:87], v[188:191], a[152:155], v[84:87]
    s_xor_b32 s5, s52, 24576
    s_add_u32 s5, s5, 11534336
    buffer_store_dwordx4 v[124:127], v7, s[32:35], s5 offen sc1
    v_mfma_f32_16x16x32_bf16 v[92:95], v[184:187], a[148:151], v[92:95]
    v_mfma_f32_16x16x32_bf16 v[92:95], v[188:191], a[156:159], v[92:95]
    s_add_u32 m0, s30, 0
    s_nop 0
    buffer_load_dwordx4 v172, s[20:23], s57 offen offset:0 lds
    v_mfma_f32_16x16x32_bf16 v[32:35], v[192:195], a[128:131], v[32:35]
    v_mfma_f32_16x16x32_bf16 v[32:35], v[196:199], a[136:139], v[32:35]
    v_mfma_f32_16x16x32_bf16 v[40:43], v[192:195], a[132:135], v[40:43]
    v_mfma_f32_16x16x32_bf16 v[40:43], v[196:199], a[140:143], v[40:43]
    v_mfma_f32_16x16x32_bf16 v[96:99], v[192:195], a[144:147], v[96:99]
    buffer_load_dwordx4 v173, s[20:23], s57 offen offset:1024 lds
    v_mfma_f32_16x16x32_bf16 v[96:99], v[196:199], a[152:155], v[96:99]
    v_mfma_f32_16x16x32_bf16 v[104:107], v[192:195], a[148:151], v[104:107]
    buffer_load_dwordx4 v174, s[20:23], s57 offen offset:2048 lds
    v_mfma_f32_16x16x32_bf16 v[104:107], v[196:199], a[156:159], v[104:107]
    v_mfma_f32_16x16x32_bf16 v[36:39], v[200:203], a[128:131], v[36:39]
    v_mfma_f32_16x16x32_bf16 v[36:39], v[204:207], a[136:139], v[36:39]
    v_mfma_f32_16x16x32_bf16 v[44:47], v[200:203], a[132:135], v[44:47]
    v_mfma_f32_16x16x32_bf16 v[44:47], v[204:207], a[140:143], v[44:47]
    v_mfma_f32_16x16x32_bf16 v[100:103], v[200:203], a[144:147], v[100:103]
    buffer_load_dwordx4 v175, s[20:23], s57 offen offset:3072 lds
    s_add_u32 s57, s57, 0x40000
    v_mfma_f32_16x16x32_bf16 v[100:103], v[204:207], a[152:155], v[100:103]
    v_mfma_f32_16x16x32_bf16 v[108:111], v[200:203], a[148:151], v[108:111]
    buffer_load_dwordx4 a[96:99], v7, s[32:35], s53 offen offset:0 sc1
    v_mfma_f32_16x16x32_bf16 v[108:111], v[204:207], a[156:159], v[108:111]
    ds_read_b64_tr_b16 v[176:177], v164 offset:0
    ds_read_b64_tr_b16 v[178:179], v164 offset:1024
    ds_read_b64_tr_b16 v[180:181], v164 offset:4096
    ds_read_b64_tr_b16 v[182:183], v164 offset:5120
    ds_read_b64_tr_b16 v[184:185], v165 offset:0
    ds_read_b64_tr_b16 v[186:187], v165 offset:1024
    ds_read_b64_tr_b16 v[188:189], v165 offset:4096
    ds_read_b64_tr_b16 v[190:191], v165 offset:5120
    ds_read_b64_tr_b16 v[192:193], v166 offset:0
    ds_read_b64_tr_b16 v[194:195], v166 offset:1024
    ds_read_b64_tr_b16 v[196:197], v166 offset:4096
    ds_read_b64_tr_b16 v[198:199], v166 offset:5120
    ds_read_b64_tr_b16 v[200:201], v167 offset:0
    ds_read_b64_tr_b16 v[202:203], v167 offset:1024
    ds_read_b64_tr_b16 v[204:205], v167 offset:4096
    ds_read_b64_tr_b16 v[206:207], v167 offset:5120
    v_cvt_pk_bf16_f32 v80, v80, v81
    v_min_u32 v80, s46, v80
    v_cvt_pk_bf16_f32 v81, v82, v83
    v_min_u32 v81, s46, v81
    v_cvt_pk_bf16_f32 v82, v84, v85
    v_min_u32 v82, s46, v82
    v_cvt_pk_bf16_f32 v83, v86, v87
    v_min_u32 v83, s46, v83
    v_cvt_pk_bf16_f32 v84, v88, v89
    v_min_u32 v84, s46, v84
    v_cvt_pk_bf16_f32 v85, v90, v91
    v_min_u32 v85, s46, v85
    v_cvt_pk_bf16_f32 v86, v92, v93
    v_min_u32 v86, s46, v86
    v_cvt_pk_bf16_f32 v87, v94, v95
    v_min_u32 v87, s46, v87
    s_xor_b32 s5, s52, 16384
    s_add_u32 s5, s5, 4194304
    buffer_store_dwordx4 v[80:83], v7, s[32:35], s5 offen sc1
    v_cvt_pk_bf16_f32 v88, v96, v97
    v_min_u32 v88, s46, v88
    v_cvt_pk_bf16_f32 v89, v98, v99
    v_min_u32 v89, s46, v89
    v_cvt_pk_bf16_f32 v90, v100, v101
    v_min_u32 v90, s46, v90
    v_cvt_pk_bf16_f32 v91, v102, v103
    v_min_u32 v91, s46, v91
    v_cvt_pk_bf16_f32 v92, v104, v105
    v_min_u32 v92, s46, v92
    v_cvt_pk_bf16_f32 v93, v106, v107
    v_min_u32 v93, s46, v93
    v_cvt_pk_bf16_f32 v94, v108, v109
    v_min_u32 v94, s46, v94
    v_cvt_pk_bf16_f32 v95, v110, v111
    v_min_u32 v95, s46, v95
    s_xor_b32 s5, s52, 16384
    s_add_u32 s5, s5, 5242880
    buffer_store_dwordx4 v[84:87], v7, s[32:35], s5 offen sc1
    s_waitcnt vmcnt(63) lgkmcnt(8)
    v_mfma_f32_16x16x32_bf16 v[64:67], v[176:179], a[0:3], 0
    ds_read_b64_tr_b16 v[208:209], v164 offset:8192
    ds_read_b64_tr_b16 v[210:211], v164 offset:9216
    v_mfma_f32_16x16x32_bf16 v[64:67], v[180:183], a[8:11], v[64:67]
    s_xor_b32 s5, s52, 16384
    s_add_u32 s5, s5, 6291456
    buffer_store_dwordx4 v[88:91], v7, s[32:35], s5 offen sc1
    v_mfma_f32_16x16x32_bf16 v[72:75], v[176:179], a[4:7], 0
    ds_read_b64_tr_b16 v[212:213], v164 offset:12288
    ds_read_b64_tr_b16 v[214:215], v164 offset:13312
    v_mfma_f32_16x16x32_bf16 v[72:75], v[180:183], a[12:15], v[72:75]
    s_xor_b32 s5, s52, 16384
    s_add_u32 s5, s5, 7340032
    buffer_store_dwordx4 v[92:95], v7, s[32:35], s5 offen sc1
    v_mfma_f32_16x16x32_bf16 v[68:71], v[184:187], a[0:3], 0
    ds_read_b64_tr_b16 v[216:217], v165 offset:8192
    ds_read_b64_tr_b16 v[218:219], v165 offset:9216
    v_mfma_f32_16x16x32_bf16 v[68:71], v[188:191], a[8:11], v[68:71]
    v_mfma_f32_16x16x32_bf16 v[76:79], v[184:187], a[4:7], 0
    ds_read_b64_tr_b16 v[220:221], v165 offset:12288
    ds_read_b64_tr_b16 v[222:223], v165 offset:13312
    v_mfma_f32_16x16x32_bf16 v[76:79], v[188:191], a[12:15], v[76:79]
    s_waitcnt lgkmcnt(8)
    v_mfma_f32_16x16x32_bf16 v[96:99], v[192:195], a[0:3], 0
    ds_read_b64_tr_b16 v[224:225], v166 offset:8192
    ds_read_b64_tr_b16 v[226:227], v166 offset:9216
    v_mfma_f32_16x16x32_bf16 v[96:99], v[196:199], a[8:11], v[96:99]
    v_mfma_f32_16x16x32_bf16 v[104:107], v[192:195], a[4:7], 0
    ds_read_b64_tr_b16 v[228:229], v166 offset:12288
    ds_read_b64_tr_b16 v[230:231], v166 offset:13312
    v_mfma_f32_16x16x32_bf16 v[104:107], v[196:199], a[12:15], v[104:107]
    v_mfma_f32_16x16x32_bf16 v[100:103], v[200:203], a[0:3], 0
    ds_read_b64_tr_b16 v[232:233], v167 offset:8192
    ds_read_b64_tr_b16 v[234:235], v167 offset:9216
    v_mfma_f32_16x16x32_bf16 v[100:103], v[204:207], a[8:11], v[100:103]
    v_mfma_f32_16x16x32_bf16 v[108:111], v[200:203], a[4:7], 0
    ds_read_b64_tr_b16 v[236:237], v167 offset:12288
    ds_read_b64_tr_b16 v[238:239], v167 offset:13312
    v_mfma_f32_16x16x32_bf16 v[108:111], v[204:207], a[12:15], v[108:111]
    s_waitcnt vmcnt(63) lgkmcnt(8)
    s_barrier
    v_mfma_f32_16x16x32_bf16 v[64:67], v[208:211], a[16:19], v[64:67]
    ds_read_b64_tr_b16 v[176:177], v164 offset:16384
    ds_read_b64_tr_b16 v[178:179], v164 offset:17408
    v_mfma_f32_16x16x32_bf16 v[64:67], v[212:215], a[24:27], v[64:67]
    v_mfma_f32_16x16x32_bf16 v[72:75], v[208:211], a[20:23], v[72:75]
    ds_read_b64_tr_b16 v[180:181], v164 offset:20480
    ds_read_b64_tr_b16 v[182:183], v164 offset:21504
    v_mfma_f32_16x16x32_bf16 v[72:75], v[212:215], a[28:31], v[72:75]
    v_mfma_f32_16x16x32_bf16 v[68:71], v[216:219], a[16:19], v[68:71]
    ds_read_b64_tr_b16 v[184:185], v165 offset:16384
    ds_read_b64_tr_b16 v[186:187], v165 offset:17408
    v_mfma_f32_16x16x32_bf16 v[68:71], v[220:223], a[24:27], v[68:71]
    v_mfma_f32_16x16x32_bf16 v[76:79], v[216:219], a[20:23], v[76:79]
    ds_read_b64_tr_b16 v[188:189], v165 offset:20480
    ds_read_b64_tr_b16 v[190:191], v165 offset:21504
    v_mfma_f32_16x16x32_bf16 v[76:79], v[220:223], a[28:31], v[76:79]
    s_waitcnt lgkmcnt(8)
    v_mfma_f32_16x16x32_bf16 v[96:99], v[224:227], a[16:19], v[96:99]
    ds_read_b64_tr_b16 v[192:193], v166 offset:16384
    ds_read_b64_tr_b16 v[194:195], v166 offset:17408
    v_mfma_f32_16x16x32_bf16 v[96:99], v[228:231], a[24:27], v[96:99]
    v_mfma_f32_16x16x32_bf16 v[104:107], v[224:227], a[20:23], v[104:107]
    ds_read_b64_tr_b16 v[196:197], v166 offset:20480
    ds_read_b64_tr_b16 v[198:199], v166 offset:21504
    v_mfma_f32_16x16x32_bf16 v[104:107], v[228:231], a[28:31], v[104:107]
    v_mfma_f32_16x16x32_bf16 v[100:103], v[232:235], a[16:19], v[100:103]
    ds_read_b64_tr_b16 v[200:201], v167 offset:16384
    ds_read_b64_tr_b16 v[202:203], v167 offset:17408
    v_mfma_f32_16x16x32_bf16 v[100:103], v[236:239], a[24:27], v[100:103]
    v_mfma_f32_16x16x32_bf16 v[108:111], v[232:235], a[20:23], v[108:111]
    ds_read_b64_tr_b16 v[204:205], v167 offset:20480
    ds_read_b64_tr_b16 v[206:207], v167 offset:21504
    v_mfma_f32_16x16x32_bf16 v[108:111], v[236:239], a[28:31], v[108:111]
    s_waitcnt vmcnt(63) lgkmcnt(8)
    v_mfma_f32_16x16x32_bf16 v[64:67], v[176:179], a[32:35], v[64:67]
    ds_read_b64_tr_b16 v[208:209], v164 offset:24576
    ds_read_b64_tr_b16 v[210:211], v164 offset:25600
    v_mfma_f32_16x16x32_bf16 v[64:67], v[180:183], a[40:43], v[64:67]
    v_mfma_f32_16x16x32_bf16 v[72:75], v[176:179], a[36:39], v[72:75]
    ds_read_b64_tr_b16 v[212:213], v164 offset:28672
    ds_read_b64_tr_b16 v[214:215], v164 offset:29696
    v_mfma_f32_16x16x32_bf16 v[72:75], v[180:183], a[44:47], v[72:75]
    v_mfma_f32_16x16x32_bf16 v[68:71], v[184:187], a[32:35], v[68:71]
    ds_read_b64_tr_b16 v[216:217], v165 offset:24576
    ds_read_b64_tr_b16 v[218:219], v165 offset:25600
    v_mfma_f32_16x16x32_bf16 v[68:71], v[188:191], a[40:43], v[68:71]
    v_mfma_f32_16x16x32_bf16 v[76:79], v[184:187], a[36:39], v[76:79]
    ds_read_b64_tr_b16 v[220:221], v165 offset:28672
    ds_read_b64_tr_b16 v[222:223], v165 offset:29696
    v_mfma_f32_16x16x32_bf16 v[76:79], v[188:191], a[44:47], v[76:79]
    s_waitcnt lgkmcnt(8)
    v_mfma_f32_16x16x32_bf16 v[96:99], v[192:195], a[32:35], v[96:99]
    ds_read_b64_tr_b16 v[224:225], v166 offset:24576
    ds_read_b64_tr_b16 v[226:227], v166 offset:25600
    v_mfma_f32_16x16x32_bf16 v[96:99], v[196:199], a[40:43], v[96:99]
    v_mfma_f32_16x16x32_bf16 v[104:107], v[192:195], a[36:39], v[104:107]
    ds_read_b64_tr_b16 v[228:229], v166 offset:28672
    ds_read_b64_tr_b16 v[230:231], v166 offset:29696
    v_mfma_f32_16x16x32_bf16 v[104:107], v[196:199], a[44:47], v[104:107]
    v_mfma_f32_16x16x32_bf16 v[100:103], v[200:203], a[32:35], v[100:103]
    ds_read_b64_tr_b16 v[232:233], v167 offset:24576
    ds_read_b64_tr_b16 v[234:235], v167 offset:25600
    v_mfma_f32_16x16x32_bf16 v[100:103], v[204:207], a[40:43], v[100:103]
    v_mfma_f32_16x16x32_bf16 v[108:111], v[200:203], a[36:39], v[108:111]
    ds_read_b64_tr_b16 v[236:237], v167 offset:28672
    ds_read_b64_tr_b16 v[238:239], v167 offset:29696
    v_mfma_f32_16x16x32_bf16 v[108:111], v[204:207], a[44:47], v[108:111]
    s_waitcnt vmcnt(63) lgkmcnt(8)
    s_barrier
    v_mfma_f32_16x16x32_bf16 v[64:67], v[208:211], a[48:51], v[64:67]
    ds_read_b64_tr_b16 v[176:177], v164 offset:32768
    ds_read_b64_tr_b16 v[178:179], v164 offset:33792
    v_mfma_f32_16x16x32_bf16 v[64:67], v[212:215], a[56:59], v[64:67]
    v_mfma_f32_16x16x32_bf16 v[72:75], v[208:211], a[52:55], v[72:75]
    ds_read_b64_tr_b16 v[180:181], v164 offset:36864
    ds_read_b64_tr_b16 v[182:183], v164 offset:37888
    v_mfma_f32_16x16x32_bf16 v[72:75], v[212:215], a[60:63], v[72:75]
    v_mfma_f32_16x16x32_bf16 v[68:71], v[216:219], a[48:51], v[68:71]
    ds_read_b64_tr_b16 v[184:185], v165 offset:32768
    ds_read_b64_tr_b16 v[186:187], v165 offset:33792
    v_mfma_f32_16x16x32_bf16 v[68:71], v[220:223], a[56:59], v[68:71]
    v_mfma_f32_16x16x32_bf16 v[76:79], v[216:219], a[52:55], v[76:79]
    ds_read_b64_tr_b16 v[188:189], v165 offset:36864
    ds_read_b64_tr_b16 v[190:191], v165 offset:37888
    v_mfma_f32_16x16x32_bf16 v[76:79], v[220:223], a[60:63], v[76:79]
    s_waitcnt lgkmcnt(8)
    v_mfma_f32_16x16x32_bf16 v[96:99], v[224:227], a[48:51], v[96:99]
    ds_read_b64_tr_b16 v[192:193], v166 offset:32768
    ds_read_b64_tr_b16 v[194:195], v166 offset:33792
    v_mfma_f32_16x16x32_bf16 v[96:99], v[228:231], a[56:59], v[96:99]
    v_mfma_f32_16x16x32_bf16 v[104:107], v[224:227], a[52:55], v[104:107]
    ds_read_b64_tr_b16 v[196:197], v166 offset:36864
    ds_read_b64_tr_b16 v[198:199], v166 offset:37888
    v_mfma_f32_16x16x32_bf16 v[104:107], v[228:231], a[60:63], v[104:107]
    v_mfma_f32_16x16x32_bf16 v[100:103], v[232:235], a[48:51], v[100:103]
    ds_read_b64_tr_b16 v[200:201], v167 offset:32768
    ds_read_b64_tr_b16 v[202:203], v167 offset:33792
    v_mfma_f32_16x16x32_bf16 v[100:103], v[236:239], a[56:59], v[100:103]
    v_mfma_f32_16x16x32_bf16 v[108:111], v[232:235], a[52:55], v[108:111]
    ds_read_b64_tr_b16 v[204:205], v167 offset:36864
    ds_read_b64_tr_b16 v[206:207], v167 offset:37888
    v_mfma_f32_16x16x32_bf16 v[108:111], v[236:239], a[60:63], v[108:111]
    s_waitcnt vmcnt(63) lgkmcnt(8)
    v_mfma_f32_16x16x32_bf16 v[64:67], v[176:179], a[64:67], v[64:67]
    ds_read_b64_tr_b16 v[208:209], v164 offset:40960
    ds_read_b64_tr_b16 v[210:211], v164 offset:41984
    v_mfma_f32_16x16x32_bf16 v[64:67], v[180:183], a[72:75], v[64:67]
    v_mfma_f32_16x16x32_bf16 v[72:75], v[176:179], a[68:71], v[72:75]
    ds_read_b64_tr_b16 v[212:213], v164 offset:45056
    ds_read_b64_tr_b16 v[214:215], v164 offset:46080
    v_mfma_f32_16x16x32_bf16 v[72:75], v[180:183], a[76:79], v[72:75]
    v_mfma_f32_16x16x32_bf16 v[68:71], v[184:187], a[64:67], v[68:71]
    ds_read_b64_tr_b16 v[216:217], v165 offset:40960
    ds_read_b64_tr_b16 v[218:219], v165 offset:41984
    v_mfma_f32_16x16x32_bf16 v[68:71], v[188:191], a[72:75], v[68:71]
    v_mfma_f32_16x16x32_bf16 v[76:79], v[184:187], a[68:71], v[76:79]
    ds_read_b64_tr_b16 v[220:221], v165 offset:45056
    ds_read_b64_tr_b16 v[222:223], v165 offset:46080
    v_mfma_f32_16x16x32_bf16 v[76:79], v[188:191], a[76:79], v[76:79]
    s_waitcnt lgkmcnt(8)
    v_mfma_f32_16x16x32_bf16 v[96:99], v[192:195], a[64:67], v[96:99]
    ds_read_b64_tr_b16 v[224:225], v166 offset:40960
    ds_read_b64_tr_b16 v[226:227], v166 offset:41984
    v_mfma_f32_16x16x32_bf16 v[96:99], v[196:199], a[72:75], v[96:99]
    v_mfma_f32_16x16x32_bf16 v[104:107], v[192:195], a[68:71], v[104:107]
    ds_read_b64_tr_b16 v[228:229], v166 offset:45056
    ds_read_b64_tr_b16 v[230:231], v166 offset:46080
    v_mfma_f32_16x16x32_bf16 v[104:107], v[196:199], a[76:79], v[104:107]
    v_mfma_f32_16x16x32_bf16 v[100:103], v[200:203], a[64:67], v[100:103]
    ds_read_b64_tr_b16 v[232:233], v167 offset:40960
    ds_read_b64_tr_b16 v[234:235], v167 offset:41984
    v_mfma_f32_16x16x32_bf16 v[100:103], v[204:207], a[72:75], v[100:103]
    v_mfma_f32_16x16x32_bf16 v[108:111], v[200:203], a[68:71], v[108:111]
    ds_read_b64_tr_b16 v[236:237], v167 offset:45056
    ds_read_b64_tr_b16 v[238:239], v167 offset:46080
    v_mfma_f32_16x16x32_bf16 v[108:111], v[204:207], a[76:79], v[108:111]
    s_waitcnt vmcnt(63) lgkmcnt(8)
    s_barrier
    v_mfma_f32_16x16x32_bf16 v[64:67], v[208:211], a[80:83], v[64:67]
    ds_read_b64_tr_b16 v[176:177], v164 offset:49152
    ds_read_b64_tr_b16 v[178:179], v164 offset:50176
    v_mfma_f32_16x16x32_bf16 v[64:67], v[212:215], a[88:91], v[64:67]
    buffer_load_dwordx4 a[100:103], v7, s[32:35], s53 offen offset:1024 sc1
    v_mfma_f32_16x16x32_bf16 v[72:75], v[208:211], a[84:87], v[72:75]
    ds_read_b64_tr_b16 v[180:181], v164 offset:53248
    ds_read_b64_tr_b16 v[182:183], v164 offset:54272
    v_mfma_f32_16x16x32_bf16 v[72:75], v[212:215], a[92:95], v[72:75]
    buffer_load_dwordx4 a[104:107], v7, s[32:35], s53 offen offset:2048 sc1
    v_mfma_f32_16x16x32_bf16 v[68:71], v[216:219], a[80:83], v[68:71]
    ds_read_b64_tr_b16 v[184:185], v165 offset:49152
    ds_read_b64_tr_b16 v[186:187], v165 offset:50176
    v_mfma_f32_16x16x32_bf16 v[68:71], v[220:223], a[88:91], v[68:71]
    buffer_load_dwordx4 a[108:111], v7, s[32:35], s53 offen offset:3072 sc1
    s_add_u32 s53, s53, 0x40000
    v_mfma_f32_16x16x32_bf16 v[76:79], v[216:219], a[84:87], v[76:79]
    ds_read_b64_tr_b16 v[188:189], v165 offset:53248
    ds_read_b64_tr_b16 v[190:191], v165 offset:54272
    v_mfma_f32_16x16x32_bf16 v[76:79], v[220:223], a[92:95], v[76:79]
    buffer_load_dwordx4 a[112:115], v7, s[32:35], s53 offen offset:0 sc1
    s_waitcnt lgkmcnt(8)
    v_mfma_f32_16x16x32_bf16 v[96:99], v[224:227], a[80:83], v[96:99]
    ds_read_b64_tr_b16 v[192:193], v166 offset:49152
    ds_read_b64_tr_b16 v[194:195], v166 offset:50176
    v_mfma_f32_16x16x32_bf16 v[96:99], v[228:231], a[88:91], v[96:99]
    buffer_load_dwordx4 a[116:119], v7, s[32:35], s53 offen offset:1024 sc1
    v_mfma_f32_16x16x32_bf16 v[104:107], v[224:227], a[84:87], v[104:107]
    ds_read_b64_tr_b16 v[196:197], v166 offset:53248
    ds_read_b64_tr_b16 v[198:199], v166 offset:54272
    v_mfma_f32_16x16x32_bf16 v[104:107], v[228:231], a[92:95], v[104:107]
    buffer_load_dwordx4 a[120:123], v7, s[32:35], s53 offen offset:2048 sc1
    v_mfma_f32_16x16x32_bf16 v[100:103], v[232:235], a[80:83], v[100:103]
    ds_read_b64_tr_b16 v[200:201], v167 offset:49152
    ds_read_b64_tr_b16 v[202:203], v167 offset:50176
    v_mfma_f32_16x16x32_bf16 v[100:103], v[236:239], a[88:91], v[100:103]
    buffer_load_dwordx4 a[124:127], v7, s[32:35], s53 offen offset:3072 sc1
    s_add_u32 s53, s53, 0x40000
    v_mfma_f32_16x16x32_bf16 v[108:111], v[232:235], a[84:87], v[108:111]
    ds_read_b64_tr_b16 v[204:205], v167 offset:53248
    ds_read_b64_tr_b16 v[206:207], v167 offset:54272
    v_mfma_f32_16x16x32_bf16 v[108:111], v[236:239], a[92:95], v[108:111]
    s_add_u32 m0, s30, 16384
    s_nop 0
    buffer_load_dwordx4 v172, s[20:23], s57 offen offset:0 lds
    s_waitcnt vmcnt(61) lgkmcnt(8)
    v_mfma_f32_16x16x32_bf16 v[64:67], v[176:179], a[192:195], v[64:67]
    ds_read_b64_tr_b16 v[208:209], v164 offset:57344
    ds_read_b64_tr_b16 v[210:211], v164 offset:58368
    v_mfma_f32_16x16x32_bf16 v[64:67], v[180:183], a[200:203], v[64:67]
    buffer_load_dwordx4 v173, s[20:23], s57 offen offset:1024 lds
    v_mfma_f32_16x16x32_bf16 v[72:75], v[176:179], a[196:199], v[72:75]
    ds_read_b64_tr_b16 v[212:213], v164 offset:61440
    ds_read_b64_tr_b16 v[214:215], v164 offset:62464
    v_mfma_f32_16x16x32_bf16 v[72:75], v[180:183], a[204:207], v[72:75]
    buffer_load_dwordx4 v174, s[20:23], s57 offen offset:2048 lds
    v_mfma_f32_16x16x32_bf16 v[68:71], v[184:187], a[192:195], v[68:71]
    ds_read_b64_tr_b16 v[216:217], v165 offset:57344
    ds_read_b64_tr_b16 v[218:219], v165 offset:58368
    v_mfma_f32_16x16x32_bf16 v[68:71], v[188:191], a[200:203], v[68:71]
    buffer_load_dwordx4 v175, s[20:23], s57 offen offset:3072 lds
    s_add_u32 s57, s57, 0x40000
    v_mfma_f32_16x16x32_bf16 v[76:79], v[184:187], a[196:199], v[76:79]
    ds_read_b64_tr_b16 v[220:221], v165 offset:61440
    ds_read_b64_tr_b16 v[222:223], v165 offset:62464
    v_mfma_f32_16x16x32_bf16 v[76:79], v[188:191], a[204:207], v[76:79]
    buffer_load_dwordx4 a[128:131], v7, s[32:35], s53 offen offset:0 sc1
    s_waitcnt lgkmcnt(8)
    v_mfma_f32_16x16x32_bf16 v[96:99], v[192:195], a[192:195], v[96:99]
    ds_read_b64_tr_b16 v[224:225], v166 offset:57344
    ds_read_b64_tr_b16 v[226:227], v166 offset:58368
    v_mfma_f32_16x16x32_bf16 v[96:99], v[196:199], a[200:203], v[96:99]
    buffer_load_dwordx4 a[132:135], v7, s[32:35], s53 offen offset:1024 sc1
    v_mfma_f32_16x16x32_bf16 v[104:107], v[192:195], a[196:199], v[104:107]
    ds_read_b64_tr_b16 v[228:229], v166 offset:61440
    ds_read_b64_tr_b16 v[230:231], v166 offset:62464
    v_mfma_f32_16x16x32_bf16 v[104:107], v[196:199], a[204:207], v[104:107]
    buffer_load_dwordx4 a[136:139], v7, s[32:35], s53 offen offset:2048 sc1
    v_mfma_f32_16x16x32_bf16 v[100:103], v[200:203], a[192:195], v[100:103]
    ds_read_b64_tr_b16 v[232:233], v167 offset:57344
    ds_read_b64_tr_b16 v[234:235], v167 offset:58368
    v_mfma_f32_16x16x32_bf16 v[100:103], v[204:207], a[200:203], v[100:103]
    buffer_load_dwordx4 a[140:143], v7, s[32:35], s53 offen offset:3072 sc1
    s_add_u32 s53, s53, 0x40000
    v_mfma_f32_16x16x32_bf16 v[108:111], v[200:203], a[196:199], v[108:111]
    ds_read_b64_tr_b16 v[236:237], v167 offset:61440
    ds_read_b64_tr_b16 v[238:239], v167 offset:62464
    v_mfma_f32_16x16x32_bf16 v[108:111], v[204:207], a[204:207], v[108:111]
    buffer_load_dwordx4 a[144:147], v7, s[32:35], s53 offen offset:0 sc1
    s_waitcnt vmcnt(63)
    ds_read_b64 v[128:129], v246 offset:0
    ds_read_b64 v[130:131], v247 offset:0
    ds_read_b64 v[132:133], v246 offset:2048
    ds_read_b64 v[134:135], v247 offset:2048
    ds_read_b64 v[136:137], v248 offset:0
    ds_read_b64 v[138:139], v249 offset:0
    ds_read_b64 v[140:141], v248 offset:2048
    ds_read_b64 v[142:143], v249 offset:2048
    s_waitcnt vmcnt(53) lgkmcnt(8)
    s_barrier
    v_mfma_f32_16x16x32_bf16 v[64:67], v[208:211], a[208:211], v[64:67]
    ds_read_b64_tr_b16 v[176:177], v160 offset:32768
    ds_read_b64_tr_b16 v[178:179], v160 offset:33792
    v_mfma_f32_16x16x32_bf16 v[64:67], v[212:215], a[216:219], v[64:67]
    buffer_load_dwordx4 a[148:151], v7, s[32:35], s53 offen offset:1024 sc1
    v_mfma_f32_16x16x32_bf16 v[72:75], v[208:211], a[212:215], v[72:75]
    ds_read_b64_tr_b16 v[180:181], v160 offset:36864
    ds_read_b64_tr_b16 v[182:183], v160 offset:37888
    v_mfma_f32_16x16x32_bf16 v[72:75], v[212:215], a[220:223], v[72:75]
    buffer_load_dwordx4 a[152:155], v7, s[32:35], s53 offen offset:2048 sc1
    v_mfma_f32_16x16x32_bf16 v[68:71], v[216:219], a[208:211], v[68:71]
    ds_read_b64_tr_b16 v[184:185], v161 offset:32768
    ds_read_b64_tr_b16 v[186:187], v161 offset:33792
    v_mfma_f32_16x16x32_bf16 v[68:71], v[220:223], a[216:219], v[68:71]
    buffer_load_dwordx4 a[156:159], v7, s[32:35], s53 offen offset:3072 sc1
    s_add_u32 s53, s53, 0x40000
    v_mfma_f32_16x16x32_bf16 v[76:79], v[216:219], a[212:215], v[76:79]
    ds_read_b64_tr_b16 v[188:189], v161 offset:36864
    ds_read_b64_tr_b16 v[190:191], v161 offset:37888
    v_mfma_f32_16x16x32_bf16 v[76:79], v[220:223], a[220:223], v[76:79]
    s_waitcnt lgkmcnt(8)
    v_mfma_f32_16x16x32_bf16 v[96:99], v[224:227], a[208:211], v[96:99]
    ds_read_b64_tr_b16 v[192:193], v162 offset:32768
    ds_read_b64_tr_b16 v[194:195], v162 offset:33792
    v_mfma_f32_16x16x32_bf16 v[96:99], v[228:231], a[216:219], v[96:99]
    v_mfma_f32_16x16x32_bf16 v[104:107], v[224:227], a[212:215], v[104:107]
    ds_read_b64_tr_b16 v[196:197], v162 offset:36864
    ds_read_b64_tr_b16 v[198:199], v162 offset:37888
    v_mfma_f32_16x16x32_bf16 v[104:107], v[228:231], a[220:223], v[104:107]
    v_mfma_f32_16x16x32_bf16 v[100:103], v[232:235], a[208:211], v[100:103]
    ds_read_b64_tr_b16 v[200:201], v163 offset:32768
    ds_read_b64_tr_b16 v[202:203], v163 offset:33792
    v_mfma_f32_16x16x32_bf16 v[100:103], v[236:239], a[216:219], v[100:103]
    v_mfma_f32_16x16x32_bf16 v[108:111], v[232:235], a[212:215], v[108:111]
    ds_read_b64_tr_b16 v[204:205], v163 offset:36864
    ds_read_b64_tr_b16 v[206:207], v163 offset:37888
    v_mfma_f32_16x16x32_bf16 v[108:111], v[236:239], a[220:223], v[108:111]
    s_waitcnt vmcnt(52) lgkmcnt(8)
    v_mfma_f32_16x16x32_bf16 v[64:67], v[176:179], a[224:227], v[64:67]
    ds_read_b64_tr_b16 v[208:209], v160 offset:40960
    ds_read_b64_tr_b16 v[210:211], v160 offset:41984
    v_mfma_f32_16x16x32_bf16 v[64:67], v[180:183], a[232:235], v[64:67]
    s_add_u32 s5, s52, 0
    buffer_load_dwordx4 v[48:51], v7, s[32:35], s5 offen sc1
    v_mfma_f32_16x16x32_bf16 v[72:75], v[176:179], a[228:231], v[72:75]
    ds_read_b64_tr_b16 v[212:213], v160 offset:45056
    ds_read_b64_tr_b16 v[214:215], v160 offset:46080
    v_mfma_f32_16x16x32_bf16 v[72:75], v[180:183], a[236:239], v[72:75]
    v_mfma_f32_16x16x32_bf16 v[68:71], v[184:187], a[224:227], v[68:71]
    ds_read_b64_tr_b16 v[216:217], v161 offset:40960
    ds_read_b64_tr_b16 v[218:219], v161 offset:41984
    v_mfma_f32_16x16x32_bf16 v[68:71], v[188:191], a[232:235], v[68:71]
    s_add_u32 s5, s52, 1048576
    buffer_load_dwordx4 v[52:55], v7, s[32:35], s5 offen sc1
    v_mfma_f32_16x16x32_bf16 v[76:79], v[184:187], a[228:231], v[76:79]
    ds_read_b64_tr_b16 v[220:221], v161 offset:45056
    ds_read_b64_tr_b16 v[222:223], v161 offset:46080
    v_mfma_f32_16x16x32_bf16 v[76:79], v[188:191], a[236:239], v[76:79]
    s_waitcnt lgkmcnt(8)
    v_mfma_f32_16x16x32_bf16 v[96:99], v[192:195], a[224:227], v[96:99]
    ds_read_b64_tr_b16 v[224:225], v162 offset:40960
    ds_read_b64_tr_b16 v[226:227], v162 offset:41984
    v_mfma_f32_16x16x32_bf16 v[96:99], v[196:199], a[232:235], v[96:99]
    s_add_u32 s5, s52, 2097152
    buffer_load_dwordx4 v[56:59], v7, s[32:35], s5 offen sc1
    v_mfma_f32_16x16x32_bf16 v[104:107], v[192:195], a[228:231], v[104:107]
    ds_read_b64_tr_b16 v[228:229], v162 offset:45056
    ds_read_b64_tr_b16 v[230:231], v162 offset:46080
    v_mfma_f32_16x16x32_bf16 v[104:107], v[196:199], a[236:239], v[104:107]
    v_mfma_f32_16x16x32_bf16 v[100:103], v[200:203], a[224:227], v[100:103]
    ds_read_b64_tr_b16 v[232:233], v163 offset:40960
    ds_read_b64_tr_b16 v[234:235], v163 offset:41984
    v_mfma_f32_16x16x32_bf16 v[100:103], v[204:207], a[232:235], v[100:103]
    s_add_u32 s5, s52, 3145728
    buffer_load_dwordx4 v[60:63], v7, s[32:35], s5 offen sc1
    v_mfma_f32_16x16x32_bf16 v[108:111], v[200:203], a[228:231], v[108:111]
    ds_read_b64_tr_b16 v[236:237], v163 offset:45056
    ds_read_b64_tr_b16 v[238:239], v163 offset:46080
    v_mfma_f32_16x16x32_bf16 v[108:111], v[204:207], a[236:239], v[108:111]
    s_waitcnt vmcnt(48) lgkmcnt(8)
    s_barrier
    v_mfma_f32_16x16x32_bf16 v[64:67], v[208:211], a[240:243], v[64:67]
    ds_read_b64_tr_b16 v[176:177], v160 offset:49152
    ds_read_b64_tr_b16 v[178:179], v160 offset:50176
    v_mfma_f32_16x16x32_bf16 v[64:67], v[212:215], a[248:251], v[64:67]
    s_add_u32 s5, s52, 8388608
    buffer_load_dwordx4 v[112:115], v7, s[32:35], s5 offen sc1
    v_mfma_f32_16x16x32_bf16 v[72:75], v[208:211], a[244:247], v[72:75]
    ds_read_b64_tr_b16 v[180:181], v160 offset:53248
    ds_read_b64_tr_b16 v[182:183], v160 offset:54272
    v_mfma_f32_16x16x32_bf16 v[72:75], v[212:215], a[252:255], v[72:75]
    v_mfma_f32_16x16x32_bf16 v[68:71], v[216:219], a[240:243], v[68:71]
    ds_read_b64_tr_b16 v[184:185], v161 offset:49152
    ds_read_b64_tr_b16 v[186:187], v161 offset:50176
    v_mfma_f32_16x16x32_bf16 v[68:71], v[220:223], a[248:251], v[68:71]
    s_add_u32 s5, s52, 9437184
    buffer_load_dwordx4 v[116:119], v7, s[32:35], s5 offen sc1
    v_mfma_f32_16x16x32_bf16 v[76:79], v[216:219], a[244:247], v[76:79]
    ds_read_b64_tr_b16 v[188:189], v161 offset:53248
    ds_read_b64_tr_b16 v[190:191], v161 offset:54272
    v_mfma_f32_16x16x32_bf16 v[76:79], v[220:223], a[252:255], v[76:79]
    s_waitcnt lgkmcnt(8)
    v_mfma_f32_16x16x32_bf16 v[96:99], v[224:227], a[240:243], v[96:99]
    ds_read_b64_tr_b16 v[192:193], v162 offset:49152
    ds_read_b64_tr_b16 v[194:195], v162 offset:50176
    v_mfma_f32_16x16x32_bf16 v[96:99], v[228:231], a[248:251], v[96:99]
    s_add_u32 s5, s52, 10485760
    buffer_load_dwordx4 v[120:123], v7, s[32:35], s5 offen sc1
    v_mfma_f32_16x16x32_bf16 v[104:107], v[224:227], a[244:247], v[104:107]
    ds_read_b64_tr_b16 v[196:197], v162 offset:53248
    ds_read_b64_tr_b16 v[198:199], v162 offset:54272
    v_mfma_f32_16x16x32_bf16 v[104:107], v[228:231], a[252:255], v[104:107]
    v_mfma_f32_16x16x32_bf16 v[100:103], v[232:235], a[240:243], v[100:103]
    ds_read_b64_tr_b16 v[200:201], v163 offset:49152
    ds_read_b64_tr_b16 v[202:203], v163 offset:50176
    v_mfma_f32_16x16x32_bf16 v[100:103], v[236:239], a[248:251], v[100:103]
    s_add_u32 s5, s52, 11534336
    buffer_load_dwordx4 v[124:127], v7, s[32:35], s5 offen sc1
    v_mfma_f32_16x16x32_bf16 v[108:111], v[232:235], a[244:247], v[108:111]
    ds_read_b64_tr_b16 v[204:205], v163 offset:53248
    ds_read_b64_tr_b16 v[206:207], v163 offset:54272
    v_mfma_f32_16x16x32_bf16 v[108:111], v[236:239], a[252:255], v[108:111]
    s_waitcnt vmcnt(48) lgkmcnt(8)
    v_mfma_f32_16x16x32_bf16 v[64:67], v[176:179], a[160:163], v[64:67]
    ds_read_b64_tr_b16 v[208:209], v160 offset:57344
    ds_read_b64_tr_b16 v[210:211], v160 offset:58368
    v_mfma_f32_16x16x32_bf16 v[64:67], v[180:183], a[168:171], v[64:67]
    s_add_u32 s5, s52, 4194304
    buffer_load_dwordx4 v[80:83], v7, s[32:35], s5 offen sc1
    v_mfma_f32_16x16x32_bf16 v[72:75], v[176:179], a[164:167], v[72:75]
    ds_read_b64_tr_b16 v[212:213], v160 offset:61440
    ds_read_b64_tr_b16 v[214:215], v160 offset:62464
    v_mfma_f32_16x16x32_bf16 v[72:75], v[180:183], a[172:175], v[72:75]
    v_mfma_f32_16x16x32_bf16 v[68:71], v[184:187], a[160:163], v[68:71]
    ds_read_b64_tr_b16 v[216:217], v161 offset:57344
    ds_read_b64_tr_b16 v[218:219], v161 offset:58368
    v_mfma_f32_16x16x32_bf16 v[68:71], v[188:191], a[168:171], v[68:71]
    s_add_u32 s5, s52, 5242880
    buffer_load_dwordx4 v[84:87], v7, s[32:35], s5 offen sc1
    v_mfma_f32_16x16x32_bf16 v[76:79], v[184:187], a[164:167], v[76:79]
    ds_read_b64_tr_b16 v[220:221], v161 offset:61440
    ds_read_b64_tr_b16 v[222:223], v161 offset:62464
    v_mfma_f32_16x16x32_bf16 v[76:79], v[188:191], a[172:175], v[76:79]
    s_waitcnt lgkmcnt(8)
    v_mfma_f32_16x16x32_bf16 v[96:99], v[192:195], a[160:163], v[96:99]
    ds_read_b64_tr_b16 v[224:225], v162 offset:57344
    ds_read_b64_tr_b16 v[226:227], v162 offset:58368
    v_mfma_f32_16x16x32_bf16 v[96:99], v[196:199], a[168:171], v[96:99]
    s_add_u32 s5, s52, 6291456
    buffer_load_dwordx4 v[88:91], v7, s[32:35], s5 offen sc1
    v_mfma_f32_16x16x32_bf16 v[104:107], v[192:195], a[164:167], v[104:107]
    ds_read_b64_tr_b16 v[228:229], v162 offset:61440
    ds_read_b64_tr_b16 v[230:231], v162 offset:62464
    v_mfma_f32_16x16x32_bf16 v[104:107], v[196:199], a[172:175], v[104:107]
    v_mfma_f32_16x16x32_bf16 v[100:103], v[200:203], a[160:163], v[100:103]
    ds_read_b64_tr_b16 v[232:233], v163 offset:57344
    ds_read_b64_tr_b16 v[234:235], v163 offset:58368
    v_mfma_f32_16x16x32_bf16 v[100:103], v[204:207], a[168:171], v[100:103]
    s_add_u32 s5, s52, 7340032
    buffer_load_dwordx4 v[92:95], v7, s[32:35], s5 offen sc1
    v_mfma_f32_16x16x32_bf16 v[108:111], v[200:203], a[164:167], v[108:111]
    ds_read_b64_tr_b16 v[236:237], v163 offset:61440
    ds_read_b64_tr_b16 v[238:239], v163 offset:62464
    v_mfma_f32_16x16x32_bf16 v[108:111], v[204:207], a[172:175], v[108:111]
    s_waitcnt vmcnt(36) lgkmcnt(8)
    s_barrier
    v_mfma_f32_16x16x32_bf16 v[64:67], v[208:211], a[176:179], v[64:67]
    ds_read_b64_tr_b16 v[176:177], v160 offset:0
    ds_read_b64_tr_b16 v[178:179], v160 offset:1024
    v_mfma_f32_16x16x32_bf16 v[64:67], v[212:215], a[184:187], v[64:67]
    v_mfma_f32_16x16x32_bf16 v[72:75], v[208:211], a[180:183], v[72:75]
    ds_read_b64_tr_b16 v[180:181], v160 offset:4096
    ds_read_b64_tr_b16 v[182:183], v160 offset:5120
    v_mfma_f32_16x16x32_bf16 v[72:75], v[212:215], a[188:191], v[72:75]
    v_mfma_f32_16x16x32_bf16 v[68:71], v[216:219], a[176:179], v[68:71]
    ds_read_b64_tr_b16 v[184:185], v161 offset:0
    ds_read_b64_tr_b16 v[186:187], v161 offset:1024
    v_mfma_f32_16x16x32_bf16 v[68:71], v[220:223], a[184:187], v[68:71]
    v_mfma_f32_16x16x32_bf16 v[76:79], v[216:219], a[180:183], v[76:79]
    ds_read_b64_tr_b16 v[188:189], v161 offset:4096
    ds_read_b64_tr_b16 v[190:191], v161 offset:5120
    v_mfma_f32_16x16x32_bf16 v[76:79], v[220:223], a[188:191], v[76:79]
    s_waitcnt lgkmcnt(8)
    v_mfma_f32_16x16x32_bf16 v[96:99], v[224:227], a[176:179], v[96:99]
    ds_read_b64_tr_b16 v[192:193], v162 offset:0
    ds_read_b64_tr_b16 v[194:195], v162 offset:1024
    v_mfma_f32_16x16x32_bf16 v[96:99], v[228:231], a[184:187], v[96:99]
    v_mfma_f32_16x16x32_bf16 v[104:107], v[224:227], a[180:183], v[104:107]
    ds_read_b64_tr_b16 v[196:197], v162 offset:4096
    ds_read_b64_tr_b16 v[198:199], v162 offset:5120
    v_mfma_f32_16x16x32_bf16 v[104:107], v[228:231], a[188:191], v[104:107]
    v_mfma_f32_16x16x32_bf16 v[100:103], v[232:235], a[176:179], v[100:103]
    ds_read_b64_tr_b16 v[200:201], v163 offset:0
    ds_read_b64_tr_b16 v[202:203], v163 offset:1024
    v_mfma_f32_16x16x32_bf16 v[100:103], v[236:239], a[184:187], v[100:103]
    v_mfma_f32_16x16x32_bf16 v[108:111], v[232:235], a[180:183], v[108:111]
    ds_read_b64_tr_b16 v[204:205], v163 offset:4096
    ds_read_b64_tr_b16 v[206:207], v163 offset:5120
    v_mfma_f32_16x16x32_bf16 v[108:111], v[236:239], a[188:191], v[108:111]
    s_waitcnt vmcnt(28) lgkmcnt(8)
    v_mfma_f32_16x16x32_bf16 v[64:67], v[176:179], a[96:99], v[64:67]
    ds_read_b64_tr_b16 v[208:209], v160 offset:8192
    ds_read_b64_tr_b16 v[210:211], v160 offset:9216
    v_mfma_f32_16x16x32_bf16 v[64:67], v[180:183], a[104:107], v[64:67]
    v_mfma_f32_16x16x32_bf16 v[72:75], v[176:179], a[100:103], v[72:75]
    ds_read_b64_tr_b16 v[212:213], v160 offset:12288
    ds_read_b64_tr_b16 v[214:215], v160 offset:13312
    v_mfma_f32_16x16x32_bf16 v[72:75], v[180:183], a[108:111], v[72:75]
    v_mfma_f32_16x16x32_bf16 v[68:71], v[184:187], a[96:99], v[68:71]
    ds_read_b64_tr_b16 v[216:217], v161 offset:8192
    ds_read_b64_tr_b16 v[218:219], v161 offset:9216
    v_mfma_f32_16x16x32_bf16 v[68:71], v[188:191], a[104:107], v[68:71]
    v_mfma_f32_16x16x32_bf16 v[76:79], v[184:187], a[100:103], v[76:79]
    ds_read_b64_tr_b16 v[220:221], v161 offset:12288
    ds_read_b64_tr_b16 v[222:223], v161 offset:13312
    v_mfma_f32_16x16x32_bf16 v[76:79], v[188:191], a[108:111], v[76:79]
    s_waitcnt lgkmcnt(8)
    v_mfma_f32_16x16x32_bf16 v[96:99], v[192:195], a[96:99], v[96:99]
    ds_read_b64_tr_b16 v[224:225], v162 offset:8192
    ds_read_b64_tr_b16 v[226:227], v162 offset:9216
    v_mfma_f32_16x16x32_bf16 v[96:99], v[196:199], a[104:107], v[96:99]
    v_mfma_f32_16x16x32_bf16 v[104:107], v[192:195], a[100:103], v[104:107]
    ds_read_b64_tr_b16 v[228:229], v162 offset:12288
    ds_read_b64_tr_b16 v[230:231], v162 offset:13312
    v_mfma_f32_16x16x32_bf16 v[104:107], v[196:199], a[108:111], v[104:107]
    v_mfma_f32_16x16x32_bf16 v[100:103], v[200:203], a[96:99], v[100:103]
    ds_read_b64_tr_b16 v[232:233], v163 offset:8192
    ds_read_b64_tr_b16 v[234:235], v163 offset:9216
    v_mfma_f32_16x16x32_bf16 v[100:103], v[204:207], a[104:107], v[100:103]
    v_mfma_f32_16x16x32_bf16 v[108:111], v[200:203], a[100:103], v[108:111]
    ds_read_b64_tr_b16 v[236:237], v163 offset:12288
    ds_read_b64_tr_b16 v[238:239], v163 offset:13312
    v_mfma_f32_16x16x32_bf16 v[108:111], v[204:207], a[108:111], v[108:111]
    s_waitcnt vmcnt(20) lgkmcnt(8)
    s_barrier
    v_mfma_f32_16x16x32_bf16 v[64:67], v[208:211], a[112:115], v[64:67]
    ds_read_b64_tr_b16 v[176:177], v160 offset:16384
    ds_read_b64_tr_b16 v[178:179], v160 offset:17408
    v_mfma_f32_16x16x32_bf16 v[64:67], v[212:215], a[120:123], v[64:67]
    v_mfma_f32_16x16x32_bf16 v[72:75], v[208:211], a[116:119], v[72:75]
    ds_read_b64_tr_b16 v[180:181], v160 offset:20480
    ds_read_b64_tr_b16 v[182:183], v160 offset:21504
    v_mfma_f32_16x16x32_bf16 v[72:75], v[212:215], a[124:127], v[72:75]
    v_mfma_f32_16x16x32_bf16 v[68:71], v[216:219], a[112:115], v[68:71]
    ds_read_b64_tr_b16 v[184:185], v161 offset:16384
    ds_read_b64_tr_b16 v[186:187], v161 offset:17408
    v_mfma_f32_16x16x32_bf16 v[68:71], v[220:223], a[120:123], v[68:71]
    v_mfma_f32_16x16x32_bf16 v[76:79], v[216:219], a[116:119], v[76:79]
    ds_read_b64_tr_b16 v[188:189], v161 offset:20480
    ds_read_b64_tr_b16 v[190:191], v161 offset:21504
    v_mfma_f32_16x16x32_bf16 v[76:79], v[220:223], a[124:127], v[76:79]
    s_waitcnt lgkmcnt(8)
    v_mfma_f32_16x16x32_bf16 v[96:99], v[224:227], a[112:115], v[96:99]
    ds_read_b64_tr_b16 v[192:193], v162 offset:16384
    ds_read_b64_tr_b16 v[194:195], v162 offset:17408
    v_mfma_f32_16x16x32_bf16 v[96:99], v[228:231], a[120:123], v[96:99]
    v_mfma_f32_16x16x32_bf16 v[104:107], v[224:227], a[116:119], v[104:107]
    ds_read_b64_tr_b16 v[196:197], v162 offset:20480
    ds_read_b64_tr_b16 v[198:199], v162 offset:21504
    v_mfma_f32_16x16x32_bf16 v[104:107], v[228:231], a[124:127], v[104:107]
    v_mfma_f32_16x16x32_bf16 v[100:103], v[232:235], a[112:115], v[100:103]
    ds_read_b64_tr_b16 v[200:201], v163 offset:16384
    ds_read_b64_tr_b16 v[202:203], v163 offset:17408
    v_mfma_f32_16x16x32_bf16 v[100:103], v[236:239], a[120:123], v[100:103]
    v_mfma_f32_16x16x32_bf16 v[108:111], v[232:235], a[116:119], v[108:111]
    ds_read_b64_tr_b16 v[204:205], v163 offset:20480
    ds_read_b64_tr_b16 v[206:207], v163 offset:21504
    v_mfma_f32_16x16x32_bf16 v[108:111], v[236:239], a[124:127], v[108:111]
    s_waitcnt vmcnt(16) lgkmcnt(8)
    v_mfma_f32_16x16x32_bf16 v[64:67], v[176:179], a[128:131], v[64:67]
    ds_read_b64_tr_b16 v[208:209], v160 offset:24576
    ds_read_b64_tr_b16 v[210:211], v160 offset:25600
    v_mfma_f32_16x16x32_bf16 v[64:67], v[180:183], a[136:139], v[64:67]
    v_mfma_f32_16x16x32_bf16 v[72:75], v[176:179], a[132:135], v[72:75]
    ds_read_b64_tr_b16 v[212:213], v160 offset:28672
    ds_read_b64_tr_b16 v[214:215], v160 offset:29696
    v_mfma_f32_16x16x32_bf16 v[72:75], v[180:183], a[140:143], v[72:75]
    v_mfma_f32_16x16x32_bf16 v[68:71], v[184:187], a[128:131], v[68:71]
    ds_read_b64_tr_b16 v[216:217], v161 offset:24576
    ds_read_b64_tr_b16 v[218:219], v161 offset:25600
    v_mfma_f32_16x16x32_bf16 v[68:71], v[188:191], a[136:139], v[68:71]
    v_mfma_f32_16x16x32_bf16 v[76:79], v[184:187], a[132:135], v[76:79]
    ds_read_b64_tr_b16 v[220:221], v161 offset:28672
    ds_read_b64_tr_b16 v[222:223], v161 offset:29696
    v_mfma_f32_16x16x32_bf16 v[76:79], v[188:191], a[140:143], v[76:79]
    s_waitcnt lgkmcnt(8)
    v_mfma_f32_16x16x32_bf16 v[96:99], v[192:195], a[128:131], v[96:99]
    ds_read_b64_tr_b16 v[224:225], v162 offset:24576
    ds_read_b64_tr_b16 v[226:227], v162 offset:25600
    v_mfma_f32_16x16x32_bf16 v[96:99], v[196:199], a[136:139], v[96:99]
    v_mfma_f32_16x16x32_bf16 v[104:107], v[192:195], a[132:135], v[104:107]
    ds_read_b64_tr_b16 v[228:229], v162 offset:28672
    ds_read_b64_tr_b16 v[230:231], v162 offset:29696
    v_mfma_f32_16x16x32_bf16 v[104:107], v[196:199], a[140:143], v[104:107]
    v_mfma_f32_16x16x32_bf16 v[100:103], v[200:203], a[128:131], v[100:103]
    ds_read_b64_tr_b16 v[232:233], v163 offset:24576
    ds_read_b64_tr_b16 v[234:235], v163 offset:25600
    v_mfma_f32_16x16x32_bf16 v[100:103], v[204:207], a[136:139], v[100:103]
    v_mfma_f32_16x16x32_bf16 v[108:111], v[200:203], a[132:135], v[108:111]
    ds_read_b64_tr_b16 v[236:237], v163 offset:28672
    ds_read_b64_tr_b16 v[238:239], v163 offset:29696
    v_mfma_f32_16x16x32_bf16 v[108:111], v[204:207], a[140:143], v[108:111]
    s_waitcnt vmcnt(0)
    s_mov_b32 s4, 0
recurrent_scan__linear_kernel_hedgehog__glu_gated_bilinear__prompt_kernel_chk2:
    v_max3_u32 v2, v48, v49, v50
    v_max3_u32 v3, v51, v52, v53
    v_max3_u32 v2, v2, v54, v55
    v_max3_u32 v3, v3, v56, v57
    v_max3_u32 v2, v2, v58, v59
    v_max3_u32 v3, v3, v60, v61
    v_max3_u32 v2, v2, v62, v63
    v_max3_u32 v3, v3, v80, v81
    v_max3_u32 v2, v2, v82, v83
    v_max3_u32 v3, v3, v84, v85
    v_max3_u32 v2, v2, v86, v87
    v_max3_u32 v3, v3, v88, v89
    v_max3_u32 v2, v2, v90, v91
    v_max3_u32 v3, v3, v92, v93
    v_max3_u32 v2, v2, v94, v95
    v_max3_u32 v3, v3, v112, v113
    v_max3_u32 v2, v2, v114, v115
    v_max3_u32 v3, v3, v116, v117
    v_max3_u32 v2, v2, v118, v119
    v_max3_u32 v3, v3, v120, v121
    v_max3_u32 v2, v2, v122, v123
    v_max3_u32 v3, v3, v124, v125
    v_max3_u32 v2, v2, v126, v127
    v_max_u32 v2, v2, v3
    v_cmp_eq_u32 vcc, -1, v2
    s_nop 4
    s_cbranch_vccz recurrent_scan__linear_kernel_hedgehog__glu_gated_bilinear__prompt_kernel_got2
    s_add_u32 s4, s4, 1
    s_cmp_ge_u32 s4, 200000
    s_cbranch_scc1 recurrent_scan__linear_kernel_hedgehog__glu_gated_bilinear__prompt_kernel_got2
    s_add_u32 s5, s52, 0
    buffer_load_dwordx4 v[48:51], v7, s[32:35], s5 offen sc1
    s_add_u32 s5, s52, 1048576
    buffer_load_dwordx4 v[52:55], v7, s[32:35], s5 offen sc1
    s_add_u32 s5, s52, 2097152
    buffer_load_dwordx4 v[56:59], v7, s[32:35], s5 offen sc1
    s_add_u32 s5, s52, 3145728
    buffer_load_dwordx4 v[60:63], v7, s[32:35], s5 offen sc1
    s_add_u32 s5, s52, 4194304
    buffer_load_dwordx4 v[80:83], v7, s[32:35], s5 offen sc1
    s_add_u32 s5, s52, 5242880
    buffer_load_dwordx4 v[84:87], v7, s[32:35], s5 offen sc1
    s_add_u32 s5, s52, 6291456
    buffer_load_dwordx4 v[88:91], v7, s[32:35], s5 offen sc1
    s_add_u32 s5, s52, 7340032
    buffer_load_dwordx4 v[92:95], v7, s[32:35], s5 offen sc1
    s_add_u32 s5, s52, 8388608
    buffer_load_dwordx4 v[112:115], v7, s[32:35], s5 offen sc1
    s_add_u32 s5, s52, 9437184
    buffer_load_dwordx4 v[116:119], v7, s[32:35], s5 offen sc1
    s_add_u32 s5, s52, 10485760
    buffer_load_dwordx4 v[120:123], v7, s[32:35], s5 offen sc1
    s_add_u32 s5, s52, 11534336
    buffer_load_dwordx4 v[124:127], v7, s[32:35], s5 offen sc1
    s_waitcnt vmcnt(0)
    s_branch recurrent_scan__linear_kernel_hedgehog__glu_gated_bilinear__prompt_kernel_chk2
recurrent_scan__linear_kernel_hedgehog__glu_gated_bilinear__prompt_kernel_got2:
    s_mov_b32 s7, 3216550459
    s_mov_b32 s6, 0xffff0000
    v_mfma_f32_16x16x32_bf16 v[16:19], v[242:245], v[48:51], v[16:19]
    v_mfma_f32_16x16x32_bf16 v[16:19], v[242:245], v[80:83], v[16:19]
    v_mfma_f32_16x16x32_bf16 v[16:19], v[242:245], v[112:115], v[16:19]
    v_mfma_f32_16x16x32_bf16 v[20:23], v[240:243], v[48:51], v[20:23]
    v_mfma_f32_16x16x32_bf16 v[20:23], v[240:243], v[80:83], v[20:23]
    v_mfma_f32_16x16x32_bf16 v[20:23], v[240:243], v[112:115], v[20:23]
    v_mfma_f32_16x16x32_bf16 v[24:27], v[242:245], v[52:55], v[24:27]
    v_mfma_f32_16x16x32_bf16 v[24:27], v[242:245], v[84:87], v[24:27]
    v_mfma_f32_16x16x32_bf16 v[24:27], v[242:245], v[116:119], v[24:27]
    v_mfma_f32_16x16x32_bf16 v[28:31], v[240:243], v[52:55], v[28:31]
    v_mfma_f32_16x16x32_bf16 v[28:31], v[240:243], v[84:87], v[28:31]
    v_mfma_f32_16x16x32_bf16 v[28:31], v[240:243], v[116:119], v[28:31]
    v_mfma_f32_16x16x32_bf16 v[32:35], v[242:245], v[56:59], v[32:35]
    v_mfma_f32_16x16x32_bf16 v[32:35], v[242:245], v[88:91], v[32:35]
    v_mfma_f32_16x16x32_bf16 v[32:35], v[242:245], v[120:123], v[32:35]
    v_mfma_f32_16x16x32_bf16 v[36:39], v[240:243], v[56:59], v[36:39]
    v_mfma_f32_16x16x32_bf16 v[36:39], v[240:243], v[88:91], v[36:39]
    v_mfma_f32_16x16x32_bf16 v[36:39], v[240:243], v[120:123], v[36:39]
    v_mfma_f32_16x16x32_bf16 v[40:43], v[242:245], v[60:63], v[40:43]
    v_mfma_f32_16x16x32_bf16 v[40:43], v[242:245], v[92:95], v[40:43]
    v_mfma_f32_16x16x32_bf16 v[40:43], v[242:245], v[124:127], v[40:43]
    v_mfma_f32_16x16x32_bf16 v[44:47], v[240:243], v[60:63], v[44:47]
    v_mfma_f32_16x16x32_bf16 v[44:47], v[240:243], v[92:95], v[44:47]
    v_mfma_f32_16x16x32_bf16 v[44:47], v[240:243], v[124:127], v[44:47]
    s_waitcnt vmcnt(12) lgkmcnt(8)
    v_lshlrev_b32 v80, 16, v128
    v_and_b32 v81, s6, v128
    v_lshlrev_b32 v82, 16, v129
    v_and_b32 v83, s6, v129
    v_lshlrev_b32 v84, 16, v130
    v_and_b32 v85, s6, v130
    v_lshlrev_b32 v86, 16, v131
    v_and_b32 v87, s6, v131
    v_lshlrev_b32 v88, 16, v132
    v_and_b32 v89, s6, v132
    v_lshlrev_b32 v90, 16, v133
    v_and_b32 v91, s6, v133
    v_mfma_f32_16x16x32_bf16 v[64:67], v[208:211], a[144:147], v[64:67]
    v_lshlrev_b32 v92, 16, v134
    v_and_b32 v93, s6, v134
    v_lshlrev_b32 v94, 16, v135
    v_and_b32 v95, s6, v135
    v_lshlrev_b32 v112, 16, v136
    v_and_b32 v113, s6, v136
    v_lshlrev_b32 v114, 16, v137
    v_and_b32 v115, s6, v137
    v_lshlrev_b32 v116, 16, v138
    v_and_b32 v117, s6, v138
    v_lshlrev_b32 v118, 16, v139
    v_and_b32 v119, s6, v139
    v_mfma_f32_16x16x32_bf16 v[64:67], v[212:215], a[152:155], v[64:67]
    v_lshlrev_b32 v120, 16, v140
    v_and_b32 v121, s6, v140
    v_lshlrev_b32 v122, 16, v141
    v_and_b32 v123, s6, v141
    v_lshlrev_b32 v124, 16, v142
    v_and_b32 v125, s6, v142
    v_lshlrev_b32 v126, 16, v143
    v_and_b32 v127, s6, v143
    v_mul_f32 v48, s7, v16
    v_mul_f32 v49, s7, v17
    v_mul_f32 v50, s7, v18
    v_mul_f32 v51, s7, v19
    v_mfma_f32_16x16x32_bf16 v[72:75], v[208:211], a[148:151], v[72:75]
    v_mul_f32 v52, s7, v20
    v_mul_f32 v53, s7, v21
    v_mul_f32 v54, s7, v22
    v_mul_f32 v55, s7, v23
    v_mul_f32 v56, s7, v24
    v_mul_f32 v57, s7, v25
    v_mul_f32 v58, s7, v26
    v_mul_f32 v59, s7, v27
    v_mul_f32 v60, s7, v28
    v_mul_f32 v61, s7, v29
    v_mul_f32 v62, s7, v30
    v_mul_f32 v63, s7, v31
    v_mfma_f32_16x16x32_bf16 v[72:75], v[212:215], a[156:159], v[72:75]
    v_exp_f32 v48, v48
    v_exp_f32 v49, v49
    v_exp_f32 v50, v50
    v_exp_f32 v51, v51
    v_exp_f32 v52, v52
    v_exp_f32 v53, v53
    v_exp_f32 v54, v54
    v_exp_f32 v55, v55
    v_exp_f32 v56, v56
    v_exp_f32 v57, v57
    v_exp_f32 v58, v58
    v_exp_f32 v59, v59
    v_mfma_f32_16x16x32_bf16 v[68:71], v[216:219], a[144:147], v[68:71]
    v_exp_f32 v60, v60
    v_exp_f32 v61, v61
    v_exp_f32 v62, v62
    v_exp_f32 v63, v63
    v_add_f32 v48, 1.0, v48
    v_add_f32 v49, 1.0, v49
    v_add_f32 v50, 1.0, v50
    v_add_f32 v51, 1.0, v51
    v_add_f32 v52, 1.0, v52
    v_add_f32 v53, 1.0, v53
    v_add_f32 v54, 1.0, v54
    v_add_f32 v55, 1.0, v55
    v_mfma_f32_16x16x32_bf16 v[68:71], v[220:223], a[152:155], v[68:71]
    v_add_f32 v56, 1.0, v56
    v_add_f32 v57, 1.0, v57
    v_add_f32 v58, 1.0, v58
    v_add_f32 v59, 1.0, v59
    v_add_f32 v60, 1.0, v60
    v_add_f32 v61, 1.0, v61
    v_add_f32 v62, 1.0, v62
    v_add_f32 v63, 1.0, v63
    v_rcp_f32 v48, v48
    v_rcp_f32 v49, v49
    v_rcp_f32 v50, v50
    v_rcp_f32 v51, v51
    v_mfma_f32_16x16x32_bf16 v[76:79], v[216:219], a[148:151], v[76:79]
    v_rcp_f32 v52, v52
    v_rcp_f32 v53, v53
    v_rcp_f32 v54, v54
    v_rcp_f32 v55, v55
    v_rcp_f32 v56, v56
    v_rcp_f32 v57, v57
    v_rcp_f32 v58, v58
    v_rcp_f32 v59, v59
    v_rcp_f32 v60, v60
    v_rcp_f32 v61, v61
    v_rcp_f32 v62, v62
    v_rcp_f32 v63, v63
    v_mfma_f32_16x16x32_bf16 v[76:79], v[220:223], a[156:159], v[76:79]
    v_mul_f32 v16, v16, v48
    v_mul_f32 v17, v17, v49
    v_mul_f32 v18, v18, v50
    v_mul_f32 v19, v19, v51
    v_mul_f32 v20, v20, v52
    v_mul_f32 v21, v21, v53
    v_mul_f32 v22, v22, v54
    v_mul_f32 v23, v23, v55
    v_mul_f32 v24, v24, v56
    v_mul_f32 v25, v25, v57
    v_mul_f32 v26, v26, v58
    v_mul_f32 v27, v27, v59
    s_waitcnt lgkmcnt(0)
    v_mul_f32 v28, v28, v60
    v_mul_f32 v29, v29, v61
    v_mul_f32 v30, v30, v62
    v_mul_f32 v31, v31, v63
    v_mul_f32 v48, s7, v32
    v_mul_f32 v49, s7, v33
    v_mul_f32 v50, s7, v34
    v_mul_f32 v51, s7, v35
    v_mul_f32 v52, s7, v36
    v_mul_f32 v53, s7, v37
    v_mul_f32 v54, s7, v38
    v_mul_f32 v55, s7, v39
    v_mfma_f32_16x16x32_bf16 v[96:99], v[224:227], a[144:147], v[96:99]
    v_mul_f32 v56, s7, v40
    v_mul_f32 v57, s7, v41
    v_mul_f32 v58, s7, v42
    v_mul_f32 v59, s7, v43
    v_mul_f32 v60, s7, v44
    v_mul_f32 v61, s7, v45
    v_mul_f32 v62, s7, v46
    v_mul_f32 v63, s7, v47
    v_exp_f32 v48, v48
    v_exp_f32 v49, v49
    v_exp_f32 v50, v50
    v_exp_f32 v51, v51
    v_mfma_f32_16x16x32_bf16 v[96:99], v[228:231], a[152:155], v[96:99]
    v_exp_f32 v52, v52
    v_exp_f32 v53, v53
    v_exp_f32 v54, v54
    v_exp_f32 v55, v55
    v_exp_f32 v56, v56
    v_exp_f32 v57, v57
    v_exp_f32 v58, v58
    v_exp_f32 v59, v59
    v_exp_f32 v60, v60
    v_exp_f32 v61, v61
    v_exp_f32 v62, v62
    v_exp_f32 v63, v63
    v_mfma_f32_16x16x32_bf16 v[104:107], v[224:227], a[148:151], v[104:107]
    v_add_f32 v48, 1.0, v48
    v_add_f32 v49, 1.0, v49
    v_add_f32 v50, 1.0, v50
    v_add_f32 v51, 1.0, v51
    v_add_f32 v52, 1.0, v52
    v_add_f32 v53, 1.0, v53
    v_add_f32 v54, 1.0, v54
    v_add_f32 v55, 1.0, v55
    v_add_f32 v56, 1.0, v56
    v_add_f32 v57, 1.0, v57
    v_add_f32 v58, 1.0, v58
    v_add_f32 v59, 1.0, v59
    v_mfma_f32_16x16x32_bf16 v[104:107], v[228:231], a[156:159], v[104:107]
    v_add_f32 v60, 1.0, v60
    v_add_f32 v61, 1.0, v61
    v_add_f32 v62, 1.0, v62
    v_add_f32 v63, 1.0, v63
    v_rcp_f32 v48, v48
    v_rcp_f32 v49, v49
    v_rcp_f32 v50, v50
    v_rcp_f32 v51, v51
    v_rcp_f32 v52, v52
    v_rcp_f32 v53, v53
    v_rcp_f32 v54, v54
    v_rcp_f32 v55, v55
    v_mfma_f32_16x16x32_bf16 v[100:103], v[232:235], a[144:147], v[100:103]
    v_rcp_f32 v56, v56
    v_rcp_f32 v57, v57
    v_rcp_f32 v58, v58
    v_rcp_f32 v59, v59
    v_rcp_f32 v60, v60
    v_rcp_f32 v61, v61
    v_rcp_f32 v62, v62
    v_rcp_f32 v63, v63
    v_mul_f32 v32, v32, v48
    v_mul_f32 v33, v33, v49
    v_mul_f32 v34, v34, v50
    v_mul_f32 v35, v35, v51
    v_mfma_f32_16x16x32_bf16 v[100:103], v[236:239], a[152:155], v[100:103]
    v_mul_f32 v36, v36, v52
    v_mul_f32 v37, v37, v53
    v_mul_f32 v38, v38, v54
    v_mul_f32 v39, v39, v55
    v_mul_f32 v40, v40, v56
    v_mul_f32 v41, v41, v57
    v_mul_f32 v42, v42, v58
    v_mul_f32 v43, v43, v59
    v_mul_f32 v44, v44, v60
    v_mul_f32 v45, v45, v61
    v_mul_f32 v46, v46, v62
    v_mul_f32 v47, v47, v63
    v_mfma_f32_16x16x32_bf16 v[108:111], v[232:235], a[148:151], v[108:111]
    v_mfma_f32_16x16x32_bf16 v[108:111], v[236:239], a[156:159], v[108:111]
    v_fma_f32 v64, v64, v16, v80
    v_fma_f32 v65, v65, v17, v81
    v_fma_f32 v66, v66, v18, v82
    v_fma_f32 v67, v67, v19, v83
    v_fma_f32 v68, v68, v20, v84
    v_fma_f32 v69, v69, v21, v85
    v_fma_f32 v70, v70, v22, v86
    v_fma_f32 v71, v71, v23, v87
    v_cvt_pk_bf16_f32 v48, v64, v65
    v_cvt_pk_bf16_f32 v49, v66, v67
    v_cvt_pk_bf16_f32 v50, v68, v69
    v_cvt_pk_bf16_f32 v51, v70, v71
    ds_write_b64 v246, v[48:49] offset:0
    ds_write_b64 v247, v[50:51] offset:0
    v_fma_f32 v72, v72, v24, v88
    v_fma_f32 v73, v73, v25, v89
    v_fma_f32 v74, v74, v26, v90
    v_fma_f32 v75, v75, v27, v91
    v_fma_f32 v76, v76, v28, v92
    v_fma_f32 v77, v77, v29, v93
    v_fma_f32 v78, v78, v30, v94
    v_fma_f32 v79, v79, v31, v95
    v_cvt_pk_bf16_f32 v52, v72, v73
    v_cvt_pk_bf16_f32 v53, v74, v75
    v_cvt_pk_bf16_f32 v54, v76, v77
    v_cvt_pk_bf16_f32 v55, v78, v79
    ds_write_b64 v246, v[52:53] offset:2048
    ds_write_b64 v247, v[54:55] offset:2048
    v_fma_f32 v96, v96, v32, v112
    v_fma_f32 v97, v97, v33, v113
    v_fma_f32 v98, v98, v34, v114
    v_fma_f32 v99, v99, v35, v115
    v_fma_f32 v100, v100, v36, v116
    v_fma_f32 v101, v101, v37, v117
    v_fma_f32 v102, v102, v38, v118
    v_fma_f32 v103, v103, v39, v119
    v_cvt_pk_bf16_f32 v56, v96, v97
    v_cvt_pk_bf16_f32 v57, v98, v99
    v_cvt_pk_bf16_f32 v58, v100, v101
    v_cvt_pk_bf16_f32 v59, v102, v103
    ds_write_b64 v248, v[56:57] offset:0
    ds_write_b64 v249, v[58:59] offset:0
    v_fma_f32 v104, v104, v40, v120
    v_fma_f32 v105, v105, v41, v121
    v_fma_f32 v106, v106, v42, v122
    v_fma_f32 v107, v107, v43, v123
    v_fma_f32 v108, v108, v44, v124
    v_fma_f32 v109, v109, v45, v125
    v_fma_f32 v110, v110, v46, v126
    v_fma_f32 v111, v111, v47, v127
    v_cvt_pk_bf16_f32 v60, v104, v105
    v_cvt_pk_bf16_f32 v61, v106, v107
    v_cvt_pk_bf16_f32 v62, v108, v109
    v_cvt_pk_bf16_f32 v63, v110, v111
    ds_write_b64 v248, v[60:61] offset:2048
    ds_write_b64 v249, v[62:63] offset:2048
    s_waitcnt lgkmcnt(0)
    ds_read_b128 v[128:131], v252 offset:0
    ds_read_b128 v[132:135], v252 offset:1024
    ds_read_b128 v[136:139], v252 offset:2048
    ds_read_b128 v[140:143], v252 offset:3072
    s_add_u32 s5, s54, 0
    s_waitcnt lgkmcnt(3)
    buffer_store_dwordx4 v[128:131], v250, s[16:19], s5 offen
    s_add_u32 s5, s54, 16384
    s_waitcnt lgkmcnt(2)
    buffer_store_dwordx4 v[132:135], v251, s[16:19], s5 offen
    s_add_u32 s5, s54, 32768
    s_waitcnt lgkmcnt(1)
    buffer_store_dwordx4 v[136:139], v250, s[16:19], s5 offen
    s_add_u32 s5, s54, 49152
    s_waitcnt lgkmcnt(0)
    buffer_store_dwordx4 v[140:143], v251, s[16:19], s5 offen
recurrent_scan__linear_kernel_hedgehog__glu_gated_bilinear__prompt_kernel_end:
    s_endpgm
code_end:
.section .rodata,"a"
.p2align 6
.amdhsa_kernel recurrent_scan__linear_kernel_hedgehog__glu_gated_bilinear__prompt_kernel
  .amdhsa_next_free_vgpr 512
  .amdhsa_next_free_sgpr 102
  .amdhsa_accum_offset 256
  .amdhsa_group_segment_fixed_size 0
  .amdhsa_kernarg_size 88
  .amdhsa_user_sgpr_count 2
  .amdhsa_user_sgpr_kernarg_segment_ptr 1
  .amdhsa_system_sgpr_workgroup_id_x 1
  .amdhsa_float_denorm_mode_32 3
.end_amdhsa_kernel
```
